```python
import torch

def _softmax(x, axis=-1):
    return torch.softmax(x, dim=axis)
def _gelu(x):
    return torch.nn.functional.gelu(x, approximate="tanh")
def _silu(x):
    return torch.nn.functional.silu(x)
def _sigmoid(x):
    return torch.sigmoid(x)
def _layernorm(x, axis=-1, eps=1e-5):
    m = x.mean(dim=axis, keepdim=True)
    v = x.var(dim=axis, keepdim=True, unbiased=False)
    return (x - m) / torch.sqrt(v + eps)
def _scatter_add(tgt, idx, src, axis=0):
    return tgt.clone().index_add_(axis, idx, src)
def _segment_sum(src, seg, n):
    out = torch.zeros((n,) + src.shape[1:], dtype=src.dtype)
    return out.index_add_(0, seg, src)
def _pad(x, pw):
    flat = tuple(v for pair in reversed(pw) for v in pair)
    return torch.nn.functional.pad(x, flat)

kernel_name = 'gated_mix__softmax_full_mha__mixer_s_mlp__prompt'

def setup_inputs():

    _w = (lambda a: (lambda t: t.to(torch.bfloat16) if t.is_floating_point() else t)(torch.as_tensor(a)))
    def _A_setup():
        B, S, D = 1, 2048, 512
        return {
            "x": _w((lambda *s: torch.randn(*s, dtype=torch.bfloat16) * 0.05)(B, S, D)),
            "wqkv": _w((lambda *s: torch.randn(*s, dtype=torch.bfloat16) * 1.6)(D, 3 * D)),
            "wo": _w((lambda *s: torch.randn(*s, dtype=torch.bfloat16) * 0.1)(D, D)),
        }
    _A_in = _A_setup()

    def _B_setup():
        B, S, D, F = 1, 2048, 512, 1376
        return {
            "x":  _w((lambda *s: torch.randn(*s, dtype=torch.bfloat16) * 0.05)(B, S, D)),
            "w1": _w((lambda *s: torch.randn(*s, dtype=torch.bfloat16) * 3.2)(D, D) * (D ** -0.5)),
            "w2": _w((lambda *s: torch.randn(*s, dtype=torch.bfloat16) * 3.2)(D, D) * (D ** -0.5)),
            "w3": _w((lambda *s: torch.randn(*s, dtype=torch.bfloat16) * 3.2)(D, F) * (D ** -0.5)),
            "w4": _w((lambda *s: torch.randn(*s, dtype=torch.bfloat16) * 1.6)(F, D) * (F ** -0.5)),
        }
    _B_in = _B_setup()

    return {
        "A_x": _A_in["x"],
        "A_wqkv": _A_in["wqkv"],
        "A_wo": _A_in["wo"],
        "B_x": _B_in["x"],
        "B_w1": _B_in["w1"],
        "B_w2": _B_in["w2"],
        "B_w3": _B_in["w3"],
        "B_w4": _B_in["w4"],
        "gate_w": _w((lambda *s: torch.randn(*s, dtype=torch.bfloat16) * 0.05)(512) * 16.0),
    }

def reference(A_x, A_wqkv, A_wo, B_x, B_w1, B_w2, B_w3, B_w4, gate_w):
    def _A_ref(x, wqkv, wo):
        B, S, D = x.shape
        H = 32; Dh = D // H
        qkv = (lambda x, *d: x.permute(*d))((x @ wqkv).reshape(B, S, 3, H, Dh), 2, 0, 3, 1, 4)
        q, k, v = qkv[0], qkv[1], qkv[2]
        scale = Dh ** -0.5
        scores = torch.einsum("bhqd,bhkd->bhqk", q, k) * scale
        p = _softmax(scores, axis=-1)
        o = torch.einsum("bhqk,bhkd->bhqd", p, v)
        return (lambda x, *d: x.permute(*d))(o, 0, 2, 1, 3).reshape(B, S, D) @ wo

    def _B_ref(x, w1, w2, w3, w4):
        B, S, D = x.shape
        h = _gelu(_layernorm(x, axis=-1) @ w1)
        c = D // 4
        g0 = _pad(h[:, :, 0*c:1*c], ((0, 0), (1, 0), (0, 0)))[:, :S, :]
        g1 = _pad(h[:, :, 1*c:2*c], ((0, 0), (0, 1), (0, 0)))[:, 1:, :]
        g2 = _pad(h[:, :, 2*c:3*c], ((0, 0), (2, 0), (0, 0)))[:, :S, :]
        g3 = _pad(h[:, :, 3*c:   ], ((0, 0), (0, 2), (0, 0)))[:, 2:, :]
        hs = torch.concatenate([g0, g1, g2, g3], axis=-1) @ w2
        x1 = x + hs
        h2 = _gelu(_layernorm(x1, axis=-1) @ w3) @ w4
        return x1 + h2

    x = A_x
    g = _sigmoid((x * gate_w).sum(-1, keepdims=True))
    a = _A_ref(x, A_wqkv, A_wo)
    b = _B_ref(x, B_w1, B_w2, B_w3, B_w4)
    return g * a + (1 - g) * b
```

```asm
; @launch kernel=k1_kernel grid=(256,1,1) block=(768,1,1) lds=154112
; @launch kernel=k2_kernel grid=(512,1,1) block=(256,1,1) lds=81920
.amdgcn_target "amdgcn-amd-amdhsa--gfx950"
.text
.globl k1_kernel
.p2align 8
.type k1_kernel,@function
k1_kernel:
    s_cmp_ge_u32 s2, 256
    s_cbranch_scc1 K1_END
    s_load_dwordx4 s[4:7], s[0:1], 0
    s_load_dwordx2 s[30:31], s[0:1], 32
    s_load_dwordx2 s[32:33], s[0:1], 64
    s_load_dwordx2 s[28:29], s[0:1], 88
    s_sub_u32 s62, s2, 64
    s_cmp_ge_u32 s62, 8
    s_cbranch_scc1 CPF_1
    s_getpc_b64 s[60:61]
CPF_1_pc:
    s_sub_u32 s60, s60, CPF_1_pc-k1_kernel
    s_subb_u32 s61, s61, 0
    s_lshr_b32 s62, s62, 3
    s_mul_i32 s62, s62, 0
    v_lshlrev_b32 v140, 7, v0
    v_add_u32 v140, s62, v140
    s_mov_b32 s62, K2_CODE_END-k1_kernel
    v_cmp_gt_u32 vcc, s62, v140
    s_and_saveexec_b64 s[62:63], vcc
    s_cbranch_execz CPF_1_x
    global_load_dword v140, v140, s[60:61]
CPF_1_x:
    s_mov_b64 exec, s[62:63]
CPF_1:
    v_lshrrev_b32 v1, 6, v0
    v_and_b32 v0, 63, v0
    s_and_b32 s40, s2, 7
    v_readfirstlane_b32 s36, v1
    s_lshr_b32 s41, s2, 3
    s_and_b32 s34, s40, 3
    s_lshl_b32 s34, s34, 2
    s_and_b32 s42, s41, 3
    s_add_u32 s34, s34, s42
    s_lshr_b32 s40, s40, 2
    s_lshr_b32 s42, s41, 2
    s_mul_i32 s35, s40, 6
    s_add_u32 s35, s35, s42
    s_sub_u32 s35, s35, 2
    s_lshl_b32 s40, s40, 1
    s_add_u32 s40, s40, s42
    s_add_u32 s40, s40, 12
    s_cmp_lt_u32 s41, 8
    s_cselect_b32 s35, s40, s35
    s_lshr_b32 s37, s35, 2
    s_cmp_eq_u32 s37, 3
    s_mov_b32 s38, 3072
    s_cselect_b32 s38, 1024, s38
    s_cselect_b32 s40, 12, 0
    s_sub_u32 s40, s35, s40
    s_lshl_b32 s44, s40, 8
    s_lshl_b32 s39, s38, 4
    s_sub_u32 s40, s36, 4
    s_cmp_lt_u32 s40, 4
    s_cbranch_scc0 K1_NOTLOADER
    s_sub_u32 s45, s36, 4
    s_lshl_b32 s46, s45, 10
    s_lshl_b32 s43, s34, 17
    v_lshrrev_b32 v1, 3, v0
    v_lshlrev_b32 v4, 10, v1
    v_lshrrev_b32 v1, 4, v0
    s_and_b32 s40, s45, 1
    s_lshl_b32 s40, s40, 2
    v_add_u32 v2, s40, v1
    v_and_b32 v3, 7, v0
    v_xor_b32 v2, v2, v3
    v_lshl_add_u32 v4, v2, 4, v4
    s_lshl_b32 s40, s45, 13
    v_add_u32 v4, s40, v4
    v_mul_lo_u32 v5, v1, s38
    v_lshlrev_b32 v2, 2, v1
    v_and_b32 v3, 15, v0
    v_xor_b32 v2, v2, v3
    v_lshl_add_u32 v5, v2, 4, v5
    s_mul_i32 s40, s45, s38
    s_lshl_b32 s40, s40, 2
    v_add_u32 v5, s40, v5
    s_waitcnt lgkmcnt(0)
    s_mov_b32 s8, s4
    s_mov_b32 s9, s5
    s_mov_b32 s10, 0x200000
    s_mov_b32 s11, 0x20000
    s_cmp_eq_u32 s37, 3
    s_cselect_b32 s12, s30, s6
    s_cselect_b32 s13, s31, s7
    s_mov_b32 s14, 0x180000
    s_cselect_b32 s14, 0x80000, s14
    s_mov_b32 s15, 0x20000
    s_mov_b32 s20, s32
    s_mov_b32 s21, s33
    s_mov_b32 s22, 0x400
    s_mov_b32 s23, 0x20000
    s_add_u32 m0, s46, 0
    s_add_u32 s40, s43, 0
    buffer_load_dwordx4 v4, s[8:11], s40 offen lds
    s_add_u32 m0, s46, 16384
    s_nop 0
    buffer_load_dwordx4 v5, s[12:15], s44 offen lds
    s_add_u32 s44, s44, s39
    s_add_u32 m0, s46, 4096
    s_add_u32 s40, s43, 32768
    buffer_load_dwordx4 v4, s[8:11], s40 offen lds
    s_add_u32 m0, s46, 20480
    s_nop 0
    buffer_load_dwordx4 v5, s[12:15], s44 offen lds
    s_add_u32 s44, s44, s39
    s_add_u32 m0, s46, 8192
    s_add_u32 s40, s43, 65536
    buffer_load_dwordx4 v4, s[8:11], s40 offen lds
    s_add_u32 m0, s46, 24576
    s_nop 0
    buffer_load_dwordx4 v5, s[12:15], s44 offen lds
    s_add_u32 s44, s44, s39
    s_add_u32 m0, s46, 12288
    s_add_u32 s40, s43, 98304
    buffer_load_dwordx4 v4, s[8:11], s40 offen lds
    s_add_u32 m0, s46, 28672
    s_nop 0
    buffer_load_dwordx4 v5, s[12:15], s44 offen lds
    s_add_u32 s44, s44, s39
    v_lshlrev_b32 v1, 4, v0
    s_mov_b32 m0, 131072
    s_nop 0
    buffer_load_dwordx4 v1, s[20:23], 0 offen lds
    s_add_u32 m0, s46, 32768
    s_add_u32 s40, s43, 128
    buffer_load_dwordx4 v4, s[8:11], s40 offen lds
    s_add_u32 m0, s46, 49152
    s_nop 0
    buffer_load_dwordx4 v5, s[12:15], s44 offen lds
    s_add_u32 s44, s44, s39
    s_add_u32 m0, s46, 36864
    s_add_u32 s40, s43, 32896
    buffer_load_dwordx4 v4, s[8:11], s40 offen lds
    s_add_u32 m0, s46, 53248
    s_nop 0
    buffer_load_dwordx4 v5, s[12:15], s44 offen lds
    s_add_u32 s44, s44, s39
    s_add_u32 m0, s46, 40960
    s_add_u32 s40, s43, 65664
    buffer_load_dwordx4 v4, s[8:11], s40 offen lds
    s_add_u32 m0, s46, 57344
    s_nop 0
    buffer_load_dwordx4 v5, s[12:15], s44 offen lds
    s_add_u32 s44, s44, s39
    s_add_u32 m0, s46, 45056
    s_add_u32 s40, s43, 98432
    buffer_load_dwordx4 v4, s[8:11], s40 offen lds
    s_add_u32 m0, s46, 61440
    s_nop 0
    buffer_load_dwordx4 v5, s[12:15], s44 offen lds
    s_add_u32 s44, s44, s39
    s_waitcnt vmcnt(8)
    s_barrier
    s_add_u32 m0, s46, 65536
    s_add_u32 s40, s43, 256
    buffer_load_dwordx4 v4, s[8:11], s40 offen lds
    s_add_u32 m0, s46, 81920
    s_nop 0
    buffer_load_dwordx4 v5, s[12:15], s44 offen lds
    s_add_u32 s44, s44, s39
    s_add_u32 m0, s46, 69632
    s_add_u32 s40, s43, 33024
    buffer_load_dwordx4 v4, s[8:11], s40 offen lds
    s_add_u32 m0, s46, 86016
    s_nop 0
    buffer_load_dwordx4 v5, s[12:15], s44 offen lds
    s_add_u32 s44, s44, s39
    s_add_u32 m0, s46, 73728
    s_add_u32 s40, s43, 65792
    buffer_load_dwordx4 v4, s[8:11], s40 offen lds
    s_add_u32 m0, s46, 90112
    s_nop 0
    buffer_load_dwordx4 v5, s[12:15], s44 offen lds
    s_add_u32 s44, s44, s39
    s_add_u32 m0, s46, 77824
    s_add_u32 s40, s43, 98560
    buffer_load_dwordx4 v4, s[8:11], s40 offen lds
    s_add_u32 m0, s46, 94208
    s_nop 0
    buffer_load_dwordx4 v5, s[12:15], s44 offen lds
    s_add_u32 s44, s44, s39
    s_add_u32 m0, s46, 98304
    s_add_u32 s40, s43, 384
    buffer_load_dwordx4 v4, s[8:11], s40 offen lds
    s_add_u32 m0, s46, 114688
    s_nop 0
    buffer_load_dwordx4 v5, s[12:15], s44 offen lds
    s_add_u32 s44, s44, s39
    s_add_u32 m0, s46, 102400
    s_add_u32 s40, s43, 33152
    buffer_load_dwordx4 v4, s[8:11], s40 offen lds
    s_add_u32 m0, s46, 118784
    s_nop 0
    buffer_load_dwordx4 v5, s[12:15], s44 offen lds
    s_add_u32 s44, s44, s39
    s_add_u32 m0, s46, 106496
    s_add_u32 s40, s43, 65920
    buffer_load_dwordx4 v4, s[8:11], s40 offen lds
    s_add_u32 m0, s46, 122880
    s_nop 0
    buffer_load_dwordx4 v5, s[12:15], s44 offen lds
    s_add_u32 s44, s44, s39
    s_add_u32 m0, s46, 110592
    s_add_u32 s40, s43, 98688
    buffer_load_dwordx4 v4, s[8:11], s40 offen lds
    s_add_u32 m0, s46, 126976
    s_nop 0
    buffer_load_dwordx4 v5, s[12:15], s44 offen lds
    s_add_u32 s44, s44, s39
    s_waitcnt vmcnt(16)
    s_barrier
    s_add_u32 m0, s46, 0
    s_add_u32 s40, s43, 512
    buffer_load_dwordx4 v4, s[8:11], s40 offen lds
    s_add_u32 m0, s46, 16384
    s_nop 0
    buffer_load_dwordx4 v5, s[12:15], s44 offen lds
    s_add_u32 s44, s44, s39
    s_add_u32 m0, s46, 4096
    s_add_u32 s40, s43, 33280
    buffer_load_dwordx4 v4, s[8:11], s40 offen lds
    s_add_u32 m0, s46, 20480
    s_nop 0
    buffer_load_dwordx4 v5, s[12:15], s44 offen lds
    s_add_u32 s44, s44, s39
    s_add_u32 m0, s46, 8192
    s_add_u32 s40, s43, 66048
    buffer_load_dwordx4 v4, s[8:11], s40 offen lds
    s_add_u32 m0, s46, 24576
    s_nop 0
    buffer_load_dwordx4 v5, s[12:15], s44 offen lds
    s_add_u32 s44, s44, s39
    s_add_u32 m0, s46, 12288
    s_add_u32 s40, s43, 98816
    buffer_load_dwordx4 v4, s[8:11], s40 offen lds
    s_add_u32 m0, s46, 28672
    s_nop 0
    buffer_load_dwordx4 v5, s[12:15], s44 offen lds
    s_add_u32 s44, s44, s39
    s_waitcnt vmcnt(16)
    s_barrier
    s_add_u32 m0, s46, 32768
    s_add_u32 s40, s43, 640
    buffer_load_dwordx4 v4, s[8:11], s40 offen lds
    s_add_u32 m0, s46, 49152
    s_nop 0
    buffer_load_dwordx4 v5, s[12:15], s44 offen lds
    s_add_u32 s44, s44, s39
    s_add_u32 m0, s46, 36864
    s_add_u32 s40, s43, 33408
    buffer_load_dwordx4 v4, s[8:11], s40 offen lds
    s_add_u32 m0, s46, 53248
    s_nop 0
    buffer_load_dwordx4 v5, s[12:15], s44 offen lds
    s_add_u32 s44, s44, s39
    s_add_u32 m0, s46, 40960
    s_add_u32 s40, s43, 66176
    buffer_load_dwordx4 v4, s[8:11], s40 offen lds
    s_add_u32 m0, s46, 57344
    s_nop 0
    buffer_load_dwordx4 v5, s[12:15], s44 offen lds
    s_add_u32 s44, s44, s39
    s_add_u32 m0, s46, 45056
    s_add_u32 s40, s43, 98944
    buffer_load_dwordx4 v4, s[8:11], s40 offen lds
    s_add_u32 m0, s46, 61440
    s_nop 0
    buffer_load_dwordx4 v5, s[12:15], s44 offen lds
    s_add_u32 s44, s44, s39
    s_waitcnt vmcnt(16)
    s_barrier
    s_add_u32 m0, s46, 65536
    s_add_u32 s40, s43, 768
    buffer_load_dwordx4 v4, s[8:11], s40 offen lds
    s_add_u32 m0, s46, 81920
    s_nop 0
    buffer_load_dwordx4 v5, s[12:15], s44 offen lds
    s_add_u32 s44, s44, s39
    s_add_u32 m0, s46, 69632
    s_add_u32 s40, s43, 33536
    buffer_load_dwordx4 v4, s[8:11], s40 offen lds
    s_add_u32 m0, s46, 86016
    s_nop 0
    buffer_load_dwordx4 v5, s[12:15], s44 offen lds
    s_add_u32 s44, s44, s39
    s_add_u32 m0, s46, 73728
    s_add_u32 s40, s43, 66304
    buffer_load_dwordx4 v4, s[8:11], s40 offen lds
    s_add_u32 m0, s46, 90112
    s_nop 0
    buffer_load_dwordx4 v5, s[12:15], s44 offen lds
    s_add_u32 s44, s44, s39
    s_add_u32 m0, s46, 77824
    s_add_u32 s40, s43, 99072
    buffer_load_dwordx4 v4, s[8:11], s40 offen lds
    s_add_u32 m0, s46, 94208
    s_nop 0
    buffer_load_dwordx4 v5, s[12:15], s44 offen lds
    s_add_u32 s44, s44, s39
    s_waitcnt vmcnt(16)
    s_barrier
    s_add_u32 m0, s46, 98304
    s_add_u32 s40, s43, 896
    buffer_load_dwordx4 v4, s[8:11], s40 offen lds
    s_add_u32 m0, s46, 114688
    s_nop 0
    buffer_load_dwordx4 v5, s[12:15], s44 offen lds
    s_add_u32 s44, s44, s39
    s_add_u32 m0, s46, 102400
    s_add_u32 s40, s43, 33664
    buffer_load_dwordx4 v4, s[8:11], s40 offen lds
    s_add_u32 m0, s46, 118784
    s_nop 0
    buffer_load_dwordx4 v5, s[12:15], s44 offen lds
    s_add_u32 s44, s44, s39
    s_add_u32 m0, s46, 106496
    s_add_u32 s40, s43, 66432
    buffer_load_dwordx4 v4, s[8:11], s40 offen lds
    s_add_u32 m0, s46, 122880
    s_nop 0
    buffer_load_dwordx4 v5, s[12:15], s44 offen lds
    s_add_u32 s44, s44, s39
    s_add_u32 m0, s46, 110592
    s_add_u32 s40, s43, 99200
    buffer_load_dwordx4 v4, s[8:11], s40 offen lds
    s_add_u32 m0, s46, 126976
    s_nop 0
    buffer_load_dwordx4 v5, s[12:15], s44 offen lds
    s_add_u32 s44, s44, s39
    s_waitcnt vmcnt(16)
    s_barrier
    s_waitcnt vmcnt(8)
    s_barrier
    s_waitcnt vmcnt(0)
    s_barrier
    s_cmp_eq_u32 s37, 3
    s_cbranch_scc0 K1_LOADER_END
    s_barrier
K1_LOADER_END:
    s_endpgm
K1_NOTLOADER:
    s_waitcnt lgkmcnt(0)
    s_mov_b32 s8, s4
    s_mov_b32 s9, s5
    s_mov_b32 s10, 0x200000
    s_mov_b32 s11, 0x20000
    s_cmp_eq_u32 s37, 3
    s_cselect_b32 s12, s30, s6
    s_cselect_b32 s13, s31, s7
    s_mov_b32 s14, 0x180000
    s_cselect_b32 s14, 0x80000, s14
    s_mov_b32 s15, 0x20000
    s_cmp_ge_u32 s36, 8
    s_cbranch_scc1 K1_STATS
    s_lshr_b32 s52, s36, 1
    s_and_b32 s53, s36, 1
    s_lshl_b32 s40, s52, 6
    s_lshl_b32 s41, s53, 1
    s_add_u32 s42, s41, 1
    s_cmp_eq_u32 s37, 3
    s_cbranch_scc1 K1_HTYPE
    v_and_b32 v2, 31, v0
    v_lshrrev_b32 v3, 5, v0
    v_add_u32 v112, s40, v2
    v_lshlrev_b32 v112, 7, v112
    v_bfe_u32 v113, v0, 1, 3
    v_add_u32 v114, 0, v3
    v_xor_b32 v114, v114, v113
    v_lshl_add_u32 v4, v114, 4, v112
    v_add_u32 v8, 0x10000, v4
    v_add_u32 v114, 2, v3
    v_xor_b32 v114, v114, v113
    v_lshl_add_u32 v5, v114, 4, v112
    v_add_u32 v9, 0x10000, v5
    v_add_u32 v114, 4, v3
    v_xor_b32 v114, v114, v113
    v_lshl_add_u32 v6, v114, 4, v112
    v_add_u32 v10, 0x10000, v6
    v_add_u32 v114, 6, v3
    v_xor_b32 v114, v114, v113
    v_lshl_add_u32 v7, v114, 4, v112
    v_add_u32 v11, 0x10000, v7
    v_bfe_u32 v112, v0, 2, 2
    v_lshl_add_u32 v113, v3, 3, v112
    v_lshlrev_b32 v113, 8, v113
    v_bfe_u32 v114, v0, 4, 1
    v_lshl_add_u32 v113, v114, 5, v113
    v_and_b32 v114, 3, v0
    v_lshl_add_u32 v113, v114, 3, v113
    v_add_u32 v113, 16384, v113
    v_xor_b32 v114, s41, v112
    v_lshl_add_u32 v12, v114, 6, v113
    v_add_u32 v14, 0x10000, v12
    v_xor_b32 v114, s42, v112
    v_lshl_add_u32 v13, v114, 6, v113
    v_add_u32 v15, 0x10000, v13
    s_cmp_eq_u32 s37, 2
    s_cbranch_scc1 K1_VTYPE
    s_barrier
    ds_read_b64_tr_b16 v[32:33], v12 offset:0
    ds_read_b64_tr_b16 v[34:35], v12 offset:1024
    ds_read_b128 v[16:19], v4 offset:0
    ds_read_b128 v[20:23], v4 offset:4096
    ds_read_b64_tr_b16 v[36:37], v13 offset:0
    ds_read_b64_tr_b16 v[38:39], v13 offset:1024
    s_waitcnt lgkmcnt(0)
    v_mfma_f32_32x32x16_bf16 v[48:63], v[32:35], v[16:19], 0
    ds_read_b64_tr_b16 v[40:41], v12 offset:4096
    ds_read_b64_tr_b16 v[42:43], v12 offset:5120
    ds_read_b128 v[24:27], v5 offset:0
    v_mfma_f32_32x32x16_bf16 v[64:79], v[32:35], v[20:23], 0
    ds_read_b128 v[28:31], v5 offset:4096
    ds_read_b64_tr_b16 v[44:45], v13 offset:4096
    ds_read_b64_tr_b16 v[46:47], v13 offset:5120
    v_mfma_f32_32x32x16_bf16 v[80:95], v[36:39], v[16:19], 0
    v_mfma_f32_32x32x16_bf16 v[96:111], v[36:39], v[20:23], 0
    s_waitcnt lgkmcnt(0)
    v_mfma_f32_32x32x16_bf16 v[48:63], v[40:43], v[24:27], v[48:63]
    ds_read_b64_tr_b16 v[32:33], v12 offset:8192
    ds_read_b64_tr_b16 v[34:35], v12 offset:9216
    ds_read_b128 v[16:19], v6 offset:0
    v_mfma_f32_32x32x16_bf16 v[64:79], v[40:43], v[28:31], v[64:79]
    ds_read_b128 v[20:23], v6 offset:4096
    ds_read_b64_tr_b16 v[36:37], v13 offset:8192
    ds_read_b64_tr_b16 v[38:39], v13 offset:9216
    v_mfma_f32_32x32x16_bf16 v[80:95], v[44:47], v[24:27], v[80:95]
    v_mfma_f32_32x32x16_bf16 v[96:111], v[44:47], v[28:31], v[96:111]
    s_waitcnt lgkmcnt(0)
    v_mfma_f32_32x32x16_bf16 v[48:63], v[32:35], v[16:19], v[48:63]
    ds_read_b64_tr_b16 v[40:41], v12 offset:12288
    ds_read_b64_tr_b16 v[42:43], v12 offset:13312
    ds_read_b128 v[24:27], v7 offset:0
    v_mfma_f32_32x32x16_bf16 v[64:79], v[32:35], v[20:23], v[64:79]
    ds_read_b128 v[28:31], v7 offset:4096
    ds_read_b64_tr_b16 v[44:45], v13 offset:12288
    ds_read_b64_tr_b16 v[46:47], v13 offset:13312
    v_mfma_f32_32x32x16_bf16 v[80:95], v[36:39], v[16:19], v[80:95]
    v_mfma_f32_32x32x16_bf16 v[96:111], v[36:39], v[20:23], v[96:111]
    s_waitcnt lgkmcnt(0)
    v_mfma_f32_32x32x16_bf16 v[48:63], v[40:43], v[24:27], v[48:63]
    s_barrier
    ds_read_b64_tr_b16 v[32:33], v12 offset:32768
    ds_read_b64_tr_b16 v[34:35], v12 offset:33792
    ds_read_b128 v[16:19], v4 offset:32768
    v_mfma_f32_32x32x16_bf16 v[64:79], v[40:43], v[28:31], v[64:79]
    ds_read_b128 v[20:23], v4 offset:36864
    ds_read_b64_tr_b16 v[36:37], v13 offset:32768
    ds_read_b64_tr_b16 v[38:39], v13 offset:33792
    v_mfma_f32_32x32x16_bf16 v[80:95], v[44:47], v[24:27], v[80:95]
    v_mfma_f32_32x32x16_bf16 v[96:111], v[44:47], v[28:31], v[96:111]
    s_waitcnt lgkmcnt(0)
    v_mfma_f32_32x32x16_bf16 v[48:63], v[32:35], v[16:19], v[48:63]
    ds_read_b64_tr_b16 v[40:41], v12 offset:36864
    ds_read_b64_tr_b16 v[42:43], v12 offset:37888
    ds_read_b128 v[24:27], v5 offset:32768
    v_mfma_f32_32x32x16_bf16 v[64:79], v[32:35], v[20:23], v[64:79]
    ds_read_b128 v[28:31], v5 offset:36864
    ds_read_b64_tr_b16 v[44:45], v13 offset:36864
    ds_read_b64_tr_b16 v[46:47], v13 offset:37888
    v_mfma_f32_32x32x16_bf16 v[80:95], v[36:39], v[16:19], v[80:95]
    v_mfma_f32_32x32x16_bf16 v[96:111], v[36:39], v[20:23], v[96:111]
    s_waitcnt lgkmcnt(0)
    v_mfma_f32_32x32x16_bf16 v[48:63], v[40:43], v[24:27], v[48:63]
    ds_read_b64_tr_b16 v[32:33], v12 offset:40960
    ds_read_b64_tr_b16 v[34:35], v12 offset:41984
    ds_read_b128 v[16:19], v6 offset:32768
    v_mfma_f32_32x32x16_bf16 v[64:79], v[40:43], v[28:31], v[64:79]
    ds_read_b128 v[20:23], v6 offset:36864
    ds_read_b64_tr_b16 v[36:37], v13 offset:40960
    ds_read_b64_tr_b16 v[38:39], v13 offset:41984
    v_mfma_f32_32x32x16_bf16 v[80:95], v[44:47], v[24:27], v[80:95]
    v_mfma_f32_32x32x16_bf16 v[96:111], v[44:47], v[28:31], v[96:111]
    s_waitcnt lgkmcnt(0)
    v_mfma_f32_32x32x16_bf16 v[48:63], v[32:35], v[16:19], v[48:63]
    ds_read_b64_tr_b16 v[40:41], v12 offset:45056
    ds_read_b64_tr_b16 v[42:43], v12 offset:46080
    ds_read_b128 v[24:27], v7 offset:32768
    v_mfma_f32_32x32x16_bf16 v[64:79], v[32:35], v[20:23], v[64:79]
    ds_read_b128 v[28:31], v7 offset:36864
    ds_read_b64_tr_b16 v[44:45], v13 offset:45056
    ds_read_b64_tr_b16 v[46:47], v13 offset:46080
    v_mfma_f32_32x32x16_bf16 v[80:95], v[36:39], v[16:19], v[80:95]
    v_mfma_f32_32x32x16_bf16 v[96:111], v[36:39], v[20:23], v[96:111]
    s_waitcnt lgkmcnt(0)
    v_mfma_f32_32x32x16_bf16 v[48:63], v[40:43], v[24:27], v[48:63]
    s_barrier
    ds_read_b64_tr_b16 v[32:33], v14 offset:0
    ds_read_b64_tr_b16 v[34:35], v14 offset:1024
    ds_read_b128 v[16:19], v8 offset:0
    v_mfma_f32_32x32x16_bf16 v[64:79], v[40:43], v[28:31], v[64:79]
    ds_read_b128 v[20:23], v8 offset:4096
    ds_read_b64_tr_b16 v[36:37], v15 offset:0
    ds_read_b64_tr_b16 v[38:39], v15 offset:1024
    v_mfma_f32_32x32x16_bf16 v[80:95], v[44:47], v[24:27], v[80:95]
    v_mfma_f32_32x32x16_bf16 v[96:111], v[44:47], v[28:31], v[96:111]
    s_waitcnt lgkmcnt(0)
    v_mfma_f32_32x32x16_bf16 v[48:63], v[32:35], v[16:19], v[48:63]
    ds_read_b64_tr_b16 v[40:41], v14 offset:4096
    ds_read_b64_tr_b16 v[42:43], v14 offset:5120
    ds_read_b128 v[24:27], v9 offset:0
    v_mfma_f32_32x32x16_bf16 v[64:79], v[32:35], v[20:23], v[64:79]
    ds_read_b128 v[28:31], v9 offset:4096
    ds_read_b64_tr_b16 v[44:45], v15 offset:4096
    ds_read_b64_tr_b16 v[46:47], v15 offset:5120
    v_mfma_f32_32x32x16_bf16 v[80:95], v[36:39], v[16:19], v[80:95]
    v_mfma_f32_32x32x16_bf16 v[96:111], v[36:39], v[20:23], v[96:111]
    s_waitcnt lgkmcnt(0)
    v_mfma_f32_32x32x16_bf16 v[48:63], v[40:43], v[24:27], v[48:63]
    ds_read_b64_tr_b16 v[32:33], v14 offset:8192
    ds_read_b64_tr_b16 v[34:35], v14 offset:9216
    ds_read_b128 v[16:19], v10 offset:0
    v_mfma_f32_32x32x16_bf16 v[64:79], v[40:43], v[28:31], v[64:79]
    ds_read_b128 v[20:23], v10 offset:4096
    ds_read_b64_tr_b16 v[36:37], v15 offset:8192
    ds_read_b64_tr_b16 v[38:39], v15 offset:9216
    v_mfma_f32_32x32x16_bf16 v[80:95], v[44:47], v[24:27], v[80:95]
    v_mfma_f32_32x32x16_bf16 v[96:111], v[44:47], v[28:31], v[96:111]
    s_waitcnt lgkmcnt(0)
    v_mfma_f32_32x32x16_bf16 v[48:63], v[32:35], v[16:19], v[48:63]
    ds_read_b64_tr_b16 v[40:41], v14 offset:12288
    ds_read_b64_tr_b16 v[42:43], v14 offset:13312
    ds_read_b128 v[24:27], v11 offset:0
    v_mfma_f32_32x32x16_bf16 v[64:79], v[32:35], v[20:23], v[64:79]
    ds_read_b128 v[28:31], v11 offset:4096
    ds_read_b64_tr_b16 v[44:45], v15 offset:12288
    ds_read_b64_tr_b16 v[46:47], v15 offset:13312
    v_mfma_f32_32x32x16_bf16 v[80:95], v[36:39], v[16:19], v[80:95]
    v_mfma_f32_32x32x16_bf16 v[96:111], v[36:39], v[20:23], v[96:111]
    s_waitcnt lgkmcnt(0)
    v_mfma_f32_32x32x16_bf16 v[48:63], v[40:43], v[24:27], v[48:63]
    s_barrier
    ds_read_b64_tr_b16 v[32:33], v14 offset:32768
    ds_read_b64_tr_b16 v[34:35], v14 offset:33792
    ds_read_b128 v[16:19], v8 offset:32768
    v_mfma_f32_32x32x16_bf16 v[64:79], v[40:43], v[28:31], v[64:79]
    ds_read_b128 v[20:23], v8 offset:36864
    ds_read_b64_tr_b16 v[36:37], v15 offset:32768
    ds_read_b64_tr_b16 v[38:39], v15 offset:33792
    v_mfma_f32_32x32x16_bf16 v[80:95], v[44:47], v[24:27], v[80:95]
    v_mfma_f32_32x32x16_bf16 v[96:111], v[44:47], v[28:31], v[96:111]
    s_waitcnt lgkmcnt(0)
    v_mfma_f32_32x32x16_bf16 v[48:63], v[32:35], v[16:19], v[48:63]
    ds_read_b64_tr_b16 v[40:41], v14 offset:36864
    ds_read_b64_tr_b16 v[42:43], v14 offset:37888
    ds_read_b128 v[24:27], v9 offset:32768
    v_mfma_f32_32x32x16_bf16 v[64:79], v[32:35], v[20:23], v[64:79]
    ds_read_b128 v[28:31], v9 offset:36864
    ds_read_b64_tr_b16 v[44:45], v15 offset:36864
    ds_read_b64_tr_b16 v[46:47], v15 offset:37888
    v_mfma_f32_32x32x16_bf16 v[80:95], v[36:39], v[16:19], v[80:95]
    v_mfma_f32_32x32x16_bf16 v[96:111], v[36:39], v[20:23], v[96:111]
    s_waitcnt lgkmcnt(0)
    v_mfma_f32_32x32x16_bf16 v[48:63], v[40:43], v[24:27], v[48:63]
    ds_read_b64_tr_b16 v[32:33], v14 offset:40960
    ds_read_b64_tr_b16 v[34:35], v14 offset:41984
    ds_read_b128 v[16:19], v10 offset:32768
    v_mfma_f32_32x32x16_bf16 v[64:79], v[40:43], v[28:31], v[64:79]
    ds_read_b128 v[20:23], v10 offset:36864
    ds_read_b64_tr_b16 v[36:37], v15 offset:40960
    ds_read_b64_tr_b16 v[38:39], v15 offset:41984
    v_mfma_f32_32x32x16_bf16 v[80:95], v[44:47], v[24:27], v[80:95]
    v_mfma_f32_32x32x16_bf16 v[96:111], v[44:47], v[28:31], v[96:111]
    s_waitcnt lgkmcnt(0)
    v_mfma_f32_32x32x16_bf16 v[48:63], v[32:35], v[16:19], v[48:63]
    ds_read_b64_tr_b16 v[40:41], v14 offset:45056
    ds_read_b64_tr_b16 v[42:43], v14 offset:46080
    ds_read_b128 v[24:27], v11 offset:32768
    v_mfma_f32_32x32x16_bf16 v[64:79], v[32:35], v[20:23], v[64:79]
    ds_read_b128 v[28:31], v11 offset:36864
    ds_read_b64_tr_b16 v[44:45], v15 offset:45056
    ds_read_b64_tr_b16 v[46:47], v15 offset:46080
    v_mfma_f32_32x32x16_bf16 v[80:95], v[36:39], v[16:19], v[80:95]
    v_mfma_f32_32x32x16_bf16 v[96:111], v[36:39], v[20:23], v[96:111]
    s_waitcnt lgkmcnt(0)
    v_mfma_f32_32x32x16_bf16 v[48:63], v[40:43], v[24:27], v[48:63]
    s_barrier
    ds_read_b64_tr_b16 v[32:33], v12 offset:0
    ds_read_b64_tr_b16 v[34:35], v12 offset:1024
    ds_read_b128 v[16:19], v4 offset:0
    v_mfma_f32_32x32x16_bf16 v[64:79], v[40:43], v[28:31], v[64:79]
    ds_read_b128 v[20:23], v4 offset:4096
    ds_read_b64_tr_b16 v[36:37], v13 offset:0
    ds_read_b64_tr_b16 v[38:39], v13 offset:1024
    v_mfma_f32_32x32x16_bf16 v[80:95], v[44:47], v[24:27], v[80:95]
    v_mfma_f32_32x32x16_bf16 v[96:111], v[44:47], v[28:31], v[96:111]
    s_waitcnt lgkmcnt(0)
    v_mfma_f32_32x32x16_bf16 v[48:63], v[32:35], v[16:19], v[48:63]
    ds_read_b64_tr_b16 v[40:41], v12 offset:4096
    ds_read_b64_tr_b16 v[42:43], v12 offset:5120
    ds_read_b128 v[24:27], v5 offset:0
    v_mfma_f32_32x32x16_bf16 v[64:79], v[32:35], v[20:23], v[64:79]
    ds_read_b128 v[28:31], v5 offset:4096
    ds_read_b64_tr_b16 v[44:45], v13 offset:4096
    ds_read_b64_tr_b16 v[46:47], v13 offset:5120
    v_mfma_f32_32x32x16_bf16 v[80:95], v[36:39], v[16:19], v[80:95]
    v_mfma_f32_32x32x16_bf16 v[96:111], v[36:39], v[20:23], v[96:111]
    s_waitcnt lgkmcnt(0)
    v_mfma_f32_32x32x16_bf16 v[48:63], v[40:43], v[24:27], v[48:63]
    ds_read_b64_tr_b16 v[32:33], v12 offset:8192
    ds_read_b64_tr_b16 v[34:35], v12 offset:9216
    ds_read_b128 v[16:19], v6 offset:0
    v_mfma_f32_32x32x16_bf16 v[64:79], v[40:43], v[28:31], v[64:79]
    ds_read_b128 v[20:23], v6 offset:4096
    ds_read_b64_tr_b16 v[36:37], v13 offset:8192
    ds_read_b64_tr_b16 v[38:39], v13 offset:9216
    v_mfma_f32_32x32x16_bf16 v[80:95], v[44:47], v[24:27], v[80:95]
    v_mfma_f32_32x32x16_bf16 v[96:111], v[44:47], v[28:31], v[96:111]
    s_waitcnt lgkmcnt(0)
    v_mfma_f32_32x32x16_bf16 v[48:63], v[32:35], v[16:19], v[48:63]
    ds_read_b64_tr_b16 v[40:41], v12 offset:12288
    ds_read_b64_tr_b16 v[42:43], v12 offset:13312
    ds_read_b128 v[24:27], v7 offset:0
    v_mfma_f32_32x32x16_bf16 v[64:79], v[32:35], v[20:23], v[64:79]
    ds_read_b128 v[28:31], v7 offset:4096
    ds_read_b64_tr_b16 v[44:45], v13 offset:12288
    ds_read_b64_tr_b16 v[46:47], v13 offset:13312
    v_mfma_f32_32x32x16_bf16 v[80:95], v[36:39], v[16:19], v[80:95]
    v_mfma_f32_32x32x16_bf16 v[96:111], v[36:39], v[20:23], v[96:111]
    s_waitcnt lgkmcnt(0)
    v_mfma_f32_32x32x16_bf16 v[48:63], v[40:43], v[24:27], v[48:63]
    s_barrier
    ds_read_b64_tr_b16 v[32:33], v12 offset:32768
    ds_read_b64_tr_b16 v[34:35], v12 offset:33792
    ds_read_b128 v[16:19], v4 offset:32768
    v_mfma_f32_32x32x16_bf16 v[64:79], v[40:43], v[28:31], v[64:79]
    ds_read_b128 v[20:23], v4 offset:36864
    ds_read_b64_tr_b16 v[36:37], v13 offset:32768
    ds_read_b64_tr_b16 v[38:39], v13 offset:33792
    v_mfma_f32_32x32x16_bf16 v[80:95], v[44:47], v[24:27], v[80:95]
    v_mfma_f32_32x32x16_bf16 v[96:111], v[44:47], v[28:31], v[96:111]
    s_waitcnt lgkmcnt(0)
    v_mfma_f32_32x32x16_bf16 v[48:63], v[32:35], v[16:19], v[48:63]
    ds_read_b64_tr_b16 v[40:41], v12 offset:36864
    ds_read_b64_tr_b16 v[42:43], v12 offset:37888
    ds_read_b128 v[24:27], v5 offset:32768
    v_mfma_f32_32x32x16_bf16 v[64:79], v[32:35], v[20:23], v[64:79]
    ds_read_b128 v[28:31], v5 offset:36864
    ds_read_b64_tr_b16 v[44:45], v13 offset:36864
    ds_read_b64_tr_b16 v[46:47], v13 offset:37888
    v_mfma_f32_32x32x16_bf16 v[80:95], v[36:39], v[16:19], v[80:95]
    v_mfma_f32_32x32x16_bf16 v[96:111], v[36:39], v[20:23], v[96:111]
    s_waitcnt lgkmcnt(0)
    v_mfma_f32_32x32x16_bf16 v[48:63], v[40:43], v[24:27], v[48:63]
    ds_read_b64_tr_b16 v[32:33], v12 offset:40960
    ds_read_b64_tr_b16 v[34:35], v12 offset:41984
    ds_read_b128 v[16:19], v6 offset:32768
    v_mfma_f32_32x32x16_bf16 v[64:79], v[40:43], v[28:31], v[64:79]
    ds_read_b128 v[20:23], v6 offset:36864
    ds_read_b64_tr_b16 v[36:37], v13 offset:40960
    ds_read_b64_tr_b16 v[38:39], v13 offset:41984
    v_mfma_f32_32x32x16_bf16 v[80:95], v[44:47], v[24:27], v[80:95]
    v_mfma_f32_32x32x16_bf16 v[96:111], v[44:47], v[28:31], v[96:111]
    s_waitcnt lgkmcnt(0)
    v_mfma_f32_32x32x16_bf16 v[48:63], v[32:35], v[16:19], v[48:63]
    ds_read_b64_tr_b16 v[40:41], v12 offset:45056
    ds_read_b64_tr_b16 v[42:43], v12 offset:46080
    ds_read_b128 v[24:27], v7 offset:32768
    v_mfma_f32_32x32x16_bf16 v[64:79], v[32:35], v[20:23], v[64:79]
    ds_read_b128 v[28:31], v7 offset:36864
    ds_read_b64_tr_b16 v[44:45], v13 offset:45056
    ds_read_b64_tr_b16 v[46:47], v13 offset:46080
    v_mfma_f32_32x32x16_bf16 v[80:95], v[36:39], v[16:19], v[80:95]
    v_mfma_f32_32x32x16_bf16 v[96:111], v[36:39], v[20:23], v[96:111]
    s_waitcnt lgkmcnt(0)
    v_mfma_f32_32x32x16_bf16 v[48:63], v[40:43], v[24:27], v[48:63]
    s_barrier
    ds_read_b64_tr_b16 v[32:33], v14 offset:0
    ds_read_b64_tr_b16 v[34:35], v14 offset:1024
    ds_read_b128 v[16:19], v8 offset:0
    v_mfma_f32_32x32x16_bf16 v[64:79], v[40:43], v[28:31], v[64:79]
    ds_read_b128 v[20:23], v8 offset:4096
    ds_read_b64_tr_b16 v[36:37], v15 offset:0
    ds_read_b64_tr_b16 v[38:39], v15 offset:1024
    v_mfma_f32_32x32x16_bf16 v[80:95], v[44:47], v[24:27], v[80:95]
    v_mfma_f32_32x32x16_bf16 v[96:111], v[44:47], v[28:31], v[96:111]
    s_waitcnt lgkmcnt(0)
    v_mfma_f32_32x32x16_bf16 v[48:63], v[32:35], v[16:19], v[48:63]
    ds_read_b64_tr_b16 v[40:41], v14 offset:4096
    ds_read_b64_tr_b16 v[42:43], v14 offset:5120
    ds_read_b128 v[24:27], v9 offset:0
    v_mfma_f32_32x32x16_bf16 v[64:79], v[32:35], v[20:23], v[64:79]
    ds_read_b128 v[28:31], v9 offset:4096
    ds_read_b64_tr_b16 v[44:45], v15 offset:4096
    ds_read_b64_tr_b16 v[46:47], v15 offset:5120
    v_mfma_f32_32x32x16_bf16 v[80:95], v[36:39], v[16:19], v[80:95]
    v_mfma_f32_32x32x16_bf16 v[96:111], v[36:39], v[20:23], v[96:111]
    s_waitcnt lgkmcnt(0)
    v_mfma_f32_32x32x16_bf16 v[48:63], v[40:43], v[24:27], v[48:63]
    ds_read_b64_tr_b16 v[32:33], v14 offset:8192
    ds_read_b64_tr_b16 v[34:35], v14 offset:9216
    ds_read_b128 v[16:19], v10 offset:0
    v_mfma_f32_32x32x16_bf16 v[64:79], v[40:43], v[28:31], v[64:79]
    ds_read_b128 v[20:23], v10 offset:4096
    ds_read_b64_tr_b16 v[36:37], v15 offset:8192
    ds_read_b64_tr_b16 v[38:39], v15 offset:9216
    v_mfma_f32_32x32x16_bf16 v[80:95], v[44:47], v[24:27], v[80:95]
    v_mfma_f32_32x32x16_bf16 v[96:111], v[44:47], v[28:31], v[96:111]
    s_waitcnt lgkmcnt(0)
    v_mfma_f32_32x32x16_bf16 v[48:63], v[32:35], v[16:19], v[48:63]
    ds_read_b64_tr_b16 v[40:41], v14 offset:12288
    ds_read_b64_tr_b16 v[42:43], v14 offset:13312
    ds_read_b128 v[24:27], v11 offset:0
    v_mfma_f32_32x32x16_bf16 v[64:79], v[32:35], v[20:23], v[64:79]
    ds_read_b128 v[28:31], v11 offset:4096
    ds_read_b64_tr_b16 v[44:45], v15 offset:12288
    ds_read_b64_tr_b16 v[46:47], v15 offset:13312
    v_mfma_f32_32x32x16_bf16 v[80:95], v[36:39], v[16:19], v[80:95]
    v_mfma_f32_32x32x16_bf16 v[96:111], v[36:39], v[20:23], v[96:111]
    s_waitcnt lgkmcnt(0)
    v_mfma_f32_32x32x16_bf16 v[48:63], v[40:43], v[24:27], v[48:63]
    s_barrier
    ds_read_b64_tr_b16 v[32:33], v14 offset:32768
    ds_read_b64_tr_b16 v[34:35], v14 offset:33792
    ds_read_b128 v[16:19], v8 offset:32768
    v_mfma_f32_32x32x16_bf16 v[64:79], v[40:43], v[28:31], v[64:79]
    ds_read_b128 v[20:23], v8 offset:36864
    ds_read_b64_tr_b16 v[36:37], v15 offset:32768
    ds_read_b64_tr_b16 v[38:39], v15 offset:33792
    v_mfma_f32_32x32x16_bf16 v[80:95], v[44:47], v[24:27], v[80:95]
    v_mfma_f32_32x32x16_bf16 v[96:111], v[44:47], v[28:31], v[96:111]
    s_waitcnt lgkmcnt(0)
    v_mfma_f32_32x32x16_bf16 v[48:63], v[32:35], v[16:19], v[48:63]
    ds_read_b64_tr_b16 v[40:41], v14 offset:36864
    ds_read_b64_tr_b16 v[42:43], v14 offset:37888
    ds_read_b128 v[24:27], v9 offset:32768
    v_mfma_f32_32x32x16_bf16 v[64:79], v[32:35], v[20:23], v[64:79]
    ds_read_b128 v[28:31], v9 offset:36864
    ds_read_b64_tr_b16 v[44:45], v15 offset:36864
    ds_read_b64_tr_b16 v[46:47], v15 offset:37888
    v_mfma_f32_32x32x16_bf16 v[80:95], v[36:39], v[16:19], v[80:95]
    v_mfma_f32_32x32x16_bf16 v[96:111], v[36:39], v[20:23], v[96:111]
    s_waitcnt lgkmcnt(0)
    v_mfma_f32_32x32x16_bf16 v[48:63], v[40:43], v[24:27], v[48:63]
    ds_read_b64_tr_b16 v[32:33], v14 offset:40960
    ds_read_b64_tr_b16 v[34:35], v14 offset:41984
    ds_read_b128 v[16:19], v10 offset:32768
    v_mfma_f32_32x32x16_bf16 v[64:79], v[40:43], v[28:31], v[64:79]
    ds_read_b128 v[20:23], v10 offset:36864
    ds_read_b64_tr_b16 v[36:37], v15 offset:40960
    ds_read_b64_tr_b16 v[38:39], v15 offset:41984
    v_mfma_f32_32x32x16_bf16 v[80:95], v[44:47], v[24:27], v[80:95]
    v_mfma_f32_32x32x16_bf16 v[96:111], v[44:47], v[28:31], v[96:111]
    s_waitcnt lgkmcnt(0)
    v_mfma_f32_32x32x16_bf16 v[48:63], v[32:35], v[16:19], v[48:63]
    ds_read_b64_tr_b16 v[40:41], v14 offset:45056
    ds_read_b64_tr_b16 v[42:43], v14 offset:46080
    ds_read_b128 v[24:27], v11 offset:32768
    v_mfma_f32_32x32x16_bf16 v[64:79], v[32:35], v[20:23], v[64:79]
    ds_read_b128 v[28:31], v11 offset:36864
    ds_read_b64_tr_b16 v[44:45], v15 offset:45056
    ds_read_b64_tr_b16 v[46:47], v15 offset:46080
    v_mfma_f32_32x32x16_bf16 v[80:95], v[36:39], v[16:19], v[80:95]
    v_mfma_f32_32x32x16_bf16 v[96:111], v[36:39], v[20:23], v[96:111]
    s_waitcnt lgkmcnt(0)
    v_mfma_f32_32x32x16_bf16 v[48:63], v[40:43], v[24:27], v[48:63]
    v_mfma_f32_32x32x16_bf16 v[64:79], v[40:43], v[28:31], v[64:79]
    v_mfma_f32_32x32x16_bf16 v[80:95], v[44:47], v[24:27], v[80:95]
    v_mfma_f32_32x32x16_bf16 v[96:111], v[44:47], v[28:31], v[96:111]
    s_waitcnt vmcnt(0)
    s_and_b32 s40, s35, 3
    s_lshl_b32 s40, s40, 3
    s_lshl_b32 s41, s53, 2
    s_add_u32 s40, s40, s41
    s_lshl_b32 s40, s40, 6
    s_lshl_b32 s41, s34, 2
    s_add_u32 s40, s40, s41
    s_lshl_b32 s41, s52, 1
    s_add_u32 s47, s40, s41
    v_lshlrev_b32 v1, 4, v0
    s_cmp_eq_u32 s37, 0
    s_cbranch_scc0 K1_EPI_K
    s_mov_b32 s16, s28
    s_mov_b32 s17, s29
    s_mov_b32 s18, 0x200000
    s_mov_b32 s19, 0x20000
    s_lshl_b32 s47, s47, 10
    s_mov_b32 s48, 0x3eb8aa3b
    s_mov_b32 s49, 0x3eb8aa3b
    s_nop 3
    v_pk_mul_f32 v[48:49], v[48:49], s[48:49]
    v_pk_mul_f32 v[50:51], v[50:51], s[48:49]
    v_pk_mul_f32 v[52:53], v[52:53], s[48:49]
    v_pk_mul_f32 v[54:55], v[54:55], s[48:49]
    v_cvt_pk_bf16_f32 v112, v48, v49
    v_cvt_pk_bf16_f32 v113, v50, v51
    v_cvt_pk_bf16_f32 v114, v52, v53
    v_cvt_pk_bf16_f32 v115, v54, v55
    s_add_u32 s40, s47, 0
    buffer_store_dwordx4 v[112:115], v1, s[16:19], s40 offen sc1
    v_pk_mul_f32 v[56:57], v[56:57], s[48:49]
    v_pk_mul_f32 v[58:59], v[58:59], s[48:49]
    v_pk_mul_f32 v[60:61], v[60:61], s[48:49]
    v_pk_mul_f32 v[62:63], v[62:63], s[48:49]
    v_cvt_pk_bf16_f32 v120, v56, v57
    v_cvt_pk_bf16_f32 v121, v58, v59
    v_cvt_pk_bf16_f32 v122, v60, v61
    v_cvt_pk_bf16_f32 v123, v62, v63
    s_add_u32 s40, s47, 65536
    buffer_store_dwordx4 v[120:123], v1, s[16:19], s40 offen sc1
    v_pk_mul_f32 v[64:65], v[64:65], s[48:49]
    v_pk_mul_f32 v[66:67], v[66:67], s[48:49]
    v_pk_mul_f32 v[68:69], v[68:69], s[48:49]
    v_pk_mul_f32 v[70:71], v[70:71], s[48:49]
    v_cvt_pk_bf16_f32 v112, v64, v65
    v_cvt_pk_bf16_f32 v113, v66, v67
    v_cvt_pk_bf16_f32 v114, v68, v69
    v_cvt_pk_bf16_f32 v115, v70, v71
    s_add_u32 s40, s47, 1024
    buffer_store_dwordx4 v[112:115], v1, s[16:19], s40 offen sc1
    v_pk_mul_f32 v[72:73], v[72:73], s[48:49]
    v_pk_mul_f32 v[74:75], v[74:75], s[48:49]
    v_pk_mul_f32 v[76:77], v[76:77], s[48:49]
    v_pk_mul_f32 v[78:79], v[78:79], s[48:49]
    v_cvt_pk_bf16_f32 v120, v72, v73
    v_cvt_pk_bf16_f32 v121, v74, v75
    v_cvt_pk_bf16_f32 v122, v76, v77
    v_cvt_pk_bf16_f32 v123, v78, v79
    s_add_u32 s40, s47, 66560
    buffer_store_dwordx4 v[120:123], v1, s[16:19], s40 offen sc1
    v_pk_mul_f32 v[80:81], v[80:81], s[48:49]
    v_pk_mul_f32 v[82:83], v[82:83], s[48:49]
    v_pk_mul_f32 v[84:85], v[84:85], s[48:49]
    v_pk_mul_f32 v[86:87], v[86:87], s[48:49]
    v_cvt_pk_bf16_f32 v112, v80, v81
    v_cvt_pk_bf16_f32 v113, v82, v83
    v_cvt_pk_bf16_f32 v114, v84, v85
    v_cvt_pk_bf16_f32 v115, v86, v87
    s_add_u32 s40, s47, 131072
    buffer_store_dwordx4 v[112:115], v1, s[16:19], s40 offen sc1
    v_pk_mul_f32 v[88:89], v[88:89], s[48:49]
    v_pk_mul_f32 v[90:91], v[90:91], s[48:49]
    v_pk_mul_f32 v[92:93], v[92:93], s[48:49]
    v_pk_mul_f32 v[94:95], v[94:95], s[48:49]
    v_cvt_pk_bf16_f32 v120, v88, v89
    v_cvt_pk_bf16_f32 v121, v90, v91
    v_cvt_pk_bf16_f32 v122, v92, v93
    v_cvt_pk_bf16_f32 v123, v94, v95
    s_add_u32 s40, s47, 196608
    buffer_store_dwordx4 v[120:123], v1, s[16:19], s40 offen sc1
    v_pk_mul_f32 v[96:97], v[96:97], s[48:49]
    v_pk_mul_f32 v[98:99], v[98:99], s[48:49]
    v_pk_mul_f32 v[100:101], v[100:101], s[48:49]
    v_pk_mul_f32 v[102:103], v[102:103], s[48:49]
    v_cvt_pk_bf16_f32 v112, v96, v97
    v_cvt_pk_bf16_f32 v113, v98, v99
    v_cvt_pk_bf16_f32 v114, v100, v101
    v_cvt_pk_bf16_f32 v115, v102, v103
    s_add_u32 s40, s47, 132096
    buffer_store_dwordx4 v[112:115], v1, s[16:19], s40 offen sc1
    v_pk_mul_f32 v[104:105], v[104:105], s[48:49]
    v_pk_mul_f32 v[106:107], v[106:107], s[48:49]
    v_pk_mul_f32 v[108:109], v[108:109], s[48:49]
    v_pk_mul_f32 v[110:111], v[110:111], s[48:49]
    v_cvt_pk_bf16_f32 v120, v104, v105
    v_cvt_pk_bf16_f32 v121, v106, v107
    v_cvt_pk_bf16_f32 v122, v108, v109
    v_cvt_pk_bf16_f32 v123, v110, v111
    s_add_u32 s40, s47, 197632
    buffer_store_dwordx4 v[120:123], v1, s[16:19], s40 offen sc1
    s_endpgm
K1_EPI_K:
    s_add_u32 s16, s28, 0x200000
    s_addc_u32 s17, s29, 0
    s_mov_b32 s18, 0x400000
    s_mov_b32 s19, 0x20000
    s_lshl_b32 s47, s47, 11
    s_nop 3
    v_cvt_pk_bf16_f32 v112, v48, v49
    v_cvt_pk_bf16_f32 v113, v50, v51
    v_cvt_pk_bf16_f32 v114, v52, v53
    v_cvt_pk_bf16_f32 v115, v54, v55
    s_add_u32 s40, s47, 0
    buffer_store_dwordx4 v[112:115], v1, s[16:19], s40 offen sc1
    v_cvt_pk_bf16_f32 v120, v56, v57
    v_cvt_pk_bf16_f32 v121, v58, v59
    v_cvt_pk_bf16_f32 v122, v60, v61
    v_cvt_pk_bf16_f32 v123, v62, v63
    s_add_u32 s40, s47, 131072
    buffer_store_dwordx4 v[120:123], v1, s[16:19], s40 offen sc1
    v_cvt_pk_bf16_f32 v112, v64, v65
    v_cvt_pk_bf16_f32 v113, v66, v67
    v_cvt_pk_bf16_f32 v114, v68, v69
    v_cvt_pk_bf16_f32 v115, v70, v71
    s_add_u32 s40, s47, 2048
    buffer_store_dwordx4 v[112:115], v1, s[16:19], s40 offen sc1
    v_cvt_pk_bf16_f32 v120, v72, v73
    v_cvt_pk_bf16_f32 v121, v74, v75
    v_cvt_pk_bf16_f32 v122, v76, v77
    v_cvt_pk_bf16_f32 v123, v78, v79
    s_add_u32 s40, s47, 133120
    buffer_store_dwordx4 v[120:123], v1, s[16:19], s40 offen sc1
    v_cvt_pk_bf16_f32 v112, v80, v81
    v_cvt_pk_bf16_f32 v113, v82, v83
    v_cvt_pk_bf16_f32 v114, v84, v85
    v_cvt_pk_bf16_f32 v115, v86, v87
    s_add_u32 s40, s47, 262144
    buffer_store_dwordx4 v[112:115], v1, s[16:19], s40 offen sc1
    v_cvt_pk_bf16_f32 v120, v88, v89
    v_cvt_pk_bf16_f32 v121, v90, v91
    v_cvt_pk_bf16_f32 v122, v92, v93
    v_cvt_pk_bf16_f32 v123, v94, v95
    s_add_u32 s40, s47, 393216
    buffer_store_dwordx4 v[120:123], v1, s[16:19], s40 offen sc1
    v_cvt_pk_bf16_f32 v112, v96, v97
    v_cvt_pk_bf16_f32 v113, v98, v99
    v_cvt_pk_bf16_f32 v114, v100, v101
    v_cvt_pk_bf16_f32 v115, v102, v103
    s_add_u32 s40, s47, 264192
    buffer_store_dwordx4 v[112:115], v1, s[16:19], s40 offen sc1
    v_cvt_pk_bf16_f32 v120, v104, v105
    v_cvt_pk_bf16_f32 v121, v106, v107
    v_cvt_pk_bf16_f32 v122, v108, v109
    v_cvt_pk_bf16_f32 v123, v110, v111
    s_add_u32 s40, s47, 395264
    buffer_store_dwordx4 v[120:123], v1, s[16:19], s40 offen sc1
    s_endpgm
K1_VTYPE:
    s_barrier
    ds_read_b64_tr_b16 v[32:33], v12 offset:0
    ds_read_b64_tr_b16 v[34:35], v12 offset:1024
    ds_read_b128 v[16:19], v4 offset:0
    ds_read_b128 v[20:23], v4 offset:4096
    ds_read_b64_tr_b16 v[36:37], v13 offset:0
    ds_read_b64_tr_b16 v[38:39], v13 offset:1024
    s_waitcnt lgkmcnt(0)
    v_mfma_f32_32x32x16_bf16 v[48:63], v[16:19], v[32:35], 0
    ds_read_b64_tr_b16 v[40:41], v12 offset:4096
    ds_read_b64_tr_b16 v[42:43], v12 offset:5120
    ds_read_b128 v[24:27], v5 offset:0
    v_mfma_f32_32x32x16_bf16 v[64:79], v[20:23], v[32:35], 0
    ds_read_b128 v[28:31], v5 offset:4096
    ds_read_b64_tr_b16 v[44:45], v13 offset:4096
    ds_read_b64_tr_b16 v[46:47], v13 offset:5120
    v_mfma_f32_32x32x16_bf16 v[80:95], v[16:19], v[36:39], 0
    v_mfma_f32_32x32x16_bf16 v[96:111], v[20:23], v[36:39], 0
    s_waitcnt lgkmcnt(0)
    v_mfma_f32_32x32x16_bf16 v[48:63], v[24:27], v[40:43], v[48:63]
    ds_read_b64_tr_b16 v[32:33], v12 offset:8192
    ds_read_b64_tr_b16 v[34:35], v12 offset:9216
    ds_read_b128 v[16:19], v6 offset:0
    v_mfma_f32_32x32x16_bf16 v[64:79], v[28:31], v[40:43], v[64:79]
    ds_read_b128 v[20:23], v6 offset:4096
    ds_read_b64_tr_b16 v[36:37], v13 offset:8192
    ds_read_b64_tr_b16 v[38:39], v13 offset:9216
    v_mfma_f32_32x32x16_bf16 v[80:95], v[24:27], v[44:47], v[80:95]
    v_mfma_f32_32x32x16_bf16 v[96:111], v[28:31], v[44:47], v[96:111]
    s_waitcnt lgkmcnt(0)
    v_mfma_f32_32x32x16_bf16 v[48:63], v[16:19], v[32:35], v[48:63]
    ds_read_b64_tr_b16 v[40:41], v12 offset:12288
    ds_read_b64_tr_b16 v[42:43], v12 offset:13312
    ds_read_b128 v[24:27], v7 offset:0
    v_mfma_f32_32x32x16_bf16 v[64:79], v[20:23], v[32:35], v[64:79]
    ds_read_b128 v[28:31], v7 offset:4096
    ds_read_b64_tr_b16 v[44:45], v13 offset:12288
    ds_read_b64_tr_b16 v[46:47], v13 offset:13312
    v_mfma_f32_32x32x16_bf16 v[80:95], v[16:19], v[36:39], v[80:95]
    v_mfma_f32_32x32x16_bf16 v[96:111], v[20:23], v[36:39], v[96:111]
    s_waitcnt lgkmcnt(0)
    v_mfma_f32_32x32x16_bf16 v[48:63], v[24:27], v[40:43], v[48:63]
    s_barrier
    ds_read_b64_tr_b16 v[32:33], v12 offset:32768
    ds_read_b64_tr_b16 v[34:35], v12 offset:33792
    ds_read_b128 v[16:19], v4 offset:32768
    v_mfma_f32_32x32x16_bf16 v[64:79], v[28:31], v[40:43], v[64:79]
    ds_read_b128 v[20:23], v4 offset:36864
    ds_read_b64_tr_b16 v[36:37], v13 offset:32768
    ds_read_b64_tr_b16 v[38:39], v13 offset:33792
    v_mfma_f32_32x32x16_bf16 v[80:95], v[24:27], v[44:47], v[80:95]
    v_mfma_f32_32x32x16_bf16 v[96:111], v[28:31], v[44:47], v[96:111]
    s_waitcnt lgkmcnt(0)
    v_mfma_f32_32x32x16_bf16 v[48:63], v[16:19], v[32:35], v[48:63]
    ds_read_b64_tr_b16 v[40:41], v12 offset:36864
    ds_read_b64_tr_b16 v[42:43], v12 offset:37888
    ds_read_b128 v[24:27], v5 offset:32768
    v_mfma_f32_32x32x16_bf16 v[64:79], v[20:23], v[32:35], v[64:79]
    ds_read_b128 v[28:31], v5 offset:36864
    ds_read_b64_tr_b16 v[44:45], v13 offset:36864
    ds_read_b64_tr_b16 v[46:47], v13 offset:37888
    v_mfma_f32_32x32x16_bf16 v[80:95], v[16:19], v[36:39], v[80:95]
    v_mfma_f32_32x32x16_bf16 v[96:111], v[20:23], v[36:39], v[96:111]
    s_waitcnt lgkmcnt(0)
    v_mfma_f32_32x32x16_bf16 v[48:63], v[24:27], v[40:43], v[48:63]
    ds_read_b64_tr_b16 v[32:33], v12 offset:40960
    ds_read_b64_tr_b16 v[34:35], v12 offset:41984
    ds_read_b128 v[16:19], v6 offset:32768
    v_mfma_f32_32x32x16_bf16 v[64:79], v[28:31], v[40:43], v[64:79]
    ds_read_b128 v[20:23], v6 offset:36864
    ds_read_b64_tr_b16 v[36:37], v13 offset:40960
    ds_read_b64_tr_b16 v[38:39], v13 offset:41984
    v_mfma_f32_32x32x16_bf16 v[80:95], v[24:27], v[44:47], v[80:95]
    v_mfma_f32_32x32x16_bf16 v[96:111], v[28:31], v[44:47], v[96:111]
    s_waitcnt lgkmcnt(0)
    v_mfma_f32_32x32x16_bf16 v[48:63], v[16:19], v[32:35], v[48:63]
    ds_read_b64_tr_b16 v[40:41], v12 offset:45056
    ds_read_b64_tr_b16 v[42:43], v12 offset:46080
    ds_read_b128 v[24:27], v7 offset:32768
    v_mfma_f32_32x32x16_bf16 v[64:79], v[20:23], v[32:35], v[64:79]
    ds_read_b128 v[28:31], v7 offset:36864
    ds_read_b64_tr_b16 v[44:45], v13 offset:45056
    ds_read_b64_tr_b16 v[46:47], v13 offset:46080
    v_mfma_f32_32x32x16_bf16 v[80:95], v[16:19], v[36:39], v[80:95]
    v_mfma_f32_32x32x16_bf16 v[96:111], v[20:23], v[36:39], v[96:111]
    s_waitcnt lgkmcnt(0)
    v_mfma_f32_32x32x16_bf16 v[48:63], v[24:27], v[40:43], v[48:63]
    s_barrier
    ds_read_b64_tr_b16 v[32:33], v14 offset:0
    ds_read_b64_tr_b16 v[34:35], v14 offset:1024
    ds_read_b128 v[16:19], v8 offset:0
    v_mfma_f32_32x32x16_bf16 v[64:79], v[28:31], v[40:43], v[64:79]
    ds_read_b128 v[20:23], v8 offset:4096
    ds_read_b64_tr_b16 v[36:37], v15 offset:0
    ds_read_b64_tr_b16 v[38:39], v15 offset:1024
    v_mfma_f32_32x32x16_bf16 v[80:95], v[24:27], v[44:47], v[80:95]
    v_mfma_f32_32x32x16_bf16 v[96:111], v[28:31], v[44:47], v[96:111]
    s_waitcnt lgkmcnt(0)
    v_mfma_f32_32x32x16_bf16 v[48:63], v[16:19], v[32:35], v[48:63]
    ds_read_b64_tr_b16 v[40:41], v14 offset:4096
    ds_read_b64_tr_b16 v[42:43], v14 offset:5120
    ds_read_b128 v[24:27], v9 offset:0
    v_mfma_f32_32x32x16_bf16 v[64:79], v[20:23], v[32:35], v[64:79]
    ds_read_b128 v[28:31], v9 offset:4096
    ds_read_b64_tr_b16 v[44:45], v15 offset:4096
    ds_read_b64_tr_b16 v[46:47], v15 offset:5120
    v_mfma_f32_32x32x16_bf16 v[80:95], v[16:19], v[36:39], v[80:95]
    v_mfma_f32_32x32x16_bf16 v[96:111], v[20:23], v[36:39], v[96:111]
    s_waitcnt lgkmcnt(0)
    v_mfma_f32_32x32x16_bf16 v[48:63], v[24:27], v[40:43], v[48:63]
    ds_read_b64_tr_b16 v[32:33], v14 offset:8192
    ds_read_b64_tr_b16 v[34:35], v14 offset:9216
    ds_read_b128 v[16:19], v10 offset:0
    v_mfma_f32_32x32x16_bf16 v[64:79], v[28:31], v[40:43], v[64:79]
    ds_read_b128 v[20:23], v10 offset:4096
    ds_read_b64_tr_b16 v[36:37], v15 offset:8192
    ds_read_b64_tr_b16 v[38:39], v15 offset:9216
    v_mfma_f32_32x32x16_bf16 v[80:95], v[24:27], v[44:47], v[80:95]
    v_mfma_f32_32x32x16_bf16 v[96:111], v[28:31], v[44:47], v[96:111]
    s_waitcnt lgkmcnt(0)
    v_mfma_f32_32x32x16_bf16 v[48:63], v[16:19], v[32:35], v[48:63]
    ds_read_b64_tr_b16 v[40:41], v14 offset:12288
    ds_read_b64_tr_b16 v[42:43], v14 offset:13312
    ds_read_b128 v[24:27], v11 offset:0
    v_mfma_f32_32x32x16_bf16 v[64:79], v[20:23], v[32:35], v[64:79]
    ds_read_b128 v[28:31], v11 offset:4096
    ds_read_b64_tr_b16 v[44:45], v15 offset:12288
    ds_read_b64_tr_b16 v[46:47], v15 offset:13312
    v_mfma_f32_32x32x16_bf16 v[80:95], v[16:19], v[36:39], v[80:95]
    v_mfma_f32_32x32x16_bf16 v[96:111], v[20:23], v[36:39], v[96:111]
    s_waitcnt lgkmcnt(0)
    v_mfma_f32_32x32x16_bf16 v[48:63], v[24:27], v[40:43], v[48:63]
    s_barrier
    ds_read_b64_tr_b16 v[32:33], v14 offset:32768
    ds_read_b64_tr_b16 v[34:35], v14 offset:33792
    ds_read_b128 v[16:19], v8 offset:32768
    v_mfma_f32_32x32x16_bf16 v[64:79], v[28:31], v[40:43], v[64:79]
    ds_read_b128 v[20:23], v8 offset:36864
    ds_read_b64_tr_b16 v[36:37], v15 offset:32768
    ds_read_b64_tr_b16 v[38:39], v15 offset:33792
    v_mfma_f32_32x32x16_bf16 v[80:95], v[24:27], v[44:47], v[80:95]
    v_mfma_f32_32x32x16_bf16 v[96:111], v[28:31], v[44:47], v[96:111]
    s_waitcnt lgkmcnt(0)
    v_mfma_f32_32x32x16_bf16 v[48:63], v[16:19], v[32:35], v[48:63]
    ds_read_b64_tr_b16 v[40:41], v14 offset:36864
    ds_read_b64_tr_b16 v[42:43], v14 offset:37888
    ds_read_b128 v[24:27], v9 offset:32768
    v_mfma_f32_32x32x16_bf16 v[64:79], v[20:23], v[32:35], v[64:79]
    ds_read_b128 v[28:31], v9 offset:36864
    ds_read_b64_tr_b16 v[44:45], v15 offset:36864
    ds_read_b64_tr_b16 v[46:47], v15 offset:37888
    v_mfma_f32_32x32x16_bf16 v[80:95], v[16:19], v[36:39], v[80:95]
    v_mfma_f32_32x32x16_bf16 v[96:111], v[20:23], v[36:39], v[96:111]
    s_waitcnt lgkmcnt(0)
    v_mfma_f32_32x32x16_bf16 v[48:63], v[24:27], v[40:43], v[48:63]
    ds_read_b64_tr_b16 v[32:33], v14 offset:40960
    ds_read_b64_tr_b16 v[34:35], v14 offset:41984
    ds_read_b128 v[16:19], v10 offset:32768
    v_mfma_f32_32x32x16_bf16 v[64:79], v[28:31], v[40:43], v[64:79]
    ds_read_b128 v[20:23], v10 offset:36864
    ds_read_b64_tr_b16 v[36:37], v15 offset:40960
    ds_read_b64_tr_b16 v[38:39], v15 offset:41984
    v_mfma_f32_32x32x16_bf16 v[80:95], v[24:27], v[44:47], v[80:95]
    v_mfma_f32_32x32x16_bf16 v[96:111], v[28:31], v[44:47], v[96:111]
    s_waitcnt lgkmcnt(0)
    v_mfma_f32_32x32x16_bf16 v[48:63], v[16:19], v[32:35], v[48:63]
    ds_read_b64_tr_b16 v[40:41], v14 offset:45056
    ds_read_b64_tr_b16 v[42:43], v14 offset:46080
    ds_read_b128 v[24:27], v11 offset:32768
    v_mfma_f32_32x32x16_bf16 v[64:79], v[20:23], v[32:35], v[64:79]
    ds_read_b128 v[28:31], v11 offset:36864
    ds_read_b64_tr_b16 v[44:45], v15 offset:45056
    ds_read_b64_tr_b16 v[46:47], v15 offset:46080
    v_mfma_f32_32x32x16_bf16 v[80:95], v[16:19], v[36:39], v[80:95]
    v_mfma_f32_32x32x16_bf16 v[96:111], v[20:23], v[36:39], v[96:111]
    s_waitcnt lgkmcnt(0)
    v_mfma_f32_32x32x16_bf16 v[48:63], v[24:27], v[40:43], v[48:63]
    s_barrier
    ds_read_b64_tr_b16 v[32:33], v12 offset:0
    ds_read_b64_tr_b16 v[34:35], v12 offset:1024
    ds_read_b128 v[16:19], v4 offset:0
    v_mfma_f32_32x32x16_bf16 v[64:79], v[28:31], v[40:43], v[64:79]
    ds_read_b128 v[20:23], v4 offset:4096
    ds_read_b64_tr_b16 v[36:37], v13 offset:0
    ds_read_b64_tr_b16 v[38:39], v13 offset:1024
    v_mfma_f32_32x32x16_bf16 v[80:95], v[24:27], v[44:47], v[80:95]
    v_mfma_f32_32x32x16_bf16 v[96:111], v[28:31], v[44:47], v[96:111]
    s_waitcnt lgkmcnt(0)
    v_mfma_f32_32x32x16_bf16 v[48:63], v[16:19], v[32:35], v[48:63]
    ds_read_b64_tr_b16 v[40:41], v12 offset:4096
    ds_read_b64_tr_b16 v[42:43], v12 offset:5120
    ds_read_b128 v[24:27], v5 offset:0
    v_mfma_f32_32x32x16_bf16 v[64:79], v[20:23], v[32:35], v[64:79]
    ds_read_b128 v[28:31], v5 offset:4096
    ds_read_b64_tr_b16 v[44:45], v13 offset:4096
    ds_read_b64_tr_b16 v[46:47], v13 offset:5120
    v_mfma_f32_32x32x16_bf16 v[80:95], v[16:19], v[36:39], v[80:95]
    v_mfma_f32_32x32x16_bf16 v[96:111], v[20:23], v[36:39], v[96:111]
    s_waitcnt lgkmcnt(0)
    v_mfma_f32_32x32x16_bf16 v[48:63], v[24:27], v[40:43], v[48:63]
    ds_read_b64_tr_b16 v[32:33], v12 offset:8192
    ds_read_b64_tr_b16 v[34:35], v12 offset:9216
    ds_read_b128 v[16:19], v6 offset:0
    v_mfma_f32_32x32x16_bf16 v[64:79], v[28:31], v[40:43], v[64:79]
    ds_read_b128 v[20:23], v6 offset:4096
    ds_read_b64_tr_b16 v[36:37], v13 offset:8192
    ds_read_b64_tr_b16 v[38:39], v13 offset:9216
    v_mfma_f32_32x32x16_bf16 v[80:95], v[24:27], v[44:47], v[80:95]
    v_mfma_f32_32x32x16_bf16 v[96:111], v[28:31], v[44:47], v[96:111]
    s_waitcnt lgkmcnt(0)
    v_mfma_f32_32x32x16_bf16 v[48:63], v[16:19], v[32:35], v[48:63]
    ds_read_b64_tr_b16 v[40:41], v12 offset:12288
    ds_read_b64_tr_b16 v[42:43], v12 offset:13312
    ds_read_b128 v[24:27], v7 offset:0
    v_mfma_f32_32x32x16_bf16 v[64:79], v[20:23], v[32:35], v[64:79]
    ds_read_b128 v[28:31], v7 offset:4096
    ds_read_b64_tr_b16 v[44:45], v13 offset:12288
    ds_read_b64_tr_b16 v[46:47], v13 offset:13312
    v_mfma_f32_32x32x16_bf16 v[80:95], v[16:19], v[36:39], v[80:95]
    v_mfma_f32_32x32x16_bf16 v[96:111], v[20:23], v[36:39], v[96:111]
    s_waitcnt lgkmcnt(0)
    v_mfma_f32_32x32x16_bf16 v[48:63], v[24:27], v[40:43], v[48:63]
    s_barrier
    ds_read_b64_tr_b16 v[32:33], v12 offset:32768
    ds_read_b64_tr_b16 v[34:35], v12 offset:33792
    ds_read_b128 v[16:19], v4 offset:32768
    v_mfma_f32_32x32x16_bf16 v[64:79], v[28:31], v[40:43], v[64:79]
    ds_read_b128 v[20:23], v4 offset:36864
    ds_read_b64_tr_b16 v[36:37], v13 offset:32768
    ds_read_b64_tr_b16 v[38:39], v13 offset:33792
    v_mfma_f32_32x32x16_bf16 v[80:95], v[24:27], v[44:47], v[80:95]
    v_mfma_f32_32x32x16_bf16 v[96:111], v[28:31], v[44:47], v[96:111]
    s_waitcnt lgkmcnt(0)
    v_mfma_f32_32x32x16_bf16 v[48:63], v[16:19], v[32:35], v[48:63]
    ds_read_b64_tr_b16 v[40:41], v12 offset:36864
    ds_read_b64_tr_b16 v[42:43], v12 offset:37888
    ds_read_b128 v[24:27], v5 offset:32768
    v_mfma_f32_32x32x16_bf16 v[64:79], v[20:23], v[32:35], v[64:79]
    ds_read_b128 v[28:31], v5 offset:36864
    ds_read_b64_tr_b16 v[44:45], v13 offset:36864
    ds_read_b64_tr_b16 v[46:47], v13 offset:37888
    v_mfma_f32_32x32x16_bf16 v[80:95], v[16:19], v[36:39], v[80:95]
    v_mfma_f32_32x32x16_bf16 v[96:111], v[20:23], v[36:39], v[96:111]
    s_waitcnt lgkmcnt(0)
    v_mfma_f32_32x32x16_bf16 v[48:63], v[24:27], v[40:43], v[48:63]
    ds_read_b64_tr_b16 v[32:33], v12 offset:40960
    ds_read_b64_tr_b16 v[34:35], v12 offset:41984
    ds_read_b128 v[16:19], v6 offset:32768
    v_mfma_f32_32x32x16_bf16 v[64:79], v[28:31], v[40:43], v[64:79]
    ds_read_b128 v[20:23], v6 offset:36864
    ds_read_b64_tr_b16 v[36:37], v13 offset:40960
    ds_read_b64_tr_b16 v[38:39], v13 offset:41984
    v_mfma_f32_32x32x16_bf16 v[80:95], v[24:27], v[44:47], v[80:95]
    v_mfma_f32_32x32x16_bf16 v[96:111], v[28:31], v[44:47], v[96:111]
    s_waitcnt lgkmcnt(0)
    v_mfma_f32_32x32x16_bf16 v[48:63], v[16:19], v[32:35], v[48:63]
    ds_read_b64_tr_b16 v[40:41], v12 offset:45056
    ds_read_b64_tr_b16 v[42:43], v12 offset:46080
    ds_read_b128 v[24:27], v7 offset:32768
    v_mfma_f32_32x32x16_bf16 v[64:79], v[20:23], v[32:35], v[64:79]
    ds_read_b128 v[28:31], v7 offset:36864
    ds_read_b64_tr_b16 v[44:45], v13 offset:45056
    ds_read_b64_tr_b16 v[46:47], v13 offset:46080
    v_mfma_f32_32x32x16_bf16 v[80:95], v[16:19], v[36:39], v[80:95]
    v_mfma_f32_32x32x16_bf16 v[96:111], v[20:23], v[36:39], v[96:111]
    s_waitcnt lgkmcnt(0)
    v_mfma_f32_32x32x16_bf16 v[48:63], v[24:27], v[40:43], v[48:63]
    s_barrier
    ds_read_b64_tr_b16 v[32:33], v14 offset:0
    ds_read_b64_tr_b16 v[34:35], v14 offset:1024
    ds_read_b128 v[16:19], v8 offset:0
    v_mfma_f32_32x32x16_bf16 v[64:79], v[28:31], v[40:43], v[64:79]
    ds_read_b128 v[20:23], v8 offset:4096
    ds_read_b64_tr_b16 v[36:37], v15 offset:0
    ds_read_b64_tr_b16 v[38:39], v15 offset:1024
    v_mfma_f32_32x32x16_bf16 v[80:95], v[24:27], v[44:47], v[80:95]
    v_mfma_f32_32x32x16_bf16 v[96:111], v[28:31], v[44:47], v[96:111]
    s_waitcnt lgkmcnt(0)
    v_mfma_f32_32x32x16_bf16 v[48:63], v[16:19], v[32:35], v[48:63]
    ds_read_b64_tr_b16 v[40:41], v14 offset:4096
    ds_read_b64_tr_b16 v[42:43], v14 offset:5120
    ds_read_b128 v[24:27], v9 offset:0
    v_mfma_f32_32x32x16_bf16 v[64:79], v[20:23], v[32:35], v[64:79]
    ds_read_b128 v[28:31], v9 offset:4096
    ds_read_b64_tr_b16 v[44:45], v15 offset:4096
    ds_read_b64_tr_b16 v[46:47], v15 offset:5120
    v_mfma_f32_32x32x16_bf16 v[80:95], v[16:19], v[36:39], v[80:95]
    v_mfma_f32_32x32x16_bf16 v[96:111], v[20:23], v[36:39], v[96:111]
    s_waitcnt lgkmcnt(0)
    v_mfma_f32_32x32x16_bf16 v[48:63], v[24:27], v[40:43], v[48:63]
    ds_read_b64_tr_b16 v[32:33], v14 offset:8192
    ds_read_b64_tr_b16 v[34:35], v14 offset:9216
    ds_read_b128 v[16:19], v10 offset:0
    v_mfma_f32_32x32x16_bf16 v[64:79], v[28:31], v[40:43], v[64:79]
    ds_read_b128 v[20:23], v10 offset:4096
    ds_read_b64_tr_b16 v[36:37], v15 offset:8192
    ds_read_b64_tr_b16 v[38:39], v15 offset:9216
    v_mfma_f32_32x32x16_bf16 v[80:95], v[24:27], v[44:47], v[80:95]
    v_mfma_f32_32x32x16_bf16 v[96:111], v[28:31], v[44:47], v[96:111]
    s_waitcnt lgkmcnt(0)
    v_mfma_f32_32x32x16_bf16 v[48:63], v[16:19], v[32:35], v[48:63]
    ds_read_b64_tr_b16 v[40:41], v14 offset:12288
    ds_read_b64_tr_b16 v[42:43], v14 offset:13312
    ds_read_b128 v[24:27], v11 offset:0
    v_mfma_f32_32x32x16_bf16 v[64:79], v[20:23], v[32:35], v[64:79]
    ds_read_b128 v[28:31], v11 offset:4096
    ds_read_b64_tr_b16 v[44:45], v15 offset:12288
    ds_read_b64_tr_b16 v[46:47], v15 offset:13312
    v_mfma_f32_32x32x16_bf16 v[80:95], v[16:19], v[36:39], v[80:95]
    v_mfma_f32_32x32x16_bf16 v[96:111], v[20:23], v[36:39], v[96:111]
    s_waitcnt lgkmcnt(0)
    v_mfma_f32_32x32x16_bf16 v[48:63], v[24:27], v[40:43], v[48:63]
    s_barrier
    ds_read_b64_tr_b16 v[32:33], v14 offset:32768
    ds_read_b64_tr_b16 v[34:35], v14 offset:33792
    ds_read_b128 v[16:19], v8 offset:32768
    v_mfma_f32_32x32x16_bf16 v[64:79], v[28:31], v[40:43], v[64:79]
    ds_read_b128 v[20:23], v8 offset:36864
    ds_read_b64_tr_b16 v[36:37], v15 offset:32768
    ds_read_b64_tr_b16 v[38:39], v15 offset:33792
    v_mfma_f32_32x32x16_bf16 v[80:95], v[24:27], v[44:47], v[80:95]
    v_mfma_f32_32x32x16_bf16 v[96:111], v[28:31], v[44:47], v[96:111]
    s_waitcnt lgkmcnt(0)
    v_mfma_f32_32x32x16_bf16 v[48:63], v[16:19], v[32:35], v[48:63]
    ds_read_b64_tr_b16 v[40:41], v14 offset:36864
    ds_read_b64_tr_b16 v[42:43], v14 offset:37888
    ds_read_b128 v[24:27], v9 offset:32768
    v_mfma_f32_32x32x16_bf16 v[64:79], v[20:23], v[32:35], v[64:79]
    ds_read_b128 v[28:31], v9 offset:36864
    ds_read_b64_tr_b16 v[44:45], v15 offset:36864
    ds_read_b64_tr_b16 v[46:47], v15 offset:37888
    v_mfma_f32_32x32x16_bf16 v[80:95], v[16:19], v[36:39], v[80:95]
    v_mfma_f32_32x32x16_bf16 v[96:111], v[20:23], v[36:39], v[96:111]
    s_waitcnt lgkmcnt(0)
    v_mfma_f32_32x32x16_bf16 v[48:63], v[24:27], v[40:43], v[48:63]
    ds_read_b64_tr_b16 v[32:33], v14 offset:40960
    ds_read_b64_tr_b16 v[34:35], v14 offset:41984
    ds_read_b128 v[16:19], v10 offset:32768
    v_mfma_f32_32x32x16_bf16 v[64:79], v[28:31], v[40:43], v[64:79]
    ds_read_b128 v[20:23], v10 offset:36864
    ds_read_b64_tr_b16 v[36:37], v15 offset:40960
    ds_read_b64_tr_b16 v[38:39], v15 offset:41984
    v_mfma_f32_32x32x16_bf16 v[80:95], v[24:27], v[44:47], v[80:95]
    v_mfma_f32_32x32x16_bf16 v[96:111], v[28:31], v[44:47], v[96:111]
    s_waitcnt lgkmcnt(0)
    v_mfma_f32_32x32x16_bf16 v[48:63], v[16:19], v[32:35], v[48:63]
    ds_read_b64_tr_b16 v[40:41], v14 offset:45056
    ds_read_b64_tr_b16 v[42:43], v14 offset:46080
    ds_read_b128 v[24:27], v11 offset:32768
    v_mfma_f32_32x32x16_bf16 v[64:79], v[20:23], v[32:35], v[64:79]
    ds_read_b128 v[28:31], v11 offset:36864
    ds_read_b64_tr_b16 v[44:45], v15 offset:45056
    ds_read_b64_tr_b16 v[46:47], v15 offset:46080
    v_mfma_f32_32x32x16_bf16 v[80:95], v[16:19], v[36:39], v[80:95]
    v_mfma_f32_32x32x16_bf16 v[96:111], v[20:23], v[36:39], v[96:111]
    s_waitcnt lgkmcnt(0)
    v_mfma_f32_32x32x16_bf16 v[48:63], v[24:27], v[40:43], v[48:63]
    v_mfma_f32_32x32x16_bf16 v[64:79], v[28:31], v[40:43], v[64:79]
    v_mfma_f32_32x32x16_bf16 v[80:95], v[24:27], v[44:47], v[80:95]
    v_mfma_f32_32x32x16_bf16 v[96:111], v[28:31], v[44:47], v[96:111]
    s_waitcnt vmcnt(0)
    s_add_u32 s16, s28, 0x200000
    s_addc_u32 s17, s29, 0
    s_mov_b32 s18, 0x400000
    s_mov_b32 s19, 0x20000
    s_and_b32 s40, s35, 3
    s_lshl_b32 s40, s40, 3
    s_lshl_b32 s41, s53, 2
    s_add_u32 s40, s40, s41
    s_lshl_b32 s40, s40, 6
    s_lshl_b32 s41, s34, 2
    s_add_u32 s40, s40, s41
    s_lshl_b32 s41, s52, 1
    s_add_u32 s47, s40, s41
    s_lshl_b32 s47, s47, 11
    v_bfe_u32 v1, v0, 4, 1
    v_lshlrev_b32 v1, 17, v1
    v_lshl_add_u32 v1, v3, 8, v1
    v_and_b32 v112, 15, v0
    v_lshl_add_u32 v1, v112, 4, v1
    v_add_u32 v1, 1024, v1
    v_cvt_pk_bf16_f32 v112, v48, v49
    v_cvt_pk_bf16_f32 v113, v50, v51
    v_cvt_pk_bf16_f32 v114, v52, v53
    v_cvt_pk_bf16_f32 v115, v54, v55
    s_add_u32 s40, s47, 0
    buffer_store_dwordx4 v[112:115], v1, s[16:19], s40 offen offset:0 sc1
    v_cvt_pk_bf16_f32 v120, v56, v57
    v_cvt_pk_bf16_f32 v121, v58, v59
    v_cvt_pk_bf16_f32 v122, v60, v61
    v_cvt_pk_bf16_f32 v123, v62, v63
    s_add_u32 s40, s47, 0
    buffer_store_dwordx4 v[120:123], v1, s[16:19], s40 offen offset:512 sc1
    v_cvt_pk_bf16_f32 v112, v64, v65
    v_cvt_pk_bf16_f32 v113, v66, v67
    v_cvt_pk_bf16_f32 v114, v68, v69
    v_cvt_pk_bf16_f32 v115, v70, v71
    s_add_u32 s40, s47, 2048
    buffer_store_dwordx4 v[112:115], v1, s[16:19], s40 offen offset:0 sc1
    v_cvt_pk_bf16_f32 v120, v72, v73
    v_cvt_pk_bf16_f32 v121, v74, v75
    v_cvt_pk_bf16_f32 v122, v76, v77
    v_cvt_pk_bf16_f32 v123, v78, v79
    s_add_u32 s40, s47, 2048
    buffer_store_dwordx4 v[120:123], v1, s[16:19], s40 offen offset:512 sc1
    v_cvt_pk_bf16_f32 v112, v80, v81
    v_cvt_pk_bf16_f32 v113, v82, v83
    v_cvt_pk_bf16_f32 v114, v84, v85
    v_cvt_pk_bf16_f32 v115, v86, v87
    s_add_u32 s40, s47, 262144
    buffer_store_dwordx4 v[112:115], v1, s[16:19], s40 offen offset:0 sc1
    v_cvt_pk_bf16_f32 v120, v88, v89
    v_cvt_pk_bf16_f32 v121, v90, v91
    v_cvt_pk_bf16_f32 v122, v92, v93
    v_cvt_pk_bf16_f32 v123, v94, v95
    s_add_u32 s40, s47, 262144
    buffer_store_dwordx4 v[120:123], v1, s[16:19], s40 offen offset:512 sc1
    v_cvt_pk_bf16_f32 v112, v96, v97
    v_cvt_pk_bf16_f32 v113, v98, v99
    v_cvt_pk_bf16_f32 v114, v100, v101
    v_cvt_pk_bf16_f32 v115, v102, v103
    s_add_u32 s40, s47, 264192
    buffer_store_dwordx4 v[112:115], v1, s[16:19], s40 offen offset:0 sc1
    v_cvt_pk_bf16_f32 v120, v104, v105
    v_cvt_pk_bf16_f32 v121, v106, v107
    v_cvt_pk_bf16_f32 v122, v108, v109
    v_cvt_pk_bf16_f32 v123, v110, v111
    s_add_u32 s40, s47, 264192
    buffer_store_dwordx4 v[120:123], v1, s[16:19], s40 offen offset:512 sc1
    s_endpgm
K1_HTYPE:
    s_add_u32 s42, s41, s52
    s_xor_b32 s41, s42, 1
    v_and_b32 v2, 31, v0
    v_lshrrev_b32 v3, 5, v0
    v_add_u32 v112, s40, v2
    v_lshlrev_b32 v112, 7, v112
    v_bfe_u32 v113, v0, 1, 3
    v_add_u32 v114, 0, v3
    v_xor_b32 v114, v114, v113
    v_lshl_add_u32 v4, v114, 4, v112
    v_add_u32 v8, 0x10000, v4
    v_add_u32 v114, 2, v3
    v_xor_b32 v114, v114, v113
    v_lshl_add_u32 v5, v114, 4, v112
    v_add_u32 v9, 0x10000, v5
    v_add_u32 v114, 4, v3
    v_xor_b32 v114, v114, v113
    v_lshl_add_u32 v6, v114, 4, v112
    v_add_u32 v10, 0x10000, v6
    v_add_u32 v114, 6, v3
    v_xor_b32 v114, v114, v113
    v_lshl_add_u32 v7, v114, 4, v112
    v_add_u32 v11, 0x10000, v7
    v_bfe_u32 v112, v0, 2, 2
    v_lshl_add_u32 v113, v3, 3, v112
    v_lshlrev_b32 v113, 8, v113
    v_bfe_u32 v114, v0, 4, 1
    v_lshl_add_u32 v113, v114, 5, v113
    v_and_b32 v114, 3, v0
    v_lshl_add_u32 v113, v114, 3, v113
    v_add_u32 v113, 16384, v113
    v_xor_b32 v114, s42, v112
    v_lshl_add_u32 v12, v114, 6, v113
    v_add_u32 v14, 0x10000, v12
    v_xor_b32 v114, s41, v112
    v_lshl_add_u32 v13, v114, 6, v113
    v_add_u32 v15, 0x10000, v13
    s_lshl_b32 s40, s53, 12
    v_add_u32 v4, s40, v4
    v_xor_b32 v144, 0x1000, v4
    v_add_u32 v5, s40, v5
    v_xor_b32 v145, 0x1000, v5
    v_add_u32 v6, s40, v6
    v_xor_b32 v146, 0x1000, v6
    v_add_u32 v7, s40, v7
    v_xor_b32 v147, 0x1000, v7
    v_add_u32 v8, s40, v8
    v_xor_b32 v148, 0x1000, v8
    v_add_u32 v9, s40, v9
    v_xor_b32 v149, 0x1000, v9
    v_add_u32 v10, s40, v10
    v_xor_b32 v150, 0x1000, v10
    v_add_u32 v11, s40, v11
    v_xor_b32 v151, 0x1000, v11
    v_mov_b32 v162, 0
    v_mov_b32 v164, 0x3f803f80
    v_mov_b32 v165, 0x3f803f80
    v_mov_b32 v166, 0x3f803f80
    v_mov_b32 v167, 0x3f803f80
    v_mov_b32 v160, 134656
    v_mov_b32 v112, 133632
    v_cmp_eq_u32 vcc, 0, v2
    v_mov_b32 v113, 131072
    s_nop 0
    v_cndmask_b32 v160, v160, v112, vcc
    v_cmp_eq_u32 vcc, 1, v2
    v_lshlrev_b32 v114, 4, v3
    s_nop 0
    v_cndmask_b32 v160, v160, v113, vcc
    v_add_u32 v160, v160, v114
    v_mov_b32 v116, 0x3f803f80
    v_mov_b32 v117, 0x3f803f80
    v_mov_b32 v118, 0x3f803f80
    v_mov_b32 v119, 0x3f803f80
    v_mov_b32 v120, 0
    v_mov_b32 v121, 0
    v_mov_b32 v122, 0
    v_mov_b32 v123, 0
    s_lshl_b32 s40, s36, 8
    s_add_u32 s40, s40, 133632
    v_lshlrev_b32 v112, 4, v0
    v_add_u32 v112, s40, v112
    s_mov_b64 exec, 0xffff
    ds_write_b128 v112, v[116:119]
    ds_write_b128 v112, v[120:123] offset:1024
    s_mov_b64 exec, -1
    s_waitcnt lgkmcnt(0)
    s_barrier
    ds_read_b64_tr_b16 v[32:33], v12 offset:0
    ds_read_b64_tr_b16 v[34:35], v12 offset:1024
    ds_read_b128 v[16:19], v4 offset:0
    ds_read_b128 v[20:23], v144 offset:0
    ds_read_b64_tr_b16 v[36:37], v13 offset:0
    ds_read_b64_tr_b16 v[38:39], v13 offset:1024
    ds_read_b128 v[152:155], v160 offset:0
    s_waitcnt lgkmcnt(0)
    v_mfma_f32_32x32x16_bf16 v[48:63], v[32:35], v[16:19], 0
    ds_read_b64_tr_b16 v[40:41], v12 offset:4096
    ds_read_b64_tr_b16 v[42:43], v12 offset:5120
    ds_read_b128 v[24:27], v5 offset:0
    ds_read_b128 v[156:159], v160 offset:32
    v_lshlrev_b32 v161, 16, v16
    v_and_b32 v163, 0xffff0000, v16
    v_fmac_f32 v162, v161, v161
    v_fmac_f32 v162, v163, v163
    v_mfma_f32_32x32x16_bf16 v[64:79], v[32:35], v[20:23], 0
    ds_read_b128 v[28:31], v145 offset:0
    ds_read_b64_tr_b16 v[44:45], v13 offset:4096
    ds_read_b64_tr_b16 v[46:47], v13 offset:5120
    v_lshlrev_b32 v161, 16, v17
    v_and_b32 v163, 0xffff0000, v17
    v_fmac_f32 v162, v161, v161
    v_fmac_f32 v162, v163, v163
    v_mfma_f32_32x32x16_bf16 v[80:95], v[36:39], v[16:19], 0
    v_lshlrev_b32 v161, 16, v18
    v_and_b32 v163, 0xffff0000, v18
    v_fmac_f32 v162, v161, v161
    v_fmac_f32 v162, v163, v163
    v_mfma_f32_32x32x16_bf16 v[96:111], v[36:39], v[20:23], 0
    v_lshlrev_b32 v161, 16, v19
    v_and_b32 v163, 0xffff0000, v19
    v_fmac_f32 v162, v161, v161
    v_fmac_f32 v162, v163, v163
    v_mfma_f32_32x32x16_bf16 v[128:143], v[152:155], v[16:19], 0
    v_mfma_f32_32x32x16_bf16 v[112:127], v[32:35], v[164:167], 0
    s_waitcnt lgkmcnt(0)
    v_mfma_f32_32x32x16_bf16 v[48:63], v[40:43], v[24:27], v[48:63]
    ds_read_b64_tr_b16 v[32:33], v12 offset:8192
    ds_read_b64_tr_b16 v[34:35], v12 offset:9216
    ds_read_b128 v[16:19], v6 offset:0
    ds_read_b128 v[152:155], v160 offset:64
    v_lshlrev_b32 v161, 16, v24
    v_and_b32 v163, 0xffff0000, v24
    v_fmac_f32 v162, v161, v161
    v_fmac_f32 v162, v163, v163
    v_mfma_f32_32x32x16_bf16 v[64:79], v[40:43], v[28:31], v[64:79]
    ds_read_b128 v[20:23], v146 offset:0
    ds_read_b64_tr_b16 v[36:37], v13 offset:8192
    ds_read_b64_tr_b16 v[38:39], v13 offset:9216
    v_lshlrev_b32 v161, 16, v25
    v_and_b32 v163, 0xffff0000, v25
    v_fmac_f32 v162, v161, v161
    v_fmac_f32 v162, v163, v163
    v_mfma_f32_32x32x16_bf16 v[80:95], v[44:47], v[24:27], v[80:95]
    v_lshlrev_b32 v161, 16, v26
    v_and_b32 v163, 0xffff0000, v26
    v_fmac_f32 v162, v161, v161
    v_fmac_f32 v162, v163, v163
    v_mfma_f32_32x32x16_bf16 v[96:111], v[44:47], v[28:31], v[96:111]
    v_lshlrev_b32 v161, 16, v27
    v_and_b32 v163, 0xffff0000, v27
    v_fmac_f32 v162, v161, v161
    v_fmac_f32 v162, v163, v163
    v_mfma_f32_32x32x16_bf16 v[128:143], v[156:159], v[24:27], v[128:143]
    v_mfma_f32_32x32x16_bf16 v[112:127], v[40:43], v[164:167], v[112:127]
    s_waitcnt lgkmcnt(0)
    v_mfma_f32_32x32x16_bf16 v[48:63], v[32:35], v[16:19], v[48:63]
    ds_read_b64_tr_b16 v[40:41], v12 offset:12288
    ds_read_b64_tr_b16 v[42:43], v12 offset:13312
    ds_read_b128 v[24:27], v7 offset:0
    ds_read_b128 v[156:159], v160 offset:96
    v_lshlrev_b32 v161, 16, v16
    v_and_b32 v163, 0xffff0000, v16
    v_fmac_f32 v162, v161, v161
    v_fmac_f32 v162, v163, v163
    v_mfma_f32_32x32x16_bf16 v[64:79], v[32:35], v[20:23], v[64:79]
    ds_read_b128 v[28:31], v147 offset:0
    ds_read_b64_tr_b16 v[44:45], v13 offset:12288
    ds_read_b64_tr_b16 v[46:47], v13 offset:13312
    v_lshlrev_b32 v161, 16, v17
    v_and_b32 v163, 0xffff0000, v17
    v_fmac_f32 v162, v161, v161
    v_fmac_f32 v162, v163, v163
    v_mfma_f32_32x32x16_bf16 v[80:95], v[36:39], v[16:19], v[80:95]
    v_lshlrev_b32 v161, 16, v18
    v_and_b32 v163, 0xffff0000, v18
    v_fmac_f32 v162, v161, v161
    v_fmac_f32 v162, v163, v163
    v_mfma_f32_32x32x16_bf16 v[96:111], v[36:39], v[20:23], v[96:111]
    v_lshlrev_b32 v161, 16, v19
    v_and_b32 v163, 0xffff0000, v19
    v_fmac_f32 v162, v161, v161
    v_fmac_f32 v162, v163, v163
    v_mfma_f32_32x32x16_bf16 v[128:143], v[152:155], v[16:19], v[128:143]
    v_mfma_f32_32x32x16_bf16 v[112:127], v[32:35], v[164:167], v[112:127]
    s_waitcnt lgkmcnt(0)
    v_mfma_f32_32x32x16_bf16 v[48:63], v[40:43], v[24:27], v[48:63]
    s_barrier
    ds_read_b64_tr_b16 v[32:33], v12 offset:32768
    ds_read_b64_tr_b16 v[34:35], v12 offset:33792
    ds_read_b128 v[16:19], v4 offset:32768
    ds_read_b128 v[152:155], v160 offset:128
    v_lshlrev_b32 v161, 16, v24
    v_and_b32 v163, 0xffff0000, v24
    v_fmac_f32 v162, v161, v161
    v_fmac_f32 v162, v163, v163
    v_mfma_f32_32x32x16_bf16 v[64:79], v[40:43], v[28:31], v[64:79]
    ds_read_b128 v[20:23], v144 offset:32768
    ds_read_b64_tr_b16 v[36:37], v13 offset:32768
    ds_read_b64_tr_b16 v[38:39], v13 offset:33792
    v_lshlrev_b32 v161, 16, v25
    v_and_b32 v163, 0xffff0000, v25
    v_fmac_f32 v162, v161, v161
    v_fmac_f32 v162, v163, v163
    v_mfma_f32_32x32x16_bf16 v[80:95], v[44:47], v[24:27], v[80:95]
    v_lshlrev_b32 v161, 16, v26
    v_and_b32 v163, 0xffff0000, v26
    v_fmac_f32 v162, v161, v161
    v_fmac_f32 v162, v163, v163
    v_mfma_f32_32x32x16_bf16 v[96:111], v[44:47], v[28:31], v[96:111]
    v_lshlrev_b32 v161, 16, v27
    v_and_b32 v163, 0xffff0000, v27
    v_fmac_f32 v162, v161, v161
    v_fmac_f32 v162, v163, v163
    v_mfma_f32_32x32x16_bf16 v[128:143], v[156:159], v[24:27], v[128:143]
    v_mfma_f32_32x32x16_bf16 v[112:127], v[40:43], v[164:167], v[112:127]
    s_waitcnt lgkmcnt(0)
    v_mfma_f32_32x32x16_bf16 v[48:63], v[32:35], v[16:19], v[48:63]
    ds_read_b64_tr_b16 v[40:41], v12 offset:36864
    ds_read_b64_tr_b16 v[42:43], v12 offset:37888
    ds_read_b128 v[24:27], v5 offset:32768
    ds_read_b128 v[156:159], v160 offset:160
    v_lshlrev_b32 v161, 16, v16
    v_and_b32 v163, 0xffff0000, v16
    v_fmac_f32 v162, v161, v161
    v_fmac_f32 v162, v163, v163
    v_mfma_f32_32x32x16_bf16 v[64:79], v[32:35], v[20:23], v[64:79]
    ds_read_b128 v[28:31], v145 offset:32768
    ds_read_b64_tr_b16 v[44:45], v13 offset:36864
    ds_read_b64_tr_b16 v[46:47], v13 offset:37888
    v_lshlrev_b32 v161, 16, v17
    v_and_b32 v163, 0xffff0000, v17
    v_fmac_f32 v162, v161, v161
    v_fmac_f32 v162, v163, v163
    v_mfma_f32_32x32x16_bf16 v[80:95], v[36:39], v[16:19], v[80:95]
    v_lshlrev_b32 v161, 16, v18
    v_and_b32 v163, 0xffff0000, v18
    v_fmac_f32 v162, v161, v161
    v_fmac_f32 v162, v163, v163
    v_mfma_f32_32x32x16_bf16 v[96:111], v[36:39], v[20:23], v[96:111]
    v_lshlrev_b32 v161, 16, v19
    v_and_b32 v163, 0xffff0000, v19
    v_fmac_f32 v162, v161, v161
    v_fmac_f32 v162, v163, v163
    v_mfma_f32_32x32x16_bf16 v[128:143], v[152:155], v[16:19], v[128:143]
    v_mfma_f32_32x32x16_bf16 v[112:127], v[32:35], v[164:167], v[112:127]
    s_waitcnt lgkmcnt(0)
    v_mfma_f32_32x32x16_bf16 v[48:63], v[40:43], v[24:27], v[48:63]
    ds_read_b64_tr_b16 v[32:33], v12 offset:40960
    ds_read_b64_tr_b16 v[34:35], v12 offset:41984
    ds_read_b128 v[16:19], v6 offset:32768
    ds_read_b128 v[152:155], v160 offset:192
    v_lshlrev_b32 v161, 16, v24
    v_and_b32 v163, 0xffff0000, v24
    v_fmac_f32 v162, v161, v161
    v_fmac_f32 v162, v163, v163
    v_mfma_f32_32x32x16_bf16 v[64:79], v[40:43], v[28:31], v[64:79]
    ds_read_b128 v[20:23], v146 offset:32768
    ds_read_b64_tr_b16 v[36:37], v13 offset:40960
    ds_read_b64_tr_b16 v[38:39], v13 offset:41984
    v_lshlrev_b32 v161, 16, v25
    v_and_b32 v163, 0xffff0000, v25
    v_fmac_f32 v162, v161, v161
    v_fmac_f32 v162, v163, v163
    v_mfma_f32_32x32x16_bf16 v[80:95], v[44:47], v[24:27], v[80:95]
    v_lshlrev_b32 v161, 16, v26
    v_and_b32 v163, 0xffff0000, v26
    v_fmac_f32 v162, v161, v161
    v_fmac_f32 v162, v163, v163
    v_mfma_f32_32x32x16_bf16 v[96:111], v[44:47], v[28:31], v[96:111]
    v_lshlrev_b32 v161, 16, v27
    v_and_b32 v163, 0xffff0000, v27
    v_fmac_f32 v162, v161, v161
    v_fmac_f32 v162, v163, v163
    v_mfma_f32_32x32x16_bf16 v[128:143], v[156:159], v[24:27], v[128:143]
    v_mfma_f32_32x32x16_bf16 v[112:127], v[40:43], v[164:167], v[112:127]
    s_waitcnt lgkmcnt(0)
    v_mfma_f32_32x32x16_bf16 v[48:63], v[32:35], v[16:19], v[48:63]
    ds_read_b64_tr_b16 v[40:41], v12 offset:45056
    ds_read_b64_tr_b16 v[42:43], v12 offset:46080
    ds_read_b128 v[24:27], v7 offset:32768
    ds_read_b128 v[156:159], v160 offset:224
    v_lshlrev_b32 v161, 16, v16
    v_and_b32 v163, 0xffff0000, v16
    v_fmac_f32 v162, v161, v161
    v_fmac_f32 v162, v163, v163
    v_mfma_f32_32x32x16_bf16 v[64:79], v[32:35], v[20:23], v[64:79]
    ds_read_b128 v[28:31], v147 offset:32768
    ds_read_b64_tr_b16 v[44:45], v13 offset:45056
    ds_read_b64_tr_b16 v[46:47], v13 offset:46080
    v_lshlrev_b32 v161, 16, v17
    v_and_b32 v163, 0xffff0000, v17
    v_fmac_f32 v162, v161, v161
    v_fmac_f32 v162, v163, v163
    v_mfma_f32_32x32x16_bf16 v[80:95], v[36:39], v[16:19], v[80:95]
    v_lshlrev_b32 v161, 16, v18
    v_and_b32 v163, 0xffff0000, v18
    v_fmac_f32 v162, v161, v161
    v_fmac_f32 v162, v163, v163
    v_mfma_f32_32x32x16_bf16 v[96:111], v[36:39], v[20:23], v[96:111]
    v_lshlrev_b32 v161, 16, v19
    v_and_b32 v163, 0xffff0000, v19
    v_fmac_f32 v162, v161, v161
    v_fmac_f32 v162, v163, v163
    v_mfma_f32_32x32x16_bf16 v[128:143], v[152:155], v[16:19], v[128:143]
    v_mfma_f32_32x32x16_bf16 v[112:127], v[32:35], v[164:167], v[112:127]
    s_waitcnt lgkmcnt(0)
    v_mfma_f32_32x32x16_bf16 v[48:63], v[40:43], v[24:27], v[48:63]
    s_barrier
    ds_read_b64_tr_b16 v[32:33], v14 offset:0
    ds_read_b64_tr_b16 v[34:35], v14 offset:1024
    ds_read_b128 v[16:19], v8 offset:0
    ds_read_b128 v[152:155], v160 offset:256
    v_lshlrev_b32 v161, 16, v24
    v_and_b32 v163, 0xffff0000, v24
    v_fmac_f32 v162, v161, v161
    v_fmac_f32 v162, v163, v163
    v_mfma_f32_32x32x16_bf16 v[64:79], v[40:43], v[28:31], v[64:79]
    ds_read_b128 v[20:23], v148 offset:0
    ds_read_b64_tr_b16 v[36:37], v15 offset:0
    ds_read_b64_tr_b16 v[38:39], v15 offset:1024
    v_lshlrev_b32 v161, 16, v25
    v_and_b32 v163, 0xffff0000, v25
    v_fmac_f32 v162, v161, v161
    v_fmac_f32 v162, v163, v163
    v_mfma_f32_32x32x16_bf16 v[80:95], v[44:47], v[24:27], v[80:95]
    v_lshlrev_b32 v161, 16, v26
    v_and_b32 v163, 0xffff0000, v26
    v_fmac_f32 v162, v161, v161
    v_fmac_f32 v162, v163, v163
    v_mfma_f32_32x32x16_bf16 v[96:111], v[44:47], v[28:31], v[96:111]
    v_lshlrev_b32 v161, 16, v27
    v_and_b32 v163, 0xffff0000, v27
    v_fmac_f32 v162, v161, v161
    v_fmac_f32 v162, v163, v163
    v_mfma_f32_32x32x16_bf16 v[128:143], v[156:159], v[24:27], v[128:143]
    v_mfma_f32_32x32x16_bf16 v[112:127], v[40:43], v[164:167], v[112:127]
    s_waitcnt lgkmcnt(0)
    v_mfma_f32_32x32x16_bf16 v[48:63], v[32:35], v[16:19], v[48:63]
    ds_read_b64_tr_b16 v[40:41], v14 offset:4096
    ds_read_b64_tr_b16 v[42:43], v14 offset:5120
    ds_read_b128 v[24:27], v9 offset:0
    ds_read_b128 v[156:159], v160 offset:288
    v_lshlrev_b32 v161, 16, v16
    v_and_b32 v163, 0xffff0000, v16
    v_fmac_f32 v162, v161, v161
    v_fmac_f32 v162, v163, v163
    v_mfma_f32_32x32x16_bf16 v[64:79], v[32:35], v[20:23], v[64:79]
    ds_read_b128 v[28:31], v149 offset:0
    ds_read_b64_tr_b16 v[44:45], v15 offset:4096
    ds_read_b64_tr_b16 v[46:47], v15 offset:5120
    v_lshlrev_b32 v161, 16, v17
    v_and_b32 v163, 0xffff0000, v17
    v_fmac_f32 v162, v161, v161
    v_fmac_f32 v162, v163, v163
    v_mfma_f32_32x32x16_bf16 v[80:95], v[36:39], v[16:19], v[80:95]
    v_lshlrev_b32 v161, 16, v18
    v_and_b32 v163, 0xffff0000, v18
    v_fmac_f32 v162, v161, v161
    v_fmac_f32 v162, v163, v163
    v_mfma_f32_32x32x16_bf16 v[96:111], v[36:39], v[20:23], v[96:111]
    v_lshlrev_b32 v161, 16, v19
    v_and_b32 v163, 0xffff0000, v19
    v_fmac_f32 v162, v161, v161
    v_fmac_f32 v162, v163, v163
    v_mfma_f32_32x32x16_bf16 v[128:143], v[152:155], v[16:19], v[128:143]
    v_mfma_f32_32x32x16_bf16 v[112:127], v[32:35], v[164:167], v[112:127]
    s_waitcnt lgkmcnt(0)
    v_mfma_f32_32x32x16_bf16 v[48:63], v[40:43], v[24:27], v[48:63]
    ds_read_b64_tr_b16 v[32:33], v14 offset:8192
    ds_read_b64_tr_b16 v[34:35], v14 offset:9216
    ds_read_b128 v[16:19], v10 offset:0
    ds_read_b128 v[152:155], v160 offset:320
    v_lshlrev_b32 v161, 16, v24
    v_and_b32 v163, 0xffff0000, v24
    v_fmac_f32 v162, v161, v161
    v_fmac_f32 v162, v163, v163
    v_mfma_f32_32x32x16_bf16 v[64:79], v[40:43], v[28:31], v[64:79]
    ds_read_b128 v[20:23], v150 offset:0
    ds_read_b64_tr_b16 v[36:37], v15 offset:8192
    ds_read_b64_tr_b16 v[38:39], v15 offset:9216
    v_lshlrev_b32 v161, 16, v25
    v_and_b32 v163, 0xffff0000, v25
    v_fmac_f32 v162, v161, v161
    v_fmac_f32 v162, v163, v163
    v_mfma_f32_32x32x16_bf16 v[80:95], v[44:47], v[24:27], v[80:95]
    v_lshlrev_b32 v161, 16, v26
    v_and_b32 v163, 0xffff0000, v26
    v_fmac_f32 v162, v161, v161
    v_fmac_f32 v162, v163, v163
    v_mfma_f32_32x32x16_bf16 v[96:111], v[44:47], v[28:31], v[96:111]
    v_lshlrev_b32 v161, 16, v27
    v_and_b32 v163, 0xffff0000, v27
    v_fmac_f32 v162, v161, v161
    v_fmac_f32 v162, v163, v163
    v_mfma_f32_32x32x16_bf16 v[128:143], v[156:159], v[24:27], v[128:143]
    v_mfma_f32_32x32x16_bf16 v[112:127], v[40:43], v[164:167], v[112:127]
    s_waitcnt lgkmcnt(0)
    v_mfma_f32_32x32x16_bf16 v[48:63], v[32:35], v[16:19], v[48:63]
    ds_read_b64_tr_b16 v[40:41], v14 offset:12288
    ds_read_b64_tr_b16 v[42:43], v14 offset:13312
    ds_read_b128 v[24:27], v11 offset:0
    ds_read_b128 v[156:159], v160 offset:352
    v_lshlrev_b32 v161, 16, v16
    v_and_b32 v163, 0xffff0000, v16
    v_fmac_f32 v162, v161, v161
    v_fmac_f32 v162, v163, v163
    v_mfma_f32_32x32x16_bf16 v[64:79], v[32:35], v[20:23], v[64:79]
    ds_read_b128 v[28:31], v151 offset:0
    ds_read_b64_tr_b16 v[44:45], v15 offset:12288
    ds_read_b64_tr_b16 v[46:47], v15 offset:13312
    v_lshlrev_b32 v161, 16, v17
    v_and_b32 v163, 0xffff0000, v17
    v_fmac_f32 v162, v161, v161
    v_fmac_f32 v162, v163, v163
    v_mfma_f32_32x32x16_bf16 v[80:95], v[36:39], v[16:19], v[80:95]
    v_lshlrev_b32 v161, 16, v18
    v_and_b32 v163, 0xffff0000, v18
    v_fmac_f32 v162, v161, v161
    v_fmac_f32 v162, v163, v163
    v_mfma_f32_32x32x16_bf16 v[96:111], v[36:39], v[20:23], v[96:111]
    v_lshlrev_b32 v161, 16, v19
    v_and_b32 v163, 0xffff0000, v19
    v_fmac_f32 v162, v161, v161
    v_fmac_f32 v162, v163, v163
    v_mfma_f32_32x32x16_bf16 v[128:143], v[152:155], v[16:19], v[128:143]
    v_mfma_f32_32x32x16_bf16 v[112:127], v[32:35], v[164:167], v[112:127]
    s_waitcnt lgkmcnt(0)
    v_mfma_f32_32x32x16_bf16 v[48:63], v[40:43], v[24:27], v[48:63]
    s_barrier
    ds_read_b64_tr_b16 v[32:33], v14 offset:32768
    ds_read_b64_tr_b16 v[34:35], v14 offset:33792
    ds_read_b128 v[16:19], v8 offset:32768
    ds_read_b128 v[152:155], v160 offset:384
    v_lshlrev_b32 v161, 16, v24
    v_and_b32 v163, 0xffff0000, v24
    v_fmac_f32 v162, v161, v161
    v_fmac_f32 v162, v163, v163
    v_mfma_f32_32x32x16_bf16 v[64:79], v[40:43], v[28:31], v[64:79]
    ds_read_b128 v[20:23], v148 offset:32768
    ds_read_b64_tr_b16 v[36:37], v15 offset:32768
    ds_read_b64_tr_b16 v[38:39], v15 offset:33792
    v_lshlrev_b32 v161, 16, v25
    v_and_b32 v163, 0xffff0000, v25
    v_fmac_f32 v162, v161, v161
    v_fmac_f32 v162, v163, v163
    v_mfma_f32_32x32x16_bf16 v[80:95], v[44:47], v[24:27], v[80:95]
    v_lshlrev_b32 v161, 16, v26
    v_and_b32 v163, 0xffff0000, v26
    v_fmac_f32 v162, v161, v161
    v_fmac_f32 v162, v163, v163
    v_mfma_f32_32x32x16_bf16 v[96:111], v[44:47], v[28:31], v[96:111]
    v_lshlrev_b32 v161, 16, v27
    v_and_b32 v163, 0xffff0000, v27
    v_fmac_f32 v162, v161, v161
    v_fmac_f32 v162, v163, v163
    v_mfma_f32_32x32x16_bf16 v[128:143], v[156:159], v[24:27], v[128:143]
    v_mfma_f32_32x32x16_bf16 v[112:127], v[40:43], v[164:167], v[112:127]
    s_waitcnt lgkmcnt(0)
    v_mfma_f32_32x32x16_bf16 v[48:63], v[32:35], v[16:19], v[48:63]
    ds_read_b64_tr_b16 v[40:41], v14 offset:36864
    ds_read_b64_tr_b16 v[42:43], v14 offset:37888
    ds_read_b128 v[24:27], v9 offset:32768
    ds_read_b128 v[156:159], v160 offset:416
    v_lshlrev_b32 v161, 16, v16
    v_and_b32 v163, 0xffff0000, v16
    v_fmac_f32 v162, v161, v161
    v_fmac_f32 v162, v163, v163
    v_mfma_f32_32x32x16_bf16 v[64:79], v[32:35], v[20:23], v[64:79]
    ds_read_b128 v[28:31], v149 offset:32768
    ds_read_b64_tr_b16 v[44:45], v15 offset:36864
    ds_read_b64_tr_b16 v[46:47], v15 offset:37888
    v_lshlrev_b32 v161, 16, v17
    v_and_b32 v163, 0xffff0000, v17
    v_fmac_f32 v162, v161, v161
    v_fmac_f32 v162, v163, v163
    v_mfma_f32_32x32x16_bf16 v[80:95], v[36:39], v[16:19], v[80:95]
    v_lshlrev_b32 v161, 16, v18
    v_and_b32 v163, 0xffff0000, v18
    v_fmac_f32 v162, v161, v161
    v_fmac_f32 v162, v163, v163
    v_mfma_f32_32x32x16_bf16 v[96:111], v[36:39], v[20:23], v[96:111]
    v_lshlrev_b32 v161, 16, v19
    v_and_b32 v163, 0xffff0000, v19
    v_fmac_f32 v162, v161, v161
    v_fmac_f32 v162, v163, v163
    v_mfma_f32_32x32x16_bf16 v[128:143], v[152:155], v[16:19], v[128:143]
    v_mfma_f32_32x32x16_bf16 v[112:127], v[32:35], v[164:167], v[112:127]
    s_waitcnt lgkmcnt(0)
    v_mfma_f32_32x32x16_bf16 v[48:63], v[40:43], v[24:27], v[48:63]
    ds_read_b64_tr_b16 v[32:33], v14 offset:40960
    ds_read_b64_tr_b16 v[34:35], v14 offset:41984
    ds_read_b128 v[16:19], v10 offset:32768
    ds_read_b128 v[152:155], v160 offset:448
    v_lshlrev_b32 v161, 16, v24
    v_and_b32 v163, 0xffff0000, v24
    v_fmac_f32 v162, v161, v161
    v_fmac_f32 v162, v163, v163
    v_mfma_f32_32x32x16_bf16 v[64:79], v[40:43], v[28:31], v[64:79]
    ds_read_b128 v[20:23], v150 offset:32768
    ds_read_b64_tr_b16 v[36:37], v15 offset:40960
    ds_read_b64_tr_b16 v[38:39], v15 offset:41984
    v_lshlrev_b32 v161, 16, v25
    v_and_b32 v163, 0xffff0000, v25
    v_fmac_f32 v162, v161, v161
    v_fmac_f32 v162, v163, v163
    v_mfma_f32_32x32x16_bf16 v[80:95], v[44:47], v[24:27], v[80:95]
    v_lshlrev_b32 v161, 16, v26
    v_and_b32 v163, 0xffff0000, v26
    v_fmac_f32 v162, v161, v161
    v_fmac_f32 v162, v163, v163
    v_mfma_f32_32x32x16_bf16 v[96:111], v[44:47], v[28:31], v[96:111]
    v_lshlrev_b32 v161, 16, v27
    v_and_b32 v163, 0xffff0000, v27
    v_fmac_f32 v162, v161, v161
    v_fmac_f32 v162, v163, v163
    v_mfma_f32_32x32x16_bf16 v[128:143], v[156:159], v[24:27], v[128:143]
    v_mfma_f32_32x32x16_bf16 v[112:127], v[40:43], v[164:167], v[112:127]
    s_waitcnt lgkmcnt(0)
    v_mfma_f32_32x32x16_bf16 v[48:63], v[32:35], v[16:19], v[48:63]
    ds_read_b64_tr_b16 v[40:41], v14 offset:45056
    ds_read_b64_tr_b16 v[42:43], v14 offset:46080
    ds_read_b128 v[24:27], v11 offset:32768
    ds_read_b128 v[156:159], v160 offset:480
    v_lshlrev_b32 v161, 16, v16
    v_and_b32 v163, 0xffff0000, v16
    v_fmac_f32 v162, v161, v161
    v_fmac_f32 v162, v163, v163
    v_mfma_f32_32x32x16_bf16 v[64:79], v[32:35], v[20:23], v[64:79]
    ds_read_b128 v[28:31], v151 offset:32768
    ds_read_b64_tr_b16 v[44:45], v15 offset:45056
    ds_read_b64_tr_b16 v[46:47], v15 offset:46080
    v_lshlrev_b32 v161, 16, v17
    v_and_b32 v163, 0xffff0000, v17
    v_fmac_f32 v162, v161, v161
    v_fmac_f32 v162, v163, v163
    v_mfma_f32_32x32x16_bf16 v[80:95], v[36:39], v[16:19], v[80:95]
    v_lshlrev_b32 v161, 16, v18
    v_and_b32 v163, 0xffff0000, v18
    v_fmac_f32 v162, v161, v161
    v_fmac_f32 v162, v163, v163
    v_mfma_f32_32x32x16_bf16 v[96:111], v[36:39], v[20:23], v[96:111]
    v_lshlrev_b32 v161, 16, v19
    v_and_b32 v163, 0xffff0000, v19
    v_fmac_f32 v162, v161, v161
    v_fmac_f32 v162, v163, v163
    v_mfma_f32_32x32x16_bf16 v[128:143], v[152:155], v[16:19], v[128:143]
    v_mfma_f32_32x32x16_bf16 v[112:127], v[32:35], v[164:167], v[112:127]
    s_waitcnt lgkmcnt(0)
    v_mfma_f32_32x32x16_bf16 v[48:63], v[40:43], v[24:27], v[48:63]
    s_barrier
    ds_read_b64_tr_b16 v[32:33], v12 offset:0
    ds_read_b64_tr_b16 v[34:35], v12 offset:1024
    ds_read_b128 v[16:19], v4 offset:0
    ds_read_b128 v[152:155], v160 offset:512
    v_lshlrev_b32 v161, 16, v24
    v_and_b32 v163, 0xffff0000, v24
    v_fmac_f32 v162, v161, v161
    v_fmac_f32 v162, v163, v163
    v_mfma_f32_32x32x16_bf16 v[64:79], v[40:43], v[28:31], v[64:79]
    ds_read_b128 v[20:23], v144 offset:0
    ds_read_b64_tr_b16 v[36:37], v13 offset:0
    ds_read_b64_tr_b16 v[38:39], v13 offset:1024
    v_lshlrev_b32 v161, 16, v25
    v_and_b32 v163, 0xffff0000, v25
    v_fmac_f32 v162, v161, v161
    v_fmac_f32 v162, v163, v163
    v_mfma_f32_32x32x16_bf16 v[80:95], v[44:47], v[24:27], v[80:95]
    v_lshlrev_b32 v161, 16, v26
    v_and_b32 v163, 0xffff0000, v26
    v_fmac_f32 v162, v161, v161
    v_fmac_f32 v162, v163, v163
    v_mfma_f32_32x32x16_bf16 v[96:111], v[44:47], v[28:31], v[96:111]
    v_lshlrev_b32 v161, 16, v27
    v_and_b32 v163, 0xffff0000, v27
    v_fmac_f32 v162, v161, v161
    v_fmac_f32 v162, v163, v163
    v_mfma_f32_32x32x16_bf16 v[128:143], v[156:159], v[24:27], v[128:143]
    v_mfma_f32_32x32x16_bf16 v[112:127], v[40:43], v[164:167], v[112:127]
    s_waitcnt lgkmcnt(0)
    v_mfma_f32_32x32x16_bf16 v[48:63], v[32:35], v[16:19], v[48:63]
    ds_read_b64_tr_b16 v[40:41], v12 offset:4096
    ds_read_b64_tr_b16 v[42:43], v12 offset:5120
    ds_read_b128 v[24:27], v5 offset:0
    ds_read_b128 v[156:159], v160 offset:544
    v_lshlrev_b32 v161, 16, v16
    v_and_b32 v163, 0xffff0000, v16
    v_fmac_f32 v162, v161, v161
    v_fmac_f32 v162, v163, v163
    v_mfma_f32_32x32x16_bf16 v[64:79], v[32:35], v[20:23], v[64:79]
    ds_read_b128 v[28:31], v145 offset:0
    ds_read_b64_tr_b16 v[44:45], v13 offset:4096
    ds_read_b64_tr_b16 v[46:47], v13 offset:5120
    v_lshlrev_b32 v161, 16, v17
    v_and_b32 v163, 0xffff0000, v17
    v_fmac_f32 v162, v161, v161
    v_fmac_f32 v162, v163, v163
    v_mfma_f32_32x32x16_bf16 v[80:95], v[36:39], v[16:19], v[80:95]
    v_lshlrev_b32 v161, 16, v18
    v_and_b32 v163, 0xffff0000, v18
    v_fmac_f32 v162, v161, v161
    v_fmac_f32 v162, v163, v163
    v_mfma_f32_32x32x16_bf16 v[96:111], v[36:39], v[20:23], v[96:111]
    v_lshlrev_b32 v161, 16, v19
    v_and_b32 v163, 0xffff0000, v19
    v_fmac_f32 v162, v161, v161
    v_fmac_f32 v162, v163, v163
    v_mfma_f32_32x32x16_bf16 v[128:143], v[152:155], v[16:19], v[128:143]
    v_mfma_f32_32x32x16_bf16 v[112:127], v[32:35], v[164:167], v[112:127]
    s_waitcnt lgkmcnt(0)
    v_mfma_f32_32x32x16_bf16 v[48:63], v[40:43], v[24:27], v[48:63]
    ds_read_b64_tr_b16 v[32:33], v12 offset:8192
    ds_read_b64_tr_b16 v[34:35], v12 offset:9216
    ds_read_b128 v[16:19], v6 offset:0
    ds_read_b128 v[152:155], v160 offset:576
    v_lshlrev_b32 v161, 16, v24
    v_and_b32 v163, 0xffff0000, v24
    v_fmac_f32 v162, v161, v161
    v_fmac_f32 v162, v163, v163
    v_mfma_f32_32x32x16_bf16 v[64:79], v[40:43], v[28:31], v[64:79]
    ds_read_b128 v[20:23], v146 offset:0
    ds_read_b64_tr_b16 v[36:37], v13 offset:8192
    ds_read_b64_tr_b16 v[38:39], v13 offset:9216
    v_lshlrev_b32 v161, 16, v25
    v_and_b32 v163, 0xffff0000, v25
    v_fmac_f32 v162, v161, v161
    v_fmac_f32 v162, v163, v163
    v_mfma_f32_32x32x16_bf16 v[80:95], v[44:47], v[24:27], v[80:95]
    v_lshlrev_b32 v161, 16, v26
    v_and_b32 v163, 0xffff0000, v26
    v_fmac_f32 v162, v161, v161
    v_fmac_f32 v162, v163, v163
    v_mfma_f32_32x32x16_bf16 v[96:111], v[44:47], v[28:31], v[96:111]
    v_lshlrev_b32 v161, 16, v27
    v_and_b32 v163, 0xffff0000, v27
    v_fmac_f32 v162, v161, v161
    v_fmac_f32 v162, v163, v163
    v_mfma_f32_32x32x16_bf16 v[128:143], v[156:159], v[24:27], v[128:143]
    v_mfma_f32_32x32x16_bf16 v[112:127], v[40:43], v[164:167], v[112:127]
    s_waitcnt lgkmcnt(0)
    v_mfma_f32_32x32x16_bf16 v[48:63], v[32:35], v[16:19], v[48:63]
    ds_read_b64_tr_b16 v[40:41], v12 offset:12288
    ds_read_b64_tr_b16 v[42:43], v12 offset:13312
    ds_read_b128 v[24:27], v7 offset:0
    ds_read_b128 v[156:159], v160 offset:608
    v_lshlrev_b32 v161, 16, v16
    v_and_b32 v163, 0xffff0000, v16
    v_fmac_f32 v162, v161, v161
    v_fmac_f32 v162, v163, v163
    v_mfma_f32_32x32x16_bf16 v[64:79], v[32:35], v[20:23], v[64:79]
    ds_read_b128 v[28:31], v147 offset:0
    ds_read_b64_tr_b16 v[44:45], v13 offset:12288
    ds_read_b64_tr_b16 v[46:47], v13 offset:13312
    v_lshlrev_b32 v161, 16, v17
    v_and_b32 v163, 0xffff0000, v17
    v_fmac_f32 v162, v161, v161
    v_fmac_f32 v162, v163, v163
    v_mfma_f32_32x32x16_bf16 v[80:95], v[36:39], v[16:19], v[80:95]
    v_lshlrev_b32 v161, 16, v18
    v_and_b32 v163, 0xffff0000, v18
    v_fmac_f32 v162, v161, v161
    v_fmac_f32 v162, v163, v163
    v_mfma_f32_32x32x16_bf16 v[96:111], v[36:39], v[20:23], v[96:111]
    v_lshlrev_b32 v161, 16, v19
    v_and_b32 v163, 0xffff0000, v19
    v_fmac_f32 v162, v161, v161
    v_fmac_f32 v162, v163, v163
    v_mfma_f32_32x32x16_bf16 v[128:143], v[152:155], v[16:19], v[128:143]
    v_mfma_f32_32x32x16_bf16 v[112:127], v[32:35], v[164:167], v[112:127]
    s_waitcnt lgkmcnt(0)
    v_mfma_f32_32x32x16_bf16 v[48:63], v[40:43], v[24:27], v[48:63]
    s_barrier
    ds_read_b64_tr_b16 v[32:33], v12 offset:32768
    ds_read_b64_tr_b16 v[34:35], v12 offset:33792
    ds_read_b128 v[16:19], v4 offset:32768
    ds_read_b128 v[152:155], v160 offset:640
    v_lshlrev_b32 v161, 16, v24
    v_and_b32 v163, 0xffff0000, v24
    v_fmac_f32 v162, v161, v161
    v_fmac_f32 v162, v163, v163
    v_mfma_f32_32x32x16_bf16 v[64:79], v[40:43], v[28:31], v[64:79]
    ds_read_b128 v[20:23], v144 offset:32768
    ds_read_b64_tr_b16 v[36:37], v13 offset:32768
    ds_read_b64_tr_b16 v[38:39], v13 offset:33792
    v_lshlrev_b32 v161, 16, v25
    v_and_b32 v163, 0xffff0000, v25
    v_fmac_f32 v162, v161, v161
    v_fmac_f32 v162, v163, v163
    v_mfma_f32_32x32x16_bf16 v[80:95], v[44:47], v[24:27], v[80:95]
    v_lshlrev_b32 v161, 16, v26
    v_and_b32 v163, 0xffff0000, v26
    v_fmac_f32 v162, v161, v161
    v_fmac_f32 v162, v163, v163
    v_mfma_f32_32x32x16_bf16 v[96:111], v[44:47], v[28:31], v[96:111]
    v_lshlrev_b32 v161, 16, v27
    v_and_b32 v163, 0xffff0000, v27
    v_fmac_f32 v162, v161, v161
    v_fmac_f32 v162, v163, v163
    v_mfma_f32_32x32x16_bf16 v[128:143], v[156:159], v[24:27], v[128:143]
    v_mfma_f32_32x32x16_bf16 v[112:127], v[40:43], v[164:167], v[112:127]
    s_waitcnt lgkmcnt(0)
    v_mfma_f32_32x32x16_bf16 v[48:63], v[32:35], v[16:19], v[48:63]
    ds_read_b64_tr_b16 v[40:41], v12 offset:36864
    ds_read_b64_tr_b16 v[42:43], v12 offset:37888
    ds_read_b128 v[24:27], v5 offset:32768
    ds_read_b128 v[156:159], v160 offset:672
    v_lshlrev_b32 v161, 16, v16
    v_and_b32 v163, 0xffff0000, v16
    v_fmac_f32 v162, v161, v161
    v_fmac_f32 v162, v163, v163
    v_mfma_f32_32x32x16_bf16 v[64:79], v[32:35], v[20:23], v[64:79]
    ds_read_b128 v[28:31], v145 offset:32768
    ds_read_b64_tr_b16 v[44:45], v13 offset:36864
    ds_read_b64_tr_b16 v[46:47], v13 offset:37888
    v_lshlrev_b32 v161, 16, v17
    v_and_b32 v163, 0xffff0000, v17
    v_fmac_f32 v162, v161, v161
    v_fmac_f32 v162, v163, v163
    v_mfma_f32_32x32x16_bf16 v[80:95], v[36:39], v[16:19], v[80:95]
    v_lshlrev_b32 v161, 16, v18
    v_and_b32 v163, 0xffff0000, v18
    v_fmac_f32 v162, v161, v161
    v_fmac_f32 v162, v163, v163
    v_mfma_f32_32x32x16_bf16 v[96:111], v[36:39], v[20:23], v[96:111]
    v_lshlrev_b32 v161, 16, v19
    v_and_b32 v163, 0xffff0000, v19
    v_fmac_f32 v162, v161, v161
    v_fmac_f32 v162, v163, v163
    v_mfma_f32_32x32x16_bf16 v[128:143], v[152:155], v[16:19], v[128:143]
    v_mfma_f32_32x32x16_bf16 v[112:127], v[32:35], v[164:167], v[112:127]
    s_waitcnt lgkmcnt(0)
    v_mfma_f32_32x32x16_bf16 v[48:63], v[40:43], v[24:27], v[48:63]
    ds_read_b64_tr_b16 v[32:33], v12 offset:40960
    ds_read_b64_tr_b16 v[34:35], v12 offset:41984
    ds_read_b128 v[16:19], v6 offset:32768
    ds_read_b128 v[152:155], v160 offset:704
    v_lshlrev_b32 v161, 16, v24
    v_and_b32 v163, 0xffff0000, v24
    v_fmac_f32 v162, v161, v161
    v_fmac_f32 v162, v163, v163
    v_mfma_f32_32x32x16_bf16 v[64:79], v[40:43], v[28:31], v[64:79]
    ds_read_b128 v[20:23], v146 offset:32768
    ds_read_b64_tr_b16 v[36:37], v13 offset:40960
    ds_read_b64_tr_b16 v[38:39], v13 offset:41984
    v_lshlrev_b32 v161, 16, v25
    v_and_b32 v163, 0xffff0000, v25
    v_fmac_f32 v162, v161, v161
    v_fmac_f32 v162, v163, v163
    v_mfma_f32_32x32x16_bf16 v[80:95], v[44:47], v[24:27], v[80:95]
    v_lshlrev_b32 v161, 16, v26
    v_and_b32 v163, 0xffff0000, v26
    v_fmac_f32 v162, v161, v161
    v_fmac_f32 v162, v163, v163
    v_mfma_f32_32x32x16_bf16 v[96:111], v[44:47], v[28:31], v[96:111]
    v_lshlrev_b32 v161, 16, v27
    v_and_b32 v163, 0xffff0000, v27
    v_fmac_f32 v162, v161, v161
    v_fmac_f32 v162, v163, v163
    v_mfma_f32_32x32x16_bf16 v[128:143], v[156:159], v[24:27], v[128:143]
    v_mfma_f32_32x32x16_bf16 v[112:127], v[40:43], v[164:167], v[112:127]
    s_waitcnt lgkmcnt(0)
    v_mfma_f32_32x32x16_bf16 v[48:63], v[32:35], v[16:19], v[48:63]
    ds_read_b64_tr_b16 v[40:41], v12 offset:45056
    ds_read_b64_tr_b16 v[42:43], v12 offset:46080
    ds_read_b128 v[24:27], v7 offset:32768
    ds_read_b128 v[156:159], v160 offset:736
    v_lshlrev_b32 v161, 16, v16
    v_and_b32 v163, 0xffff0000, v16
    v_fmac_f32 v162, v161, v161
    v_fmac_f32 v162, v163, v163
    v_mfma_f32_32x32x16_bf16 v[64:79], v[32:35], v[20:23], v[64:79]
    ds_read_b128 v[28:31], v147 offset:32768
    ds_read_b64_tr_b16 v[44:45], v13 offset:45056
    ds_read_b64_tr_b16 v[46:47], v13 offset:46080
    v_lshlrev_b32 v161, 16, v17
    v_and_b32 v163, 0xffff0000, v17
    v_fmac_f32 v162, v161, v161
    v_fmac_f32 v162, v163, v163
    v_mfma_f32_32x32x16_bf16 v[80:95], v[36:39], v[16:19], v[80:95]
    v_lshlrev_b32 v161, 16, v18
    v_and_b32 v163, 0xffff0000, v18
    v_fmac_f32 v162, v161, v161
    v_fmac_f32 v162, v163, v163
    v_mfma_f32_32x32x16_bf16 v[96:111], v[36:39], v[20:23], v[96:111]
    v_lshlrev_b32 v161, 16, v19
    v_and_b32 v163, 0xffff0000, v19
    v_fmac_f32 v162, v161, v161
    v_fmac_f32 v162, v163, v163
    v_mfma_f32_32x32x16_bf16 v[128:143], v[152:155], v[16:19], v[128:143]
    v_mfma_f32_32x32x16_bf16 v[112:127], v[32:35], v[164:167], v[112:127]
    s_waitcnt lgkmcnt(0)
    v_mfma_f32_32x32x16_bf16 v[48:63], v[40:43], v[24:27], v[48:63]
    s_barrier
    ds_read_b64_tr_b16 v[32:33], v14 offset:0
    ds_read_b64_tr_b16 v[34:35], v14 offset:1024
    ds_read_b128 v[16:19], v8 offset:0
    ds_read_b128 v[152:155], v160 offset:768
    v_lshlrev_b32 v161, 16, v24
    v_and_b32 v163, 0xffff0000, v24
    v_fmac_f32 v162, v161, v161
    v_fmac_f32 v162, v163, v163
    v_mfma_f32_32x32x16_bf16 v[64:79], v[40:43], v[28:31], v[64:79]
    ds_read_b128 v[20:23], v148 offset:0
    ds_read_b64_tr_b16 v[36:37], v15 offset:0
    ds_read_b64_tr_b16 v[38:39], v15 offset:1024
    v_lshlrev_b32 v161, 16, v25
    v_and_b32 v163, 0xffff0000, v25
    v_fmac_f32 v162, v161, v161
    v_fmac_f32 v162, v163, v163
    v_mfma_f32_32x32x16_bf16 v[80:95], v[44:47], v[24:27], v[80:95]
    v_lshlrev_b32 v161, 16, v26
    v_and_b32 v163, 0xffff0000, v26
    v_fmac_f32 v162, v161, v161
    v_fmac_f32 v162, v163, v163
    v_mfma_f32_32x32x16_bf16 v[96:111], v[44:47], v[28:31], v[96:111]
    v_lshlrev_b32 v161, 16, v27
    v_and_b32 v163, 0xffff0000, v27
    v_fmac_f32 v162, v161, v161
    v_fmac_f32 v162, v163, v163
    v_mfma_f32_32x32x16_bf16 v[128:143], v[156:159], v[24:27], v[128:143]
    v_mfma_f32_32x32x16_bf16 v[112:127], v[40:43], v[164:167], v[112:127]
    s_waitcnt lgkmcnt(0)
    v_mfma_f32_32x32x16_bf16 v[48:63], v[32:35], v[16:19], v[48:63]
    ds_read_b64_tr_b16 v[40:41], v14 offset:4096
    ds_read_b64_tr_b16 v[42:43], v14 offset:5120
    ds_read_b128 v[24:27], v9 offset:0
    ds_read_b128 v[156:159], v160 offset:800
    v_lshlrev_b32 v161, 16, v16
    v_and_b32 v163, 0xffff0000, v16
    v_fmac_f32 v162, v161, v161
    v_fmac_f32 v162, v163, v163
    v_mfma_f32_32x32x16_bf16 v[64:79], v[32:35], v[20:23], v[64:79]
    ds_read_b128 v[28:31], v149 offset:0
    ds_read_b64_tr_b16 v[44:45], v15 offset:4096
    ds_read_b64_tr_b16 v[46:47], v15 offset:5120
    v_lshlrev_b32 v161, 16, v17
    v_and_b32 v163, 0xffff0000, v17
    v_fmac_f32 v162, v161, v161
    v_fmac_f32 v162, v163, v163
    v_mfma_f32_32x32x16_bf16 v[80:95], v[36:39], v[16:19], v[80:95]
    v_lshlrev_b32 v161, 16, v18
    v_and_b32 v163, 0xffff0000, v18
    v_fmac_f32 v162, v161, v161
    v_fmac_f32 v162, v163, v163
    v_mfma_f32_32x32x16_bf16 v[96:111], v[36:39], v[20:23], v[96:111]
    v_lshlrev_b32 v161, 16, v19
    v_and_b32 v163, 0xffff0000, v19
    v_fmac_f32 v162, v161, v161
    v_fmac_f32 v162, v163, v163
    v_mfma_f32_32x32x16_bf16 v[128:143], v[152:155], v[16:19], v[128:143]
    v_mfma_f32_32x32x16_bf16 v[112:127], v[32:35], v[164:167], v[112:127]
    s_waitcnt lgkmcnt(0)
    v_mfma_f32_32x32x16_bf16 v[48:63], v[40:43], v[24:27], v[48:63]
    ds_read_b64_tr_b16 v[32:33], v14 offset:8192
    ds_read_b64_tr_b16 v[34:35], v14 offset:9216
    ds_read_b128 v[16:19], v10 offset:0
    ds_read_b128 v[152:155], v160 offset:832
    v_lshlrev_b32 v161, 16, v24
    v_and_b32 v163, 0xffff0000, v24
    v_fmac_f32 v162, v161, v161
    v_fmac_f32 v162, v163, v163
    v_mfma_f32_32x32x16_bf16 v[64:79], v[40:43], v[28:31], v[64:79]
    ds_read_b128 v[20:23], v150 offset:0
    ds_read_b64_tr_b16 v[36:37], v15 offset:8192
    ds_read_b64_tr_b16 v[38:39], v15 offset:9216
    v_lshlrev_b32 v161, 16, v25
    v_and_b32 v163, 0xffff0000, v25
    v_fmac_f32 v162, v161, v161
    v_fmac_f32 v162, v163, v163
    v_mfma_f32_32x32x16_bf16 v[80:95], v[44:47], v[24:27], v[80:95]
    v_lshlrev_b32 v161, 16, v26
    v_and_b32 v163, 0xffff0000, v26
    v_fmac_f32 v162, v161, v161
    v_fmac_f32 v162, v163, v163
    v_mfma_f32_32x32x16_bf16 v[96:111], v[44:47], v[28:31], v[96:111]
    v_lshlrev_b32 v161, 16, v27
    v_and_b32 v163, 0xffff0000, v27
    v_fmac_f32 v162, v161, v161
    v_fmac_f32 v162, v163, v163
    v_mfma_f32_32x32x16_bf16 v[128:143], v[156:159], v[24:27], v[128:143]
    v_mfma_f32_32x32x16_bf16 v[112:127], v[40:43], v[164:167], v[112:127]
    s_waitcnt lgkmcnt(0)
    v_mfma_f32_32x32x16_bf16 v[48:63], v[32:35], v[16:19], v[48:63]
    ds_read_b64_tr_b16 v[40:41], v14 offset:12288
    ds_read_b64_tr_b16 v[42:43], v14 offset:13312
    ds_read_b128 v[24:27], v11 offset:0
    ds_read_b128 v[156:159], v160 offset:864
    v_lshlrev_b32 v161, 16, v16
    v_and_b32 v163, 0xffff0000, v16
    v_fmac_f32 v162, v161, v161
    v_fmac_f32 v162, v163, v163
    v_mfma_f32_32x32x16_bf16 v[64:79], v[32:35], v[20:23], v[64:79]
    ds_read_b128 v[28:31], v151 offset:0
    ds_read_b64_tr_b16 v[44:45], v15 offset:12288
    ds_read_b64_tr_b16 v[46:47], v15 offset:13312
    v_lshlrev_b32 v161, 16, v17
    v_and_b32 v163, 0xffff0000, v17
    v_fmac_f32 v162, v161, v161
    v_fmac_f32 v162, v163, v163
    v_mfma_f32_32x32x16_bf16 v[80:95], v[36:39], v[16:19], v[80:95]
    v_lshlrev_b32 v161, 16, v18
    v_and_b32 v163, 0xffff0000, v18
    v_fmac_f32 v162, v161, v161
    v_fmac_f32 v162, v163, v163
    v_mfma_f32_32x32x16_bf16 v[96:111], v[36:39], v[20:23], v[96:111]
    v_lshlrev_b32 v161, 16, v19
    v_and_b32 v163, 0xffff0000, v19
    v_fmac_f32 v162, v161, v161
    v_fmac_f32 v162, v163, v163
    v_mfma_f32_32x32x16_bf16 v[128:143], v[152:155], v[16:19], v[128:143]
    v_mfma_f32_32x32x16_bf16 v[112:127], v[32:35], v[164:167], v[112:127]
    s_waitcnt lgkmcnt(0)
    v_mfma_f32_32x32x16_bf16 v[48:63], v[40:43], v[24:27], v[48:63]
    s_barrier
    ds_read_b64_tr_b16 v[32:33], v14 offset:32768
    ds_read_b64_tr_b16 v[34:35], v14 offset:33792
    ds_read_b128 v[16:19], v8 offset:32768
    ds_read_b128 v[152:155], v160 offset:896
    v_lshlrev_b32 v161, 16, v24
    v_and_b32 v163, 0xffff0000, v24
    v_fmac_f32 v162, v161, v161
    v_fmac_f32 v162, v163, v163
    v_mfma_f32_32x32x16_bf16 v[64:79], v[40:43], v[28:31], v[64:79]
    ds_read_b128 v[20:23], v148 offset:32768
    ds_read_b64_tr_b16 v[36:37], v15 offset:32768
    ds_read_b64_tr_b16 v[38:39], v15 offset:33792
    v_lshlrev_b32 v161, 16, v25
    v_and_b32 v163, 0xffff0000, v25
    v_fmac_f32 v162, v161, v161
    v_fmac_f32 v162, v163, v163
    v_mfma_f32_32x32x16_bf16 v[80:95], v[44:47], v[24:27], v[80:95]
    v_lshlrev_b32 v161, 16, v26
    v_and_b32 v163, 0xffff0000, v26
    v_fmac_f32 v162, v161, v161
    v_fmac_f32 v162, v163, v163
    v_mfma_f32_32x32x16_bf16 v[96:111], v[44:47], v[28:31], v[96:111]
    v_lshlrev_b32 v161, 16, v27
    v_and_b32 v163, 0xffff0000, v27
    v_fmac_f32 v162, v161, v161
    v_fmac_f32 v162, v163, v163
    v_mfma_f32_32x32x16_bf16 v[128:143], v[156:159], v[24:27], v[128:143]
    v_mfma_f32_32x32x16_bf16 v[112:127], v[40:43], v[164:167], v[112:127]
    s_waitcnt lgkmcnt(0)
    v_mfma_f32_32x32x16_bf16 v[48:63], v[32:35], v[16:19], v[48:63]
    ds_read_b64_tr_b16 v[40:41], v14 offset:36864
    ds_read_b64_tr_b16 v[42:43], v14 offset:37888
    ds_read_b128 v[24:27], v9 offset:32768
    ds_read_b128 v[156:159], v160 offset:928
    v_lshlrev_b32 v161, 16, v16
    v_and_b32 v163, 0xffff0000, v16
    v_fmac_f32 v162, v161, v161
    v_fmac_f32 v162, v163, v163
    v_mfma_f32_32x32x16_bf16 v[64:79], v[32:35], v[20:23], v[64:79]
    ds_read_b128 v[28:31], v149 offset:32768
    ds_read_b64_tr_b16 v[44:45], v15 offset:36864
    ds_read_b64_tr_b16 v[46:47], v15 offset:37888
    v_lshlrev_b32 v161, 16, v17
    v_and_b32 v163, 0xffff0000, v17
    v_fmac_f32 v162, v161, v161
    v_fmac_f32 v162, v163, v163
    v_mfma_f32_32x32x16_bf16 v[80:95], v[36:39], v[16:19], v[80:95]
    v_lshlrev_b32 v161, 16, v18
    v_and_b32 v163, 0xffff0000, v18
    v_fmac_f32 v162, v161, v161
    v_fmac_f32 v162, v163, v163
    v_mfma_f32_32x32x16_bf16 v[96:111], v[36:39], v[20:23], v[96:111]
    v_lshlrev_b32 v161, 16, v19
    v_and_b32 v163, 0xffff0000, v19
    v_fmac_f32 v162, v161, v161
    v_fmac_f32 v162, v163, v163
    v_mfma_f32_32x32x16_bf16 v[128:143], v[152:155], v[16:19], v[128:143]
    v_mfma_f32_32x32x16_bf16 v[112:127], v[32:35], v[164:167], v[112:127]
    s_waitcnt lgkmcnt(0)
    v_mfma_f32_32x32x16_bf16 v[48:63], v[40:43], v[24:27], v[48:63]
    ds_read_b64_tr_b16 v[32:33], v14 offset:40960
    ds_read_b64_tr_b16 v[34:35], v14 offset:41984
    ds_read_b128 v[16:19], v10 offset:32768
    ds_read_b128 v[152:155], v160 offset:960
    v_lshlrev_b32 v161, 16, v24
    v_and_b32 v163, 0xffff0000, v24
    v_fmac_f32 v162, v161, v161
    v_fmac_f32 v162, v163, v163
    v_mfma_f32_32x32x16_bf16 v[64:79], v[40:43], v[28:31], v[64:79]
    ds_read_b128 v[20:23], v150 offset:32768
    ds_read_b64_tr_b16 v[36:37], v15 offset:40960
    ds_read_b64_tr_b16 v[38:39], v15 offset:41984
    v_lshlrev_b32 v161, 16, v25
    v_and_b32 v163, 0xffff0000, v25
    v_fmac_f32 v162, v161, v161
    v_fmac_f32 v162, v163, v163
    v_mfma_f32_32x32x16_bf16 v[80:95], v[44:47], v[24:27], v[80:95]
    v_lshlrev_b32 v161, 16, v26
    v_and_b32 v163, 0xffff0000, v26
    v_fmac_f32 v162, v161, v161
    v_fmac_f32 v162, v163, v163
    v_mfma_f32_32x32x16_bf16 v[96:111], v[44:47], v[28:31], v[96:111]
    v_lshlrev_b32 v161, 16, v27
    v_and_b32 v163, 0xffff0000, v27
    v_fmac_f32 v162, v161, v161
    v_fmac_f32 v162, v163, v163
    v_mfma_f32_32x32x16_bf16 v[128:143], v[156:159], v[24:27], v[128:143]
    v_mfma_f32_32x32x16_bf16 v[112:127], v[40:43], v[164:167], v[112:127]
    s_waitcnt lgkmcnt(0)
    v_mfma_f32_32x32x16_bf16 v[48:63], v[32:35], v[16:19], v[48:63]
    ds_read_b64_tr_b16 v[40:41], v14 offset:45056
    ds_read_b64_tr_b16 v[42:43], v14 offset:46080
    ds_read_b128 v[24:27], v11 offset:32768
    ds_read_b128 v[156:159], v160 offset:992
    v_lshlrev_b32 v161, 16, v16
    v_and_b32 v163, 0xffff0000, v16
    v_fmac_f32 v162, v161, v161
    v_fmac_f32 v162, v163, v163
    v_mfma_f32_32x32x16_bf16 v[64:79], v[32:35], v[20:23], v[64:79]
    ds_read_b128 v[28:31], v151 offset:32768
    ds_read_b64_tr_b16 v[44:45], v15 offset:45056
    ds_read_b64_tr_b16 v[46:47], v15 offset:46080
    v_lshlrev_b32 v161, 16, v17
    v_and_b32 v163, 0xffff0000, v17
    v_fmac_f32 v162, v161, v161
    v_fmac_f32 v162, v163, v163
    v_mfma_f32_32x32x16_bf16 v[80:95], v[36:39], v[16:19], v[80:95]
    v_lshlrev_b32 v161, 16, v18
    v_and_b32 v163, 0xffff0000, v18
    v_fmac_f32 v162, v161, v161
    v_fmac_f32 v162, v163, v163
    v_mfma_f32_32x32x16_bf16 v[96:111], v[36:39], v[20:23], v[96:111]
    v_lshlrev_b32 v161, 16, v19
    v_and_b32 v163, 0xffff0000, v19
    v_fmac_f32 v162, v161, v161
    v_fmac_f32 v162, v163, v163
    v_mfma_f32_32x32x16_bf16 v[128:143], v[152:155], v[16:19], v[128:143]
    v_mfma_f32_32x32x16_bf16 v[112:127], v[32:35], v[164:167], v[112:127]
    s_waitcnt lgkmcnt(0)
    v_mfma_f32_32x32x16_bf16 v[48:63], v[40:43], v[24:27], v[48:63]
    v_lshlrev_b32 v161, 16, v24
    v_and_b32 v163, 0xffff0000, v24
    v_fmac_f32 v162, v161, v161
    v_fmac_f32 v162, v163, v163
    v_mfma_f32_32x32x16_bf16 v[64:79], v[40:43], v[28:31], v[64:79]
    v_lshlrev_b32 v161, 16, v25
    v_and_b32 v163, 0xffff0000, v25
    v_fmac_f32 v162, v161, v161
    v_fmac_f32 v162, v163, v163
    v_mfma_f32_32x32x16_bf16 v[80:95], v[44:47], v[24:27], v[80:95]
    v_lshlrev_b32 v161, 16, v26
    v_and_b32 v163, 0xffff0000, v26
    v_fmac_f32 v162, v161, v161
    v_fmac_f32 v162, v163, v163
    v_mfma_f32_32x32x16_bf16 v[96:111], v[44:47], v[28:31], v[96:111]
    v_lshlrev_b32 v161, 16, v27
    v_and_b32 v163, 0xffff0000, v27
    v_fmac_f32 v162, v161, v161
    v_fmac_f32 v162, v163, v163
    v_mfma_f32_32x32x16_bf16 v[128:143], v[156:159], v[24:27], v[128:143]
    v_mfma_f32_32x32x16_bf16 v[112:127], v[40:43], v[164:167], v[112:127]
    s_waitcnt vmcnt(0)
    s_nop 11
    s_lshl_b32 s40, s53, 8
    s_lshl_b32 s41, s52, 7
    s_add_u32 s40, s40, s41
    s_add_u32 s40, s40, 133120
    v_lshlrev_b32 v161, 4, v3
    v_add_u32 v161, s40, v161
    s_mov_b32 exec_lo, 1
    s_mov_b32 exec_hi, 1
    ds_write_b128 v161, v[112:115] offset:0
    ds_write_b128 v161, v[116:119] offset:32
    ds_write_b128 v161, v[120:123] offset:64
    ds_write_b128 v161, v[124:127] offset:96
    s_mov_b64 exec, -1
    v_mov_b32 v42, v128
    v_mov_b32 v44, v129
    s_waitcnt lgkmcnt(0)
    v_mov_b32 v112, v42
    s_nop 1
    v_permlane32_swap_b32 v112, v42
    v_add_f32 v42, v42, v112
    v_mov_b32 v112, v162
    s_nop 1
    v_permlane32_swap_b32 v112, v162
    v_add_f32 v162, v162, v112
    v_mov_b32 v112, v44
    s_nop 1
    v_permlane32_swap_b32 v112, v44
    v_add_f32 v44, v44, v112
    s_add_u32 s24, s28, 0x1c00000
    s_addc_u32 s25, s29, 0
    s_mov_b32 s26, 0x2000
    s_mov_b32 s27, 0x20000
    v_mul_f32 v42, 0x3b000000, v42
    v_mul_f32 v162, 0x3b000000, v162
    v_fma_f32 v162, -v42, v42, v162
    v_max_f32 v162, 0, v162
    v_add_f32 v162, 0x3727c5ac, v162
    v_rsq_f32 v43, v162
    v_mul_f32 v44, 0xbfb8aa3b, v44
    v_exp_f32 v44, v44
    s_lshl_b32 s40, s52, 1
    s_add_u32 s40, s40, s53
    s_lshl_b32 s40, s40, 5
    v_add_u32 v112, s40, v2
    v_add_f32 v44, 1.0, v44
    v_rcp_f32 v44, v44
    v_lshlrev_b32 v113, 3, v112
    v_add_u32 v113, 132096, v113
    v_lshlrev_b32 v114, 2, v112
    s_lshl_b32 s40, s34, 9
    s_mov_b32 exec_hi, 0
    ds_write_b64 v113, v[42:43]
    buffer_store_dword v44, v114, s[24:27], s40 offen
    s_mov_b64 exec, -1
    s_waitcnt lgkmcnt(0)
    s_barrier
    s_add_u32 s16, s28, 0x600000
    s_addc_u32 s17, s29, 0
    s_mov_b32 s18, 0x200000
    s_mov_b32 s19, 0x20000
    ds_read_b64 v[16:17], v113
    v_xor_b32 v113, 0x100, v113
    ds_read_b64 v[18:19], v113
    s_lshl_b32 s41, s53, 8
    s_lshl_b32 s42, s52, 7
    s_add_u32 s41, s41, s42
    s_add_u32 s41, s41, 133120
    v_lshlrev_b32 v114, 4, v3
    v_add_u32 v114, s41, v114
    v_xor_b32 v115, 0x80, v114
    v_mov_b32 v40, 0xc0135761
    v_mov_b32 v41, 0xc0135761
    s_mov_b32 s48, 0xbdd2d3e8
    s_mov_b32 s49, 0xbdd2d3e8
    s_sub_u32 s41, s35, 12
    s_lshr_b32 s42, s41, 1
    s_add_u32 s42, s42, 1
    s_sub_u32 s40, 0, s42
    s_bitcmp1_b32 s41, 0
    s_cselect_b32 s42, s40, s42
    s_lshl_b32 s40, s34, 7
    s_add_u32 s40, s40, s42
    s_lshl_b32 s41, s41, 3
    s_lshl_b32 s42, s53, 2
    s_add_u32 s41, s41, s42
    s_lshl_b32 s42, s52, 1
    s_add_u32 s41, s41, s42
    s_lshl_b32 s47, s41, 10
    s_xor_b32 s58, s47, 0x800
    v_add_u32 v112, s40, v112
    s_lshl_b32 s40, s53, 6
    s_sub_u32 s40, 32, s40
    v_mov_b32 v116, v112
    v_cmp_gt_u32 vcc, 0x800, v116
    s_mov_b64 s[54:55], vcc
    v_and_b32 v116, 0x7ff, v116
    v_lshrrev_b32 v117, 5, v116
    v_lshlrev_b32 v117, 15, v117
    v_and_b32 v116, 31, v116
    v_lshl_add_u32 v116, v3, 5, v116
    v_lshl_add_u32 v36, v116, 4, v117
    v_add_u32 v116, s40, v112
    v_cmp_gt_u32 vcc, 0x800, v116
    s_mov_b64 s[56:57], vcc
    v_and_b32 v116, 0x7ff, v116
    v_lshrrev_b32 v117, 5, v116
    v_lshlrev_b32 v117, 15, v117
    v_and_b32 v116, 31, v116
    v_lshl_add_u32 v116, v3, 5, v116
    v_lshl_add_u32 v37, v116, 4, v117
    ds_read_b128 v[20:23], v114 offset:0
    ds_read_b128 v[24:27], v114 offset:32
    ds_read_b128 v[28:31], v114 offset:64
    ds_read_b128 v[32:35], v114 offset:96
    s_waitcnt lgkmcnt(0)
    v_cndmask_b32 v17, 0, v17, s[54:55]
    v_cndmask_b32 v19, 0, v19, s[56:57]
    v_pk_fma_f32 v[48:49], v[16:17], v[20:21], v[48:49] op_sel_hi:[0,1,1] neg_lo:[1,0,0] neg_hi:[1,0,0]
    v_pk_fma_f32 v[50:51], v[16:17], v[22:23], v[50:51] op_sel_hi:[0,1,1] neg_lo:[1,0,0] neg_hi:[1,0,0]
    v_pk_fma_f32 v[52:53], v[16:17], v[24:25], v[52:53] op_sel_hi:[0,1,1] neg_lo:[1,0,0] neg_hi:[1,0,0]
    v_pk_fma_f32 v[54:55], v[16:17], v[26:27], v[54:55] op_sel_hi:[0,1,1] neg_lo:[1,0,0] neg_hi:[1,0,0]
    v_pk_fma_f32 v[56:57], v[16:17], v[28:29], v[56:57] op_sel_hi:[0,1,1] neg_lo:[1,0,0] neg_hi:[1,0,0]
    v_pk_fma_f32 v[58:59], v[16:17], v[30:31], v[58:59] op_sel_hi:[0,1,1] neg_lo:[1,0,0] neg_hi:[1,0,0]
    v_pk_fma_f32 v[60:61], v[16:17], v[32:33], v[60:61] op_sel_hi:[0,1,1] neg_lo:[1,0,0] neg_hi:[1,0,0]
    v_pk_fma_f32 v[62:63], v[16:17], v[34:35], v[62:63] op_sel_hi:[0,1,1] neg_lo:[1,0,0] neg_hi:[1,0,0]
    v_pk_mul_f32 v[48:49], v[48:49], v[16:17] op_sel:[0,1] op_sel_hi:[1,1]
    v_pk_mul_f32 v[50:51], v[50:51], v[16:17] op_sel:[0,1] op_sel_hi:[1,1]
    v_pk_mul_f32 v[52:53], v[52:53], v[16:17] op_sel:[0,1] op_sel_hi:[1,1]
    v_pk_mul_f32 v[54:55], v[54:55], v[16:17] op_sel:[0,1] op_sel_hi:[1,1]
    v_pk_mul_f32 v[56:57], v[56:57], v[16:17] op_sel:[0,1] op_sel_hi:[1,1]
    v_pk_mul_f32 v[58:59], v[58:59], v[16:17] op_sel:[0,1] op_sel_hi:[1,1]
    v_pk_mul_f32 v[60:61], v[60:61], v[16:17] op_sel:[0,1] op_sel_hi:[1,1]
    v_pk_mul_f32 v[62:63], v[62:63], v[16:17] op_sel:[0,1] op_sel_hi:[1,1]
    v_pk_mul_f32 v[120:121], v[48:49], v[48:49]
    v_pk_mul_f32 v[122:123], v[50:51], v[50:51]
    v_pk_mul_f32 v[124:125], v[52:53], v[52:53]
    v_pk_mul_f32 v[126:127], v[54:55], v[54:55]
    v_pk_mul_f32 v[128:129], v[56:57], v[56:57]
    v_pk_mul_f32 v[130:131], v[58:59], v[58:59]
    v_pk_mul_f32 v[132:133], v[60:61], v[60:61]
    v_pk_mul_f32 v[134:135], v[62:63], v[62:63]
    v_pk_fma_f32 v[120:121], v[120:121], s[48:49], v[40:41]
    v_pk_fma_f32 v[122:123], v[122:123], s[48:49], v[40:41]
    v_pk_fma_f32 v[124:125], v[124:125], s[48:49], v[40:41]
    v_pk_fma_f32 v[126:127], v[126:127], s[48:49], v[40:41]
    v_pk_fma_f32 v[128:129], v[128:129], s[48:49], v[40:41]
    v_pk_fma_f32 v[130:131], v[130:131], s[48:49], v[40:41]
    v_pk_fma_f32 v[132:133], v[132:133], s[48:49], v[40:41]
    v_pk_fma_f32 v[134:135], v[134:135], s[48:49], v[40:41]
    v_pk_mul_f32 v[120:121], v[120:121], v[48:49]
    v_pk_mul_f32 v[122:123], v[122:123], v[50:51]
    v_pk_mul_f32 v[124:125], v[124:125], v[52:53]
    v_pk_mul_f32 v[126:127], v[126:127], v[54:55]
    v_pk_mul_f32 v[128:129], v[128:129], v[56:57]
    v_pk_mul_f32 v[130:131], v[130:131], v[58:59]
    v_pk_mul_f32 v[132:133], v[132:133], v[60:61]
    v_pk_mul_f32 v[134:135], v[134:135], v[62:63]
    v_exp_f32 v120, v120
    v_exp_f32 v121, v121
    v_exp_f32 v122, v122
    v_exp_f32 v123, v123
    v_exp_f32 v124, v124
    v_exp_f32 v125, v125
    v_exp_f32 v126, v126
    v_exp_f32 v127, v127
    v_exp_f32 v128, v128
    v_exp_f32 v129, v129
    v_exp_f32 v130, v130
    v_exp_f32 v131, v131
    v_exp_f32 v132, v132
    v_exp_f32 v133, v133
    v_exp_f32 v134, v134
    v_exp_f32 v135, v135
    v_pk_add_f32 v[120:121], v[120:121], 1.0 op_sel_hi:[1,0]
    v_pk_add_f32 v[122:123], v[122:123], 1.0 op_sel_hi:[1,0]
    v_pk_add_f32 v[124:125], v[124:125], 1.0 op_sel_hi:[1,0]
    v_pk_add_f32 v[126:127], v[126:127], 1.0 op_sel_hi:[1,0]
    v_pk_add_f32 v[128:129], v[128:129], 1.0 op_sel_hi:[1,0]
    v_pk_add_f32 v[130:131], v[130:131], 1.0 op_sel_hi:[1,0]
    v_pk_add_f32 v[132:133], v[132:133], 1.0 op_sel_hi:[1,0]
    v_pk_add_f32 v[134:135], v[134:135], 1.0 op_sel_hi:[1,0]
    v_rcp_f32 v120, v120
    v_rcp_f32 v121, v121
    v_rcp_f32 v122, v122
    v_rcp_f32 v123, v123
    v_rcp_f32 v124, v124
    v_rcp_f32 v125, v125
    v_rcp_f32 v126, v126
    v_rcp_f32 v127, v127
    v_rcp_f32 v128, v128
    v_rcp_f32 v129, v129
    v_rcp_f32 v130, v130
    v_rcp_f32 v131, v131
    v_rcp_f32 v132, v132
    v_rcp_f32 v133, v133
    v_rcp_f32 v134, v134
    v_rcp_f32 v135, v135
    v_pk_mul_f32 v[48:49], v[48:49], v[120:121]
    v_pk_mul_f32 v[50:51], v[50:51], v[122:123]
    v_pk_mul_f32 v[52:53], v[52:53], v[124:125]
    v_pk_mul_f32 v[54:55], v[54:55], v[126:127]
    v_pk_mul_f32 v[56:57], v[56:57], v[128:129]
    v_pk_mul_f32 v[58:59], v[58:59], v[130:131]
    v_pk_mul_f32 v[60:61], v[60:61], v[132:133]
    v_pk_mul_f32 v[62:63], v[62:63], v[134:135]
    v_cvt_pk_bf16_f32 v136, v48, v49
    v_cvt_pk_bf16_f32 v137, v50, v51
    v_cvt_pk_bf16_f32 v138, v52, v53
    v_cvt_pk_bf16_f32 v139, v54, v55
    s_add_u32 s40, s47, 0
    buffer_store_dwordx4 v[136:139], v36, s[16:19], s40 offen sc1
    v_cvt_pk_bf16_f32 v140, v56, v57
    v_cvt_pk_bf16_f32 v141, v58, v59
    v_cvt_pk_bf16_f32 v142, v60, v61
    v_cvt_pk_bf16_f32 v143, v62, v63
    s_add_u32 s40, s47, 1024
    buffer_store_dwordx4 v[140:143], v36, s[16:19], s40 offen sc1
    v_pk_fma_f32 v[64:65], v[18:19], v[20:21], v[64:65] op_sel_hi:[0,1,1] neg_lo:[1,0,0] neg_hi:[1,0,0]
    v_pk_fma_f32 v[66:67], v[18:19], v[22:23], v[66:67] op_sel_hi:[0,1,1] neg_lo:[1,0,0] neg_hi:[1,0,0]
    v_pk_fma_f32 v[68:69], v[18:19], v[24:25], v[68:69] op_sel_hi:[0,1,1] neg_lo:[1,0,0] neg_hi:[1,0,0]
    v_pk_fma_f32 v[70:71], v[18:19], v[26:27], v[70:71] op_sel_hi:[0,1,1] neg_lo:[1,0,0] neg_hi:[1,0,0]
    v_pk_fma_f32 v[72:73], v[18:19], v[28:29], v[72:73] op_sel_hi:[0,1,1] neg_lo:[1,0,0] neg_hi:[1,0,0]
    v_pk_fma_f32 v[74:75], v[18:19], v[30:31], v[74:75] op_sel_hi:[0,1,1] neg_lo:[1,0,0] neg_hi:[1,0,0]
    v_pk_fma_f32 v[76:77], v[18:19], v[32:33], v[76:77] op_sel_hi:[0,1,1] neg_lo:[1,0,0] neg_hi:[1,0,0]
    v_pk_fma_f32 v[78:79], v[18:19], v[34:35], v[78:79] op_sel_hi:[0,1,1] neg_lo:[1,0,0] neg_hi:[1,0,0]
    v_pk_mul_f32 v[64:65], v[64:65], v[18:19] op_sel:[0,1] op_sel_hi:[1,1]
    v_pk_mul_f32 v[66:67], v[66:67], v[18:19] op_sel:[0,1] op_sel_hi:[1,1]
    v_pk_mul_f32 v[68:69], v[68:69], v[18:19] op_sel:[0,1] op_sel_hi:[1,1]
    v_pk_mul_f32 v[70:71], v[70:71], v[18:19] op_sel:[0,1] op_sel_hi:[1,1]
    v_pk_mul_f32 v[72:73], v[72:73], v[18:19] op_sel:[0,1] op_sel_hi:[1,1]
    v_pk_mul_f32 v[74:75], v[74:75], v[18:19] op_sel:[0,1] op_sel_hi:[1,1]
    v_pk_mul_f32 v[76:77], v[76:77], v[18:19] op_sel:[0,1] op_sel_hi:[1,1]
    v_pk_mul_f32 v[78:79], v[78:79], v[18:19] op_sel:[0,1] op_sel_hi:[1,1]
    v_pk_mul_f32 v[120:121], v[64:65], v[64:65]
    v_pk_mul_f32 v[122:123], v[66:67], v[66:67]
    v_pk_mul_f32 v[124:125], v[68:69], v[68:69]
    v_pk_mul_f32 v[126:127], v[70:71], v[70:71]
    v_pk_mul_f32 v[128:129], v[72:73], v[72:73]
    v_pk_mul_f32 v[130:131], v[74:75], v[74:75]
    v_pk_mul_f32 v[132:133], v[76:77], v[76:77]
    v_pk_mul_f32 v[134:135], v[78:79], v[78:79]
    v_pk_fma_f32 v[120:121], v[120:121], s[48:49], v[40:41]
    v_pk_fma_f32 v[122:123], v[122:123], s[48:49], v[40:41]
    v_pk_fma_f32 v[124:125], v[124:125], s[48:49], v[40:41]
    v_pk_fma_f32 v[126:127], v[126:127], s[48:49], v[40:41]
    v_pk_fma_f32 v[128:129], v[128:129], s[48:49], v[40:41]
    v_pk_fma_f32 v[130:131], v[130:131], s[48:49], v[40:41]
    v_pk_fma_f32 v[132:133], v[132:133], s[48:49], v[40:41]
    v_pk_fma_f32 v[134:135], v[134:135], s[48:49], v[40:41]
    v_pk_mul_f32 v[120:121], v[120:121], v[64:65]
    v_pk_mul_f32 v[122:123], v[122:123], v[66:67]
    v_pk_mul_f32 v[124:125], v[124:125], v[68:69]
    v_pk_mul_f32 v[126:127], v[126:127], v[70:71]
    v_pk_mul_f32 v[128:129], v[128:129], v[72:73]
    v_pk_mul_f32 v[130:131], v[130:131], v[74:75]
    v_pk_mul_f32 v[132:133], v[132:133], v[76:77]
    v_pk_mul_f32 v[134:135], v[134:135], v[78:79]
    v_exp_f32 v120, v120
    v_exp_f32 v121, v121
    v_exp_f32 v122, v122
    v_exp_f32 v123, v123
    v_exp_f32 v124, v124
    v_exp_f32 v125, v125
    v_exp_f32 v126, v126
    v_exp_f32 v127, v127
    v_exp_f32 v128, v128
    v_exp_f32 v129, v129
    v_exp_f32 v130, v130
    v_exp_f32 v131, v131
    v_exp_f32 v132, v132
    v_exp_f32 v133, v133
    v_exp_f32 v134, v134
    v_exp_f32 v135, v135
    v_pk_add_f32 v[120:121], v[120:121], 1.0 op_sel_hi:[1,0]
    v_pk_add_f32 v[122:123], v[122:123], 1.0 op_sel_hi:[1,0]
    v_pk_add_f32 v[124:125], v[124:125], 1.0 op_sel_hi:[1,0]
    v_pk_add_f32 v[126:127], v[126:127], 1.0 op_sel_hi:[1,0]
    v_pk_add_f32 v[128:129], v[128:129], 1.0 op_sel_hi:[1,0]
    v_pk_add_f32 v[130:131], v[130:131], 1.0 op_sel_hi:[1,0]
    v_pk_add_f32 v[132:133], v[132:133], 1.0 op_sel_hi:[1,0]
    v_pk_add_f32 v[134:135], v[134:135], 1.0 op_sel_hi:[1,0]
    v_rcp_f32 v120, v120
    v_rcp_f32 v121, v121
    v_rcp_f32 v122, v122
    v_rcp_f32 v123, v123
    v_rcp_f32 v124, v124
    v_rcp_f32 v125, v125
    v_rcp_f32 v126, v126
    v_rcp_f32 v127, v127
    v_rcp_f32 v128, v128
    v_rcp_f32 v129, v129
    v_rcp_f32 v130, v130
    v_rcp_f32 v131, v131
    v_rcp_f32 v132, v132
    v_rcp_f32 v133, v133
    v_rcp_f32 v134, v134
    v_rcp_f32 v135, v135
    v_pk_mul_f32 v[64:65], v[64:65], v[120:121]
    v_pk_mul_f32 v[66:67], v[66:67], v[122:123]
    v_pk_mul_f32 v[68:69], v[68:69], v[124:125]
    v_pk_mul_f32 v[70:71], v[70:71], v[126:127]
    v_pk_mul_f32 v[72:73], v[72:73], v[128:129]
    v_pk_mul_f32 v[74:75], v[74:75], v[130:131]
    v_pk_mul_f32 v[76:77], v[76:77], v[132:133]
    v_pk_mul_f32 v[78:79], v[78:79], v[134:135]
    v_cvt_pk_bf16_f32 v136, v64, v65
    v_cvt_pk_bf16_f32 v137, v66, v67
    v_cvt_pk_bf16_f32 v138, v68, v69
    v_cvt_pk_bf16_f32 v139, v70, v71
    s_add_u32 s40, s47, 0
    buffer_store_dwordx4 v[136:139], v37, s[16:19], s40 offen sc1
    v_cvt_pk_bf16_f32 v140, v72, v73
    v_cvt_pk_bf16_f32 v141, v74, v75
    v_cvt_pk_bf16_f32 v142, v76, v77
    v_cvt_pk_bf16_f32 v143, v78, v79
    s_add_u32 s40, s47, 1024
    buffer_store_dwordx4 v[140:143], v37, s[16:19], s40 offen sc1
    ds_read_b128 v[20:23], v115 offset:0
    ds_read_b128 v[24:27], v115 offset:32
    ds_read_b128 v[28:31], v115 offset:64
    ds_read_b128 v[32:35], v115 offset:96
    s_waitcnt lgkmcnt(0)
    v_pk_fma_f32 v[80:81], v[16:17], v[20:21], v[80:81] op_sel_hi:[0,1,1] neg_lo:[1,0,0] neg_hi:[1,0,0]
    v_pk_fma_f32 v[82:83], v[16:17], v[22:23], v[82:83] op_sel_hi:[0,1,1] neg_lo:[1,0,0] neg_hi:[1,0,0]
    v_pk_fma_f32 v[84:85], v[16:17], v[24:25], v[84:85] op_sel_hi:[0,1,1] neg_lo:[1,0,0] neg_hi:[1,0,0]
    v_pk_fma_f32 v[86:87], v[16:17], v[26:27], v[86:87] op_sel_hi:[0,1,1] neg_lo:[1,0,0] neg_hi:[1,0,0]
    v_pk_fma_f32 v[88:89], v[16:17], v[28:29], v[88:89] op_sel_hi:[0,1,1] neg_lo:[1,0,0] neg_hi:[1,0,0]
    v_pk_fma_f32 v[90:91], v[16:17], v[30:31], v[90:91] op_sel_hi:[0,1,1] neg_lo:[1,0,0] neg_hi:[1,0,0]
    v_pk_fma_f32 v[92:93], v[16:17], v[32:33], v[92:93] op_sel_hi:[0,1,1] neg_lo:[1,0,0] neg_hi:[1,0,0]
    v_pk_fma_f32 v[94:95], v[16:17], v[34:35], v[94:95] op_sel_hi:[0,1,1] neg_lo:[1,0,0] neg_hi:[1,0,0]
    v_pk_mul_f32 v[80:81], v[80:81], v[16:17] op_sel:[0,1] op_sel_hi:[1,1]
    v_pk_mul_f32 v[82:83], v[82:83], v[16:17] op_sel:[0,1] op_sel_hi:[1,1]
    v_pk_mul_f32 v[84:85], v[84:85], v[16:17] op_sel:[0,1] op_sel_hi:[1,1]
    v_pk_mul_f32 v[86:87], v[86:87], v[16:17] op_sel:[0,1] op_sel_hi:[1,1]
    v_pk_mul_f32 v[88:89], v[88:89], v[16:17] op_sel:[0,1] op_sel_hi:[1,1]
    v_pk_mul_f32 v[90:91], v[90:91], v[16:17] op_sel:[0,1] op_sel_hi:[1,1]
    v_pk_mul_f32 v[92:93], v[92:93], v[16:17] op_sel:[0,1] op_sel_hi:[1,1]
    v_pk_mul_f32 v[94:95], v[94:95], v[16:17] op_sel:[0,1] op_sel_hi:[1,1]
    v_pk_mul_f32 v[120:121], v[80:81], v[80:81]
    v_pk_mul_f32 v[122:123], v[82:83], v[82:83]
    v_pk_mul_f32 v[124:125], v[84:85], v[84:85]
    v_pk_mul_f32 v[126:127], v[86:87], v[86:87]
    v_pk_mul_f32 v[128:129], v[88:89], v[88:89]
    v_pk_mul_f32 v[130:131], v[90:91], v[90:91]
    v_pk_mul_f32 v[132:133], v[92:93], v[92:93]
    v_pk_mul_f32 v[134:135], v[94:95], v[94:95]
    v_pk_fma_f32 v[120:121], v[120:121], s[48:49], v[40:41]
    v_pk_fma_f32 v[122:123], v[122:123], s[48:49], v[40:41]
    v_pk_fma_f32 v[124:125], v[124:125], s[48:49], v[40:41]
    v_pk_fma_f32 v[126:127], v[126:127], s[48:49], v[40:41]
    v_pk_fma_f32 v[128:129], v[128:129], s[48:49], v[40:41]
    v_pk_fma_f32 v[130:131], v[130:131], s[48:49], v[40:41]
    v_pk_fma_f32 v[132:133], v[132:133], s[48:49], v[40:41]
    v_pk_fma_f32 v[134:135], v[134:135], s[48:49], v[40:41]
    v_pk_mul_f32 v[120:121], v[120:121], v[80:81]
    v_pk_mul_f32 v[122:123], v[122:123], v[82:83]
    v_pk_mul_f32 v[124:125], v[124:125], v[84:85]
    v_pk_mul_f32 v[126:127], v[126:127], v[86:87]
    v_pk_mul_f32 v[128:129], v[128:129], v[88:89]
    v_pk_mul_f32 v[130:131], v[130:131], v[90:91]
    v_pk_mul_f32 v[132:133], v[132:133], v[92:93]
    v_pk_mul_f32 v[134:135], v[134:135], v[94:95]
    v_exp_f32 v120, v120
    v_exp_f32 v121, v121
    v_exp_f32 v122, v122
    v_exp_f32 v123, v123
    v_exp_f32 v124, v124
    v_exp_f32 v125, v125
    v_exp_f32 v126, v126
    v_exp_f32 v127, v127
    v_exp_f32 v128, v128
    v_exp_f32 v129, v129
    v_exp_f32 v130, v130
    v_exp_f32 v131, v131
    v_exp_f32 v132, v132
    v_exp_f32 v133, v133
    v_exp_f32 v134, v134
    v_exp_f32 v135, v135
    v_pk_add_f32 v[120:121], v[120:121], 1.0 op_sel_hi:[1,0]
    v_pk_add_f32 v[122:123], v[122:123], 1.0 op_sel_hi:[1,0]
    v_pk_add_f32 v[124:125], v[124:125], 1.0 op_sel_hi:[1,0]
    v_pk_add_f32 v[126:127], v[126:127], 1.0 op_sel_hi:[1,0]
    v_pk_add_f32 v[128:129], v[128:129], 1.0 op_sel_hi:[1,0]
    v_pk_add_f32 v[130:131], v[130:131], 1.0 op_sel_hi:[1,0]
    v_pk_add_f32 v[132:133], v[132:133], 1.0 op_sel_hi:[1,0]
    v_pk_add_f32 v[134:135], v[134:135], 1.0 op_sel_hi:[1,0]
    v_rcp_f32 v120, v120
    v_rcp_f32 v121, v121
    v_rcp_f32 v122, v122
    v_rcp_f32 v123, v123
    v_rcp_f32 v124, v124
    v_rcp_f32 v125, v125
    v_rcp_f32 v126, v126
    v_rcp_f32 v127, v127
    v_rcp_f32 v128, v128
    v_rcp_f32 v129, v129
    v_rcp_f32 v130, v130
    v_rcp_f32 v131, v131
    v_rcp_f32 v132, v132
    v_rcp_f32 v133, v133
    v_rcp_f32 v134, v134
    v_rcp_f32 v135, v135
    v_pk_mul_f32 v[80:81], v[80:81], v[120:121]
    v_pk_mul_f32 v[82:83], v[82:83], v[122:123]
    v_pk_mul_f32 v[84:85], v[84:85], v[124:125]
    v_pk_mul_f32 v[86:87], v[86:87], v[126:127]
    v_pk_mul_f32 v[88:89], v[88:89], v[128:129]
    v_pk_mul_f32 v[90:91], v[90:91], v[130:131]
    v_pk_mul_f32 v[92:93], v[92:93], v[132:133]
    v_pk_mul_f32 v[94:95], v[94:95], v[134:135]
    v_cvt_pk_bf16_f32 v136, v80, v81
    v_cvt_pk_bf16_f32 v137, v82, v83
    v_cvt_pk_bf16_f32 v138, v84, v85
    v_cvt_pk_bf16_f32 v139, v86, v87
    s_add_u32 s40, s58, 0
    buffer_store_dwordx4 v[136:139], v36, s[16:19], s40 offen sc1
    v_cvt_pk_bf16_f32 v140, v88, v89
    v_cvt_pk_bf16_f32 v141, v90, v91
    v_cvt_pk_bf16_f32 v142, v92, v93
    v_cvt_pk_bf16_f32 v143, v94, v95
    s_add_u32 s40, s58, 1024
    buffer_store_dwordx4 v[140:143], v36, s[16:19], s40 offen sc1
    v_pk_fma_f32 v[96:97], v[18:19], v[20:21], v[96:97] op_sel_hi:[0,1,1] neg_lo:[1,0,0] neg_hi:[1,0,0]
    v_pk_fma_f32 v[98:99], v[18:19], v[22:23], v[98:99] op_sel_hi:[0,1,1] neg_lo:[1,0,0] neg_hi:[1,0,0]
    v_pk_fma_f32 v[100:101], v[18:19], v[24:25], v[100:101] op_sel_hi:[0,1,1] neg_lo:[1,0,0] neg_hi:[1,0,0]
    v_pk_fma_f32 v[102:103], v[18:19], v[26:27], v[102:103] op_sel_hi:[0,1,1] neg_lo:[1,0,0] neg_hi:[1,0,0]
    v_pk_fma_f32 v[104:105], v[18:19], v[28:29], v[104:105] op_sel_hi:[0,1,1] neg_lo:[1,0,0] neg_hi:[1,0,0]
    v_pk_fma_f32 v[106:107], v[18:19], v[30:31], v[106:107] op_sel_hi:[0,1,1] neg_lo:[1,0,0] neg_hi:[1,0,0]
    v_pk_fma_f32 v[108:109], v[18:19], v[32:33], v[108:109] op_sel_hi:[0,1,1] neg_lo:[1,0,0] neg_hi:[1,0,0]
    v_pk_fma_f32 v[110:111], v[18:19], v[34:35], v[110:111] op_sel_hi:[0,1,1] neg_lo:[1,0,0] neg_hi:[1,0,0]
    v_pk_mul_f32 v[96:97], v[96:97], v[18:19] op_sel:[0,1] op_sel_hi:[1,1]
    v_pk_mul_f32 v[98:99], v[98:99], v[18:19] op_sel:[0,1] op_sel_hi:[1,1]
    v_pk_mul_f32 v[100:101], v[100:101], v[18:19] op_sel:[0,1] op_sel_hi:[1,1]
    v_pk_mul_f32 v[102:103], v[102:103], v[18:19] op_sel:[0,1] op_sel_hi:[1,1]
    v_pk_mul_f32 v[104:105], v[104:105], v[18:19] op_sel:[0,1] op_sel_hi:[1,1]
    v_pk_mul_f32 v[106:107], v[106:107], v[18:19] op_sel:[0,1] op_sel_hi:[1,1]
    v_pk_mul_f32 v[108:109], v[108:109], v[18:19] op_sel:[0,1] op_sel_hi:[1,1]
    v_pk_mul_f32 v[110:111], v[110:111], v[18:19] op_sel:[0,1] op_sel_hi:[1,1]
    v_pk_mul_f32 v[120:121], v[96:97], v[96:97]
    v_pk_mul_f32 v[122:123], v[98:99], v[98:99]
    v_pk_mul_f32 v[124:125], v[100:101], v[100:101]
    v_pk_mul_f32 v[126:127], v[102:103], v[102:103]
    v_pk_mul_f32 v[128:129], v[104:105], v[104:105]
    v_pk_mul_f32 v[130:131], v[106:107], v[106:107]
    v_pk_mul_f32 v[132:133], v[108:109], v[108:109]
    v_pk_mul_f32 v[134:135], v[110:111], v[110:111]
    v_pk_fma_f32 v[120:121], v[120:121], s[48:49], v[40:41]
    v_pk_fma_f32 v[122:123], v[122:123], s[48:49], v[40:41]
    v_pk_fma_f32 v[124:125], v[124:125], s[48:49], v[40:41]
    v_pk_fma_f32 v[126:127], v[126:127], s[48:49], v[40:41]
    v_pk_fma_f32 v[128:129], v[128:129], s[48:49], v[40:41]
    v_pk_fma_f32 v[130:131], v[130:131], s[48:49], v[40:41]
    v_pk_fma_f32 v[132:133], v[132:133], s[48:49], v[40:41]
    v_pk_fma_f32 v[134:135], v[134:135], s[48:49], v[40:41]
    v_pk_mul_f32 v[120:121], v[120:121], v[96:97]
    v_pk_mul_f32 v[122:123], v[122:123], v[98:99]
    v_pk_mul_f32 v[124:125], v[124:125], v[100:101]
    v_pk_mul_f32 v[126:127], v[126:127], v[102:103]
    v_pk_mul_f32 v[128:129], v[128:129], v[104:105]
    v_pk_mul_f32 v[130:131], v[130:131], v[106:107]
    v_pk_mul_f32 v[132:133], v[132:133], v[108:109]
    v_pk_mul_f32 v[134:135], v[134:135], v[110:111]
    v_exp_f32 v120, v120
    v_exp_f32 v121, v121
    v_exp_f32 v122, v122
    v_exp_f32 v123, v123
    v_exp_f32 v124, v124
    v_exp_f32 v125, v125
    v_exp_f32 v126, v126
    v_exp_f32 v127, v127
    v_exp_f32 v128, v128
    v_exp_f32 v129, v129
    v_exp_f32 v130, v130
    v_exp_f32 v131, v131
    v_exp_f32 v132, v132
    v_exp_f32 v133, v133
    v_exp_f32 v134, v134
    v_exp_f32 v135, v135
    v_pk_add_f32 v[120:121], v[120:121], 1.0 op_sel_hi:[1,0]
    v_pk_add_f32 v[122:123], v[122:123], 1.0 op_sel_hi:[1,0]
    v_pk_add_f32 v[124:125], v[124:125], 1.0 op_sel_hi:[1,0]
    v_pk_add_f32 v[126:127], v[126:127], 1.0 op_sel_hi:[1,0]
    v_pk_add_f32 v[128:129], v[128:129], 1.0 op_sel_hi:[1,0]
    v_pk_add_f32 v[130:131], v[130:131], 1.0 op_sel_hi:[1,0]
    v_pk_add_f32 v[132:133], v[132:133], 1.0 op_sel_hi:[1,0]
    v_pk_add_f32 v[134:135], v[134:135], 1.0 op_sel_hi:[1,0]
    v_rcp_f32 v120, v120
    v_rcp_f32 v121, v121
    v_rcp_f32 v122, v122
    v_rcp_f32 v123, v123
    v_rcp_f32 v124, v124
    v_rcp_f32 v125, v125
    v_rcp_f32 v126, v126
    v_rcp_f32 v127, v127
    v_rcp_f32 v128, v128
    v_rcp_f32 v129, v129
    v_rcp_f32 v130, v130
    v_rcp_f32 v131, v131
    v_rcp_f32 v132, v132
    v_rcp_f32 v133, v133
    v_rcp_f32 v134, v134
    v_rcp_f32 v135, v135
    v_pk_mul_f32 v[96:97], v[96:97], v[120:121]
    v_pk_mul_f32 v[98:99], v[98:99], v[122:123]
    v_pk_mul_f32 v[100:101], v[100:101], v[124:125]
    v_pk_mul_f32 v[102:103], v[102:103], v[126:127]
    v_pk_mul_f32 v[104:105], v[104:105], v[128:129]
    v_pk_mul_f32 v[106:107], v[106:107], v[130:131]
    v_pk_mul_f32 v[108:109], v[108:109], v[132:133]
    v_pk_mul_f32 v[110:111], v[110:111], v[134:135]
    v_cvt_pk_bf16_f32 v136, v96, v97
    v_cvt_pk_bf16_f32 v137, v98, v99
    v_cvt_pk_bf16_f32 v138, v100, v101
    v_cvt_pk_bf16_f32 v139, v102, v103
    s_add_u32 s40, s58, 0
    buffer_store_dwordx4 v[136:139], v37, s[16:19], s40 offen sc1
    v_cvt_pk_bf16_f32 v140, v104, v105
    v_cvt_pk_bf16_f32 v141, v106, v107
    v_cvt_pk_bf16_f32 v142, v108, v109
    v_cvt_pk_bf16_f32 v143, v110, v111
    s_add_u32 s40, s58, 1024
    buffer_store_dwordx4 v[140:143], v37, s[16:19], s40 offen sc1
    s_endpgm
K1_STATS:
    s_cmp_lg_u32 s2, 0
    s_cbranch_scc1 K1_NOZERO
    s_cmp_lg_u32 s36, 8
    s_cbranch_scc1 K1_NOZERO
    s_add_u32 s24, s28, 0x1d00000
    s_addc_u32 s25, s29, 0
    s_mov_b32 s26, 0x3800
    s_mov_b32 s27, 0x20000
    v_lshlrev_b32 v1, 7, v0
    v_mov_b32 v2, 0
    buffer_store_dword v2, v1, s[24:27], 0 offen sc1
    v_add_u32 v1, 8192, v1
    buffer_store_dword v2, v1, s[24:27], 0 offen sc1
K1_NOZERO:
    s_cmp_lg_u32 s36, 11
    s_cbranch_scc1 K1_NOTLB_2
    s_sub_u32 s40, s2, 64
    s_cmp_ge_u32 s40, 8
    s_cbranch_scc1 K1_NOTLB_2
    s_load_dwordx2 s[60:61], s[0:1], 72
    s_mov_b32 s40, 524288
    v_mul_lo_u32 v1, v0, s40
    global_load_dword v166, v1, s[28:29]
    v_add_u32 v1, 33554432, v1
    s_waitcnt lgkmcnt(0)
    v_lshlrev_b32 v1, 15, v0
    global_load_dword v166, v1, s[60:61]
K1_NOTLB_2:
    s_cmp_eq_u32 s37, 3
    s_cbranch_scc1 K1_END
    s_branch K1_TRANS
K1_TRANS:
    s_load_dwordx2 s[56:57], s[0:1], 40
    s_load_dwordx4 s[60:63], s[0:1], 48
    s_load_dwordx2 s[58:59], s[0:1], 16
    s_sub_u32 s45, s36, 8
    s_sub_u32 s64, s2, 64
    s_lshl_b32 s64, s64, 2
    s_add_u32 s64, s64, s45
    s_mul_i32 s46, s45, 5120
    s_add_u32 s46, s46, 133632
    s_sub_u32 s47, s2, 64
    s_cmp_eq_u32 s36, 8
    s_cselect_b32 s47, s47, 99
    s_lshl_b32 s66, s47, 6
    v_lshrrev_b32 v1, 2, v0
    v_and_b32 v2, 3, v0
    v_lshlrev_b32 v2, 4, v2
    s_mov_b32 s40, 2752
    v_mul_lo_u32 v6, v1, s40
    v_add_u32 v6, v6, v2
    s_waitcnt lgkmcnt(0)
    s_mov_b32 s52, s60
    s_mov_b32 s53, s61
    s_mov_b32 s54, 0x158000
    s_mov_b32 s55, 0x20000
    s_cmp_ge_u32 s47, 43
    s_cbranch_scc1 K1_NOCS_0
    buffer_load_dwordx4 v[8:11], v6, s[52:55], s66 offen
    s_add_u32 s66, s66, 44032
    buffer_load_dwordx4 v[12:15], v6, s[52:55], s66 offen
    s_add_u32 s66, s66, 44032
    buffer_load_dwordx4 v[16:19], v6, s[52:55], s66 offen
    s_add_u32 s66, s66, 44032
    buffer_load_dwordx4 v[20:23], v6, s[52:55], s66 offen
    s_add_u32 s66, s66, 44032
K1_NOCS_0:
    s_barrier
    s_cmp_ge_u32 s47, 43
    s_cbranch_scc1 K1_NOCS_1
    buffer_load_dwordx4 v[24:27], v6, s[52:55], s66 offen
    s_add_u32 s66, s66, 44032
    buffer_load_dwordx4 v[28:31], v6, s[52:55], s66 offen
    s_add_u32 s66, s66, 44032
    buffer_load_dwordx4 v[32:35], v6, s[52:55], s66 offen
    s_add_u32 s66, s66, 44032
    buffer_load_dwordx4 v[36:39], v6, s[52:55], s66 offen
    s_add_u32 s66, s66, 44032
K1_NOCS_1:
    s_barrier
    s_cmp_ge_u32 s47, 43
    s_cbranch_scc1 K1_NOCS_2
    buffer_load_dwordx4 v[40:43], v6, s[52:55], s66 offen
    s_add_u32 s66, s66, 44032
    buffer_load_dwordx4 v[44:47], v6, s[52:55], s66 offen
    s_add_u32 s66, s66, 44032
    buffer_load_dwordx4 v[48:51], v6, s[52:55], s66 offen
    s_add_u32 s66, s66, 44032
    buffer_load_dwordx4 v[52:55], v6, s[52:55], s66 offen
    s_add_u32 s66, s66, 44032
K1_NOCS_2:
    s_barrier
    s_cmp_ge_u32 s47, 43
    s_cbranch_scc1 K1_NOCS_3
    buffer_load_dwordx4 v[56:59], v6, s[52:55], s66 offen
    s_add_u32 s66, s66, 44032
    buffer_load_dwordx4 v[60:63], v6, s[52:55], s66 offen
    s_add_u32 s66, s66, 44032
    buffer_load_dwordx4 v[64:67], v6, s[52:55], s66 offen
    s_add_u32 s66, s66, 44032
    buffer_load_dwordx4 v[68:71], v6, s[52:55], s66 offen
    s_add_u32 s66, s66, 44032
K1_NOCS_3:
    s_barrier
    s_cmp_ge_u32 s47, 43
    s_cbranch_scc1 K1_NOCS_4
    buffer_load_dwordx4 v[72:75], v6, s[52:55], s66 offen
    s_add_u32 s66, s66, 44032
    buffer_load_dwordx4 v[76:79], v6, s[52:55], s66 offen
    s_add_u32 s66, s66, 44032
    buffer_load_dwordx4 v[80:83], v6, s[52:55], s66 offen
    s_add_u32 s66, s66, 44032
    buffer_load_dwordx4 v[84:87], v6, s[52:55], s66 offen
    s_add_u32 s66, s66, 44032
K1_NOCS_4:
    s_mov_b32 s20, s56
    s_mov_b32 s21, s57
    s_mov_b32 s22, 0x80000
    s_mov_b32 s67, 1024
    s_cmp_ge_u32 s64, 512
    s_cselect_b32 s20, s60, s20
    s_cselect_b32 s21, s61, s21
    s_cselect_b32 s22, 0x158000, s22
    s_cselect_b32 s67, 2752, s67
    s_cselect_b32 s40, 512, 0
    s_cmp_ge_u32 s64, 1888
    s_cselect_b32 s20, s62, s20
    s_cselect_b32 s21, s63, s21
    s_cselect_b32 s67, 1024, s67
    s_cselect_b32 s40, 1888, s40
    s_cmp_ge_u32 s64, 3264
    s_cselect_b32 s20, s58, s20
    s_cselect_b32 s21, s59, s21
    s_cselect_b32 s22, 0x80000, s22
    s_cselect_b32 s40, 3264, s40
    s_mov_b32 s23, 0x20000
    s_sub_u32 s65, s64, s40
    s_lshr_b32 s41, s65, 5
    s_and_b32 s42, s65, 31
    s_cmp_eq_u32 s40, 1888
    s_cbranch_scc0 K1_TR_N0
    s_and_b32 s41, s65, 15
    s_lshr_b32 s42, s65, 4
K1_TR_N0:
    s_mul_i32 s43, s42, s67
    s_lshl_b32 s43, s43, 4
    s_lshl_b32 s41, s41, 6
    s_add_u32 s43, s43, s41
    v_mul_lo_u32 v3, v1, s67
    v_add_u32 v3, v3, v2
    s_add_u32 m0, s46, 0
    s_nop 0
    buffer_load_dwordx4 v3, s[20:23], s43 offen lds
    s_add_u32 s64, s64, 768
    s_mov_b32 s20, s56
    s_mov_b32 s21, s57
    s_mov_b32 s22, 0x80000
    s_mov_b32 s67, 1024
    s_cmp_ge_u32 s64, 512
    s_cselect_b32 s20, s60, s20
    s_cselect_b32 s21, s61, s21
    s_cselect_b32 s22, 0x158000, s22
    s_cselect_b32 s67, 2752, s67
    s_cselect_b32 s40, 512, 0
    s_cmp_ge_u32 s64, 1888
    s_cselect_b32 s20, s62, s20
    s_cselect_b32 s21, s63, s21
    s_cselect_b32 s67, 1024, s67
    s_cselect_b32 s40, 1888, s40
    s_cmp_ge_u32 s64, 3264
    s_cselect_b32 s20, s58, s20
    s_cselect_b32 s21, s59, s21
    s_cselect_b32 s22, 0x80000, s22
    s_cselect_b32 s40, 3264, s40
    s_mov_b32 s23, 0x20000
    s_sub_u32 s65, s64, s40
    s_lshr_b32 s41, s65, 5
    s_and_b32 s42, s65, 31
    s_cmp_eq_u32 s40, 1888
    s_cbranch_scc0 K1_TR_N1
    s_and_b32 s41, s65, 15
    s_lshr_b32 s42, s65, 4
K1_TR_N1:
    s_mul_i32 s43, s42, s67
    s_lshl_b32 s43, s43, 4
    s_lshl_b32 s41, s41, 6
    s_add_u32 s43, s43, s41
    v_mul_lo_u32 v3, v1, s67
    v_add_u32 v3, v3, v2
    s_add_u32 m0, s46, 1024
    s_nop 0
    buffer_load_dwordx4 v3, s[20:23], s43 offen lds
    s_add_u32 s64, s64, 768
    s_mov_b32 s20, s56
    s_mov_b32 s21, s57
    s_mov_b32 s22, 0x80000
    s_mov_b32 s67, 1024
    s_cmp_ge_u32 s64, 512
    s_cselect_b32 s20, s60, s20
    s_cselect_b32 s21, s61, s21
    s_cselect_b32 s22, 0x158000, s22
    s_cselect_b32 s67, 2752, s67
    s_cselect_b32 s40, 512, 0
    s_cmp_ge_u32 s64, 1888
    s_cselect_b32 s20, s62, s20
    s_cselect_b32 s21, s63, s21
    s_cselect_b32 s67, 1024, s67
    s_cselect_b32 s40, 1888, s40
    s_cmp_ge_u32 s64, 3264
    s_cselect_b32 s20, s58, s20
    s_cselect_b32 s21, s59, s21
    s_cselect_b32 s22, 0x80000, s22
    s_cselect_b32 s40, 3264, s40
    s_mov_b32 s23, 0x20000
    s_sub_u32 s65, s64, s40
    s_lshr_b32 s41, s65, 5
    s_and_b32 s42, s65, 31
    s_cmp_eq_u32 s40, 1888
    s_cbranch_scc0 K1_TR_N2
    s_and_b32 s41, s65, 15
    s_lshr_b32 s42, s65, 4
K1_TR_N2:
    s_mul_i32 s43, s42, s67
    s_lshl_b32 s43, s43, 4
    s_lshl_b32 s41, s41, 6
    s_add_u32 s43, s43, s41
    v_mul_lo_u32 v3, v1, s67
    v_add_u32 v3, v3, v2
    s_add_u32 m0, s46, 2048
    s_nop 0
    buffer_load_dwordx4 v3, s[20:23], s43 offen lds
    s_add_u32 s64, s64, 768
    s_mov_b32 s20, s56
    s_mov_b32 s21, s57
    s_mov_b32 s22, 0x80000
    s_mov_b32 s67, 1024
    s_cmp_ge_u32 s64, 512
    s_cselect_b32 s20, s60, s20
    s_cselect_b32 s21, s61, s21
    s_cselect_b32 s22, 0x158000, s22
    s_cselect_b32 s67, 2752, s67
    s_cselect_b32 s40, 512, 0
    s_cmp_ge_u32 s64, 1888
    s_cselect_b32 s20, s62, s20
    s_cselect_b32 s21, s63, s21
    s_cselect_b32 s67, 1024, s67
    s_cselect_b32 s40, 1888, s40
    s_cmp_ge_u32 s64, 3264
    s_cselect_b32 s20, s58, s20
    s_cselect_b32 s21, s59, s21
    s_cselect_b32 s22, 0x80000, s22
    s_cselect_b32 s40, 3264, s40
    s_mov_b32 s23, 0x20000
    s_sub_u32 s65, s64, s40
    s_lshr_b32 s41, s65, 5
    s_and_b32 s42, s65, 31
    s_cmp_eq_u32 s40, 1888
    s_cbranch_scc0 K1_TR_N3
    s_and_b32 s41, s65, 15
    s_lshr_b32 s42, s65, 4
K1_TR_N3:
    s_mul_i32 s43, s42, s67
    s_lshl_b32 s43, s43, 4
    s_lshl_b32 s41, s41, 6
    s_add_u32 s43, s43, s41
    v_mul_lo_u32 v3, v1, s67
    v_add_u32 v3, v3, v2
    s_add_u32 m0, s46, 3072
    s_nop 0
    buffer_load_dwordx4 v3, s[20:23], s43 offen lds
    s_add_u32 s64, s64, 768
    s_mov_b32 s20, s56
    s_mov_b32 s21, s57
    s_mov_b32 s22, 0x80000
    s_mov_b32 s67, 1024
    s_cmp_ge_u32 s64, 512
    s_cselect_b32 s20, s60, s20
    s_cselect_b32 s21, s61, s21
    s_cselect_b32 s22, 0x158000, s22
    s_cselect_b32 s67, 2752, s67
    s_cselect_b32 s40, 512, 0
    s_cmp_ge_u32 s64, 1888
    s_cselect_b32 s20, s62, s20
    s_cselect_b32 s21, s63, s21
    s_cselect_b32 s67, 1024, s67
    s_cselect_b32 s40, 1888, s40
    s_cmp_ge_u32 s64, 3264
    s_cselect_b32 s20, s58, s20
    s_cselect_b32 s21, s59, s21
    s_cselect_b32 s22, 0x80000, s22
    s_cselect_b32 s40, 3264, s40
    s_mov_b32 s23, 0x20000
    s_sub_u32 s65, s64, s40
    s_lshr_b32 s41, s65, 5
    s_and_b32 s42, s65, 31
    s_cmp_eq_u32 s40, 1888
    s_cbranch_scc0 K1_TR_N4
    s_and_b32 s41, s65, 15
    s_lshr_b32 s42, s65, 4
K1_TR_N4:
    s_mul_i32 s43, s42, s67
    s_lshl_b32 s43, s43, 4
    s_lshl_b32 s41, s41, 6
    s_add_u32 s43, s43, s41
    v_mul_lo_u32 v3, v1, s67
    v_add_u32 v3, v3, v2
    s_add_u32 m0, s46, 4096
    s_nop 0
    buffer_load_dwordx4 v3, s[20:23], s43 offen lds
    s_add_u32 s64, s64, 768
    s_barrier
    s_cmp_ge_u32 s47, 43
    s_cbranch_scc1 K1_NOCS_5
    buffer_load_dwordx4 v[88:91], v6, s[52:55], s66 offen
    s_add_u32 s66, s66, 44032
    buffer_load_dwordx4 v[92:95], v6, s[52:55], s66 offen
    s_add_u32 s66, s66, 44032
    buffer_load_dwordx4 v[96:99], v6, s[52:55], s66 offen
    s_add_u32 s66, s66, 44032
    buffer_load_dwordx4 v[100:103], v6, s[52:55], s66 offen
    s_add_u32 s66, s66, 44032
K1_NOCS_5:
    s_barrier
    s_cmp_ge_u32 s47, 43
    s_cbranch_scc1 K1_NOCS_6
    buffer_load_dwordx4 v[104:107], v6, s[52:55], s66 offen
    s_add_u32 s66, s66, 44032
    buffer_load_dwordx4 v[108:111], v6, s[52:55], s66 offen
    s_add_u32 s66, s66, 44032
    buffer_load_dwordx4 v[112:115], v6, s[52:55], s66 offen
    s_add_u32 s66, s66, 44032
    buffer_load_dwordx4 v[116:119], v6, s[52:55], s66 offen
    s_add_u32 s66, s66, 44032
K1_NOCS_6:
    s_barrier
    s_cmp_ge_u32 s47, 43
    s_cbranch_scc1 K1_NOCS_7
    buffer_load_dwordx4 v[120:123], v6, s[52:55], s66 offen
    s_add_u32 s66, s66, 44032
    buffer_load_dwordx4 v[124:127], v6, s[52:55], s66 offen
    s_add_u32 s66, s66, 44032
    buffer_load_dwordx4 v[128:131], v6, s[52:55], s66 offen
    s_add_u32 s66, s66, 44032
    buffer_load_dwordx4 v[132:135], v6, s[52:55], s66 offen
    s_add_u32 s66, s66, 44032
K1_NOCS_7:
    s_barrier
    s_add_u32 s24, s28, 0x1200000
    s_addc_u32 s25, s29, 0
    s_mov_b32 s26, 0x3b0000
    s_mov_b32 s27, 0x20000
    v_bfe_u32 v4, v0, 2, 2
    v_lshrrev_b32 v5, 5, v0
    v_lshl_add_u32 v4, v5, 2, v4
    v_lshlrev_b32 v4, 6, v4
    v_bfe_u32 v5, v0, 4, 1
    v_lshl_add_u32 v4, v5, 5, v4
    v_and_b32 v5, 3, v0
    v_lshl_add_u32 v4, v5, 3, v4
    v_add_u32 v4, s46, v4
    v_lshlrev_b32 v5, 4, v0
    s_sub_u32 s64, s64, 3840
    s_lshl_b32 s44, s64, 10
    s_waitcnt vmcnt(0)
    ds_read_b64_tr_b16 v[144:145], v4 offset:0
    ds_read_b64_tr_b16 v[146:147], v4 offset:512
    ds_read_b64_tr_b16 v[148:149], v4 offset:1024
    ds_read_b64_tr_b16 v[150:151], v4 offset:1536
    ds_read_b64_tr_b16 v[152:153], v4 offset:2048
    ds_read_b64_tr_b16 v[154:155], v4 offset:2560
    ds_read_b64_tr_b16 v[156:157], v4 offset:3072
    ds_read_b64_tr_b16 v[158:159], v4 offset:3584
    ds_read_b64_tr_b16 v[160:161], v4 offset:4096
    ds_read_b64_tr_b16 v[162:163], v4 offset:4608
    s_waitcnt lgkmcnt(0)
    buffer_store_dwordx4 v[144:147], v5, s[24:27], s44 offen sc1
    s_add_u32 s44, s44, 786432
    buffer_store_dwordx4 v[148:151], v5, s[24:27], s44 offen sc1
    s_add_u32 s44, s44, 786432
    buffer_store_dwordx4 v[152:155], v5, s[24:27], s44 offen sc1
    s_add_u32 s44, s44, 786432
    buffer_store_dwordx4 v[156:159], v5, s[24:27], s44 offen sc1
    s_add_u32 s44, s44, 786432
    buffer_store_dwordx4 v[160:163], v5, s[24:27], s44 offen sc1
    s_waitcnt vmcnt(0)
    s_cmp_ge_u32 s47, 43
    s_cbranch_scc1 K1_NOCS_B
    v_mov_b32 v2, 0x00003f80
    v_mov_b32 v3, 0x3f800000
    v_mov_b32 v136, 0
    v_mov_b32 v137, 0
    v_mov_b32 v138, 0
    v_mov_b32 v139, 0
    v_mov_b32 v140, 0
    v_mov_b32 v141, 0
    v_mov_b32 v142, 0
    v_mov_b32 v143, 0
    v_dot2c_f32_bf16 v136, v8, v2
    v_dot2c_f32_bf16 v137, v8, v3
    v_dot2c_f32_bf16 v138, v9, v2
    v_dot2c_f32_bf16 v139, v9, v3
    v_dot2c_f32_bf16 v140, v10, v2
    v_dot2c_f32_bf16 v141, v10, v3
    v_dot2c_f32_bf16 v142, v11, v2
    v_dot2c_f32_bf16 v143, v11, v3
    v_dot2c_f32_bf16 v136, v12, v2
    v_dot2c_f32_bf16 v137, v12, v3
    v_dot2c_f32_bf16 v138, v13, v2
    v_dot2c_f32_bf16 v139, v13, v3
    v_dot2c_f32_bf16 v140, v14, v2
    v_dot2c_f32_bf16 v141, v14, v3
    v_dot2c_f32_bf16 v142, v15, v2
    v_dot2c_f32_bf16 v143, v15, v3
    v_dot2c_f32_bf16 v136, v16, v2
    v_dot2c_f32_bf16 v137, v16, v3
    v_dot2c_f32_bf16 v138, v17, v2
    v_dot2c_f32_bf16 v139, v17, v3
    v_dot2c_f32_bf16 v140, v18, v2
    v_dot2c_f32_bf16 v141, v18, v3
    v_dot2c_f32_bf16 v142, v19, v2
    v_dot2c_f32_bf16 v143, v19, v3
    v_dot2c_f32_bf16 v136, v20, v2
    v_dot2c_f32_bf16 v137, v20, v3
    v_dot2c_f32_bf16 v138, v21, v2
    v_dot2c_f32_bf16 v139, v21, v3
    v_dot2c_f32_bf16 v140, v22, v2
    v_dot2c_f32_bf16 v141, v22, v3
    v_dot2c_f32_bf16 v142, v23, v2
    v_dot2c_f32_bf16 v143, v23, v3
    v_dot2c_f32_bf16 v136, v24, v2
    v_dot2c_f32_bf16 v137, v24, v3
    v_dot2c_f32_bf16 v138, v25, v2
    v_dot2c_f32_bf16 v139, v25, v3
    v_dot2c_f32_bf16 v140, v26, v2
    v_dot2c_f32_bf16 v141, v26, v3
    v_dot2c_f32_bf16 v142, v27, v2
    v_dot2c_f32_bf16 v143, v27, v3
    v_dot2c_f32_bf16 v136, v28, v2
    v_dot2c_f32_bf16 v137, v28, v3
    v_dot2c_f32_bf16 v138, v29, v2
    v_dot2c_f32_bf16 v139, v29, v3
    v_dot2c_f32_bf16 v140, v30, v2
    v_dot2c_f32_bf16 v141, v30, v3
    v_dot2c_f32_bf16 v142, v31, v2
    v_dot2c_f32_bf16 v143, v31, v3
    v_dot2c_f32_bf16 v136, v32, v2
    v_dot2c_f32_bf16 v137, v32, v3
    v_dot2c_f32_bf16 v138, v33, v2
    v_dot2c_f32_bf16 v139, v33, v3
    v_dot2c_f32_bf16 v140, v34, v2
    v_dot2c_f32_bf16 v141, v34, v3
    v_dot2c_f32_bf16 v142, v35, v2
    v_dot2c_f32_bf16 v143, v35, v3
    v_dot2c_f32_bf16 v136, v36, v2
    v_dot2c_f32_bf16 v137, v36, v3
    v_dot2c_f32_bf16 v138, v37, v2
    v_dot2c_f32_bf16 v139, v37, v3
    v_dot2c_f32_bf16 v140, v38, v2
    v_dot2c_f32_bf16 v141, v38, v3
    v_dot2c_f32_bf16 v142, v39, v2
    v_dot2c_f32_bf16 v143, v39, v3
    v_dot2c_f32_bf16 v136, v40, v2
    v_dot2c_f32_bf16 v137, v40, v3
    v_dot2c_f32_bf16 v138, v41, v2
    v_dot2c_f32_bf16 v139, v41, v3
    v_dot2c_f32_bf16 v140, v42, v2
    v_dot2c_f32_bf16 v141, v42, v3
    v_dot2c_f32_bf16 v142, v43, v2
    v_dot2c_f32_bf16 v143, v43, v3
    v_dot2c_f32_bf16 v136, v44, v2
    v_dot2c_f32_bf16 v137, v44, v3
    v_dot2c_f32_bf16 v138, v45, v2
    v_dot2c_f32_bf16 v139, v45, v3
    v_dot2c_f32_bf16 v140, v46, v2
    v_dot2c_f32_bf16 v141, v46, v3
    v_dot2c_f32_bf16 v142, v47, v2
    v_dot2c_f32_bf16 v143, v47, v3
    v_dot2c_f32_bf16 v136, v48, v2
    v_dot2c_f32_bf16 v137, v48, v3
    v_dot2c_f32_bf16 v138, v49, v2
    v_dot2c_f32_bf16 v139, v49, v3
    v_dot2c_f32_bf16 v140, v50, v2
    v_dot2c_f32_bf16 v141, v50, v3
    v_dot2c_f32_bf16 v142, v51, v2
    v_dot2c_f32_bf16 v143, v51, v3
    v_dot2c_f32_bf16 v136, v52, v2
    v_dot2c_f32_bf16 v137, v52, v3
    v_dot2c_f32_bf16 v138, v53, v2
    v_dot2c_f32_bf16 v139, v53, v3
    v_dot2c_f32_bf16 v140, v54, v2
    v_dot2c_f32_bf16 v141, v54, v3
    v_dot2c_f32_bf16 v142, v55, v2
    v_dot2c_f32_bf16 v143, v55, v3
    v_dot2c_f32_bf16 v136, v56, v2
    v_dot2c_f32_bf16 v137, v56, v3
    v_dot2c_f32_bf16 v138, v57, v2
    v_dot2c_f32_bf16 v139, v57, v3
    v_dot2c_f32_bf16 v140, v58, v2
    v_dot2c_f32_bf16 v141, v58, v3
    v_dot2c_f32_bf16 v142, v59, v2
    v_dot2c_f32_bf16 v143, v59, v3
    v_dot2c_f32_bf16 v136, v60, v2
    v_dot2c_f32_bf16 v137, v60, v3
    v_dot2c_f32_bf16 v138, v61, v2
    v_dot2c_f32_bf16 v139, v61, v3
    v_dot2c_f32_bf16 v140, v62, v2
    v_dot2c_f32_bf16 v141, v62, v3
    v_dot2c_f32_bf16 v142, v63, v2
    v_dot2c_f32_bf16 v143, v63, v3
    v_dot2c_f32_bf16 v136, v64, v2
    v_dot2c_f32_bf16 v137, v64, v3
    v_dot2c_f32_bf16 v138, v65, v2
    v_dot2c_f32_bf16 v139, v65, v3
    v_dot2c_f32_bf16 v140, v66, v2
    v_dot2c_f32_bf16 v141, v66, v3
    v_dot2c_f32_bf16 v142, v67, v2
    v_dot2c_f32_bf16 v143, v67, v3
    v_dot2c_f32_bf16 v136, v68, v2
    v_dot2c_f32_bf16 v137, v68, v3
    v_dot2c_f32_bf16 v138, v69, v2
    v_dot2c_f32_bf16 v139, v69, v3
    v_dot2c_f32_bf16 v140, v70, v2
    v_dot2c_f32_bf16 v141, v70, v3
    v_dot2c_f32_bf16 v142, v71, v2
    v_dot2c_f32_bf16 v143, v71, v3
    v_dot2c_f32_bf16 v136, v72, v2
    v_dot2c_f32_bf16 v137, v72, v3
    v_dot2c_f32_bf16 v138, v73, v2
    v_dot2c_f32_bf16 v139, v73, v3
    v_dot2c_f32_bf16 v140, v74, v2
    v_dot2c_f32_bf16 v141, v74, v3
    v_dot2c_f32_bf16 v142, v75, v2
    v_dot2c_f32_bf16 v143, v75, v3
    v_dot2c_f32_bf16 v136, v76, v2
    v_dot2c_f32_bf16 v137, v76, v3
    v_dot2c_f32_bf16 v138, v77, v2
    v_dot2c_f32_bf16 v139, v77, v3
    v_dot2c_f32_bf16 v140, v78, v2
    v_dot2c_f32_bf16 v141, v78, v3
    v_dot2c_f32_bf16 v142, v79, v2
    v_dot2c_f32_bf16 v143, v79, v3
    v_dot2c_f32_bf16 v136, v80, v2
    v_dot2c_f32_bf16 v137, v80, v3
    v_dot2c_f32_bf16 v138, v81, v2
    v_dot2c_f32_bf16 v139, v81, v3
    v_dot2c_f32_bf16 v140, v82, v2
    v_dot2c_f32_bf16 v141, v82, v3
    v_dot2c_f32_bf16 v142, v83, v2
    v_dot2c_f32_bf16 v143, v83, v3
    v_dot2c_f32_bf16 v136, v84, v2
    v_dot2c_f32_bf16 v137, v84, v3
    v_dot2c_f32_bf16 v138, v85, v2
    v_dot2c_f32_bf16 v139, v85, v3
    v_dot2c_f32_bf16 v140, v86, v2
    v_dot2c_f32_bf16 v141, v86, v3
    v_dot2c_f32_bf16 v142, v87, v2
    v_dot2c_f32_bf16 v143, v87, v3
    v_dot2c_f32_bf16 v136, v88, v2
    v_dot2c_f32_bf16 v137, v88, v3
    v_dot2c_f32_bf16 v138, v89, v2
    v_dot2c_f32_bf16 v139, v89, v3
    v_dot2c_f32_bf16 v140, v90, v2
    v_dot2c_f32_bf16 v141, v90, v3
    v_dot2c_f32_bf16 v142, v91, v2
    v_dot2c_f32_bf16 v143, v91, v3
    v_dot2c_f32_bf16 v136, v92, v2
    v_dot2c_f32_bf16 v137, v92, v3
    v_dot2c_f32_bf16 v138, v93, v2
    v_dot2c_f32_bf16 v139, v93, v3
    v_dot2c_f32_bf16 v140, v94, v2
    v_dot2c_f32_bf16 v141, v94, v3
    v_dot2c_f32_bf16 v142, v95, v2
    v_dot2c_f32_bf16 v143, v95, v3
    v_dot2c_f32_bf16 v136, v96, v2
    v_dot2c_f32_bf16 v137, v96, v3
    v_dot2c_f32_bf16 v138, v97, v2
    v_dot2c_f32_bf16 v139, v97, v3
    v_dot2c_f32_bf16 v140, v98, v2
    v_dot2c_f32_bf16 v141, v98, v3
    v_dot2c_f32_bf16 v142, v99, v2
    v_dot2c_f32_bf16 v143, v99, v3
    v_dot2c_f32_bf16 v136, v100, v2
    v_dot2c_f32_bf16 v137, v100, v3
    v_dot2c_f32_bf16 v138, v101, v2
    v_dot2c_f32_bf16 v139, v101, v3
    v_dot2c_f32_bf16 v140, v102, v2
    v_dot2c_f32_bf16 v141, v102, v3
    v_dot2c_f32_bf16 v142, v103, v2
    v_dot2c_f32_bf16 v143, v103, v3
    v_dot2c_f32_bf16 v136, v104, v2
    v_dot2c_f32_bf16 v137, v104, v3
    v_dot2c_f32_bf16 v138, v105, v2
    v_dot2c_f32_bf16 v139, v105, v3
    v_dot2c_f32_bf16 v140, v106, v2
    v_dot2c_f32_bf16 v141, v106, v3
    v_dot2c_f32_bf16 v142, v107, v2
    v_dot2c_f32_bf16 v143, v107, v3
    v_dot2c_f32_bf16 v136, v108, v2
    v_dot2c_f32_bf16 v137, v108, v3
    v_dot2c_f32_bf16 v138, v109, v2
    v_dot2c_f32_bf16 v139, v109, v3
    v_dot2c_f32_bf16 v140, v110, v2
    v_dot2c_f32_bf16 v141, v110, v3
    v_dot2c_f32_bf16 v142, v111, v2
    v_dot2c_f32_bf16 v143, v111, v3
    v_dot2c_f32_bf16 v136, v112, v2
    v_dot2c_f32_bf16 v137, v112, v3
    v_dot2c_f32_bf16 v138, v113, v2
    v_dot2c_f32_bf16 v139, v113, v3
    v_dot2c_f32_bf16 v140, v114, v2
    v_dot2c_f32_bf16 v141, v114, v3
    v_dot2c_f32_bf16 v142, v115, v2
    v_dot2c_f32_bf16 v143, v115, v3
    v_dot2c_f32_bf16 v136, v116, v2
    v_dot2c_f32_bf16 v137, v116, v3
    v_dot2c_f32_bf16 v138, v117, v2
    v_dot2c_f32_bf16 v139, v117, v3
    v_dot2c_f32_bf16 v140, v118, v2
    v_dot2c_f32_bf16 v141, v118, v3
    v_dot2c_f32_bf16 v142, v119, v2
    v_dot2c_f32_bf16 v143, v119, v3
    v_dot2c_f32_bf16 v136, v120, v2
    v_dot2c_f32_bf16 v137, v120, v3
    v_dot2c_f32_bf16 v138, v121, v2
    v_dot2c_f32_bf16 v139, v121, v3
    v_dot2c_f32_bf16 v140, v122, v2
    v_dot2c_f32_bf16 v141, v122, v3
    v_dot2c_f32_bf16 v142, v123, v2
    v_dot2c_f32_bf16 v143, v123, v3
    v_dot2c_f32_bf16 v136, v124, v2
    v_dot2c_f32_bf16 v137, v124, v3
    v_dot2c_f32_bf16 v138, v125, v2
    v_dot2c_f32_bf16 v139, v125, v3
    v_dot2c_f32_bf16 v140, v126, v2
    v_dot2c_f32_bf16 v141, v126, v3
    v_dot2c_f32_bf16 v142, v127, v2
    v_dot2c_f32_bf16 v143, v127, v3
    v_dot2c_f32_bf16 v136, v128, v2
    v_dot2c_f32_bf16 v137, v128, v3
    v_dot2c_f32_bf16 v138, v129, v2
    v_dot2c_f32_bf16 v139, v129, v3
    v_dot2c_f32_bf16 v140, v130, v2
    v_dot2c_f32_bf16 v141, v130, v3
    v_dot2c_f32_bf16 v142, v131, v2
    v_dot2c_f32_bf16 v143, v131, v3
    v_dot2c_f32_bf16 v136, v132, v2
    v_dot2c_f32_bf16 v137, v132, v3
    v_dot2c_f32_bf16 v138, v133, v2
    v_dot2c_f32_bf16 v139, v133, v3
    v_dot2c_f32_bf16 v140, v134, v2
    v_dot2c_f32_bf16 v141, v134, v3
    v_dot2c_f32_bf16 v142, v135, v2
    v_dot2c_f32_bf16 v143, v135, v3
    s_nop 2
    v_add_f32_dpp v136, v136, v136 row_ror:4 row_mask:0xf bank_mask:0xf
    v_add_f32_dpp v137, v137, v137 row_ror:4 row_mask:0xf bank_mask:0xf
    v_add_f32_dpp v138, v138, v138 row_ror:4 row_mask:0xf bank_mask:0xf
    v_add_f32_dpp v139, v139, v139 row_ror:4 row_mask:0xf bank_mask:0xf
    v_add_f32_dpp v140, v140, v140 row_ror:4 row_mask:0xf bank_mask:0xf
    v_add_f32_dpp v141, v141, v141 row_ror:4 row_mask:0xf bank_mask:0xf
    v_add_f32_dpp v142, v142, v142 row_ror:4 row_mask:0xf bank_mask:0xf
    v_add_f32_dpp v143, v143, v143 row_ror:4 row_mask:0xf bank_mask:0xf
    s_nop 1
    v_add_f32_dpp v136, v136, v136 row_ror:8 row_mask:0xf bank_mask:0xf
    v_add_f32_dpp v137, v137, v137 row_ror:8 row_mask:0xf bank_mask:0xf
    v_add_f32_dpp v138, v138, v138 row_ror:8 row_mask:0xf bank_mask:0xf
    v_add_f32_dpp v139, v139, v139 row_ror:8 row_mask:0xf bank_mask:0xf
    v_add_f32_dpp v140, v140, v140 row_ror:8 row_mask:0xf bank_mask:0xf
    v_add_f32_dpp v141, v141, v141 row_ror:8 row_mask:0xf bank_mask:0xf
    v_add_f32_dpp v142, v142, v142 row_ror:8 row_mask:0xf bank_mask:0xf
    v_add_f32_dpp v143, v143, v143 row_ror:8 row_mask:0xf bank_mask:0xf
    s_nop 1
    v_mov_b32 v8, v136
    v_mov_b32 v9, v137
    v_mov_b32 v10, v138
    v_mov_b32 v11, v139
    v_mov_b32 v12, v140
    v_mov_b32 v13, v141
    v_mov_b32 v14, v142
    v_mov_b32 v15, v143
    s_nop 1
    v_permlane16_swap_b32 v8, v136
    v_permlane16_swap_b32 v9, v137
    v_permlane16_swap_b32 v10, v138
    v_permlane16_swap_b32 v11, v139
    v_permlane16_swap_b32 v12, v140
    v_permlane16_swap_b32 v13, v141
    v_permlane16_swap_b32 v14, v142
    v_permlane16_swap_b32 v15, v143
    v_add_f32 v136, v136, v8
    v_add_f32 v137, v137, v9
    v_add_f32 v138, v138, v10
    v_add_f32 v139, v139, v11
    v_add_f32 v140, v140, v12
    v_add_f32 v141, v141, v13
    v_add_f32 v142, v142, v14
    v_add_f32 v143, v143, v15
    v_mov_b32 v8, v136
    v_mov_b32 v9, v137
    v_mov_b32 v10, v138
    v_mov_b32 v11, v139
    v_mov_b32 v12, v140
    v_mov_b32 v13, v141
    v_mov_b32 v14, v142
    v_mov_b32 v15, v143
    s_nop 1
    v_permlane32_swap_b32 v8, v136
    v_permlane32_swap_b32 v9, v137
    v_permlane32_swap_b32 v10, v138
    v_permlane32_swap_b32 v11, v139
    v_permlane32_swap_b32 v12, v140
    v_permlane32_swap_b32 v13, v141
    v_permlane32_swap_b32 v14, v142
    v_permlane32_swap_b32 v15, v143
    v_add_f32 v136, v136, v8
    v_add_f32 v137, v137, v9
    v_add_f32 v138, v138, v10
    v_add_f32 v139, v139, v11
    v_add_f32 v140, v140, v12
    v_add_f32 v141, v141, v13
    v_add_f32 v142, v142, v14
    v_add_f32 v143, v143, v15
    s_add_u32 s24, s28, 0x1c50000
    s_addc_u32 s25, s29, 0
    s_mov_b32 s26, 0x1580
    s_mov_b32 s27, 0x20000
    v_lshlrev_b32 v1, 5, v0
    s_lshl_b32 s40, s47, 7
    s_mov_b64 exec, 15
    buffer_store_dwordx4 v[136:139], v1, s[24:27], s40 offen
    buffer_store_dwordx4 v[140:143], v1, s[24:27], s40 offen offset:16
    s_mov_b64 exec, -1
K1_NOCS_B:
    s_endpgm
K1_END:
    s_endpgm
.globl k2_kernel
.p2align 8
.type k2_kernel,@function
k2_kernel:
    s_cmp_ge_u32 s2, 512
    s_cbranch_scc1 K2_END
    s_cmp_ge_u32 s2, 256
    s_cbranch_scc1 K2_B
    s_setprio 3
    s_load_dwordx2 s[20:21], s[0:1], 88
    v_lshrrev_b32 v1, 6, v0
    v_and_b32 v0, 63, v0
    s_and_b32 s31, s2, 7
    v_readfirstlane_b32 s22, v1
    s_lshl_b32 s31, s31, 2
    s_bfe_u32 s32, s2, 0x20003
    s_add_u32 s23, s31, s32
    s_bfe_u32 s24, s2, 0x30005
    v_lshlrev_b32 v1, 4, v0
    s_mul_i32 s33, s22, 2304
    s_lshl_b32 s36, s23, 6
    s_add_u32 s36, s36, s22
    s_lshl_b32 s36, s36, 11
    s_mov_b32 s30, 0
    s_waitcnt lgkmcnt(0)
    s_add_u32 s8, s20, 0x200000
    s_addc_u32 s9, s21, 0
    s_mov_b32 s10, 0x400000
    s_mov_b32 s11, 0x20000
    s_mov_b32 s12, s20
    s_mov_b32 s13, s21
    s_mov_b32 s14, 0x200000
    s_mov_b32 s15, 0x20000
    s_add_u32 s16, s20, 0xa00000
    s_addc_u32 s17, s21, 0
    s_mov_b32 s18, 0x200000
    s_mov_b32 s19, 0x20000
    s_mov_b32 s28, s36
    s_mov_b32 s27, 0
    s_add_u32 m0, s27, s33
    s_add_u32 s31, s28, 8192
    buffer_load_dwordx4 v1, s[8:11], s28 offen lds
    buffer_load_dwordx4 v1, s[8:11], s28 offen offset:1024 lds
    s_add_u32 m0, m0, 9216
    s_add_u32 s28, s28, 16384
    buffer_load_dwordx4 v1, s[8:11], s31 offen lds
    buffer_load_dwordx4 v1, s[8:11], s31 offen offset:1024 lds
    s_lshl_b32 s31, s23, 6
    s_lshl_b32 s32, s24, 3
    s_add_u32 s31, s31, s32
    s_lshl_b32 s32, s22, 1
    s_add_u32 s31, s31, s32
    s_lshl_b32 s31, s31, 10
    buffer_load_dwordx4 v[10:13], v1, s[12:15], s31 offen
    buffer_load_dwordx4 v[14:17], v1, s[12:15], s31 offen offset:1024
    s_mov_b32 s27, 18432
    s_add_u32 m0, s27, s33
    s_add_u32 s31, s28, 8192
    buffer_load_dwordx4 v1, s[8:11], s28 offen lds
    buffer_load_dwordx4 v1, s[8:11], s28 offen offset:1024 lds
    s_add_u32 m0, m0, 9216
    s_add_u32 s28, s28, 16384
    buffer_load_dwordx4 v1, s[8:11], s31 offen lds
    buffer_load_dwordx4 v1, s[8:11], s31 offen offset:1024 lds
    v_lshrrev_b32 v158, 5, v0
    v_lshlrev_b32 v158, 8, v158
    v_and_b32 v159, 15, v0
    v_lshl_add_u32 v158, v159, 4, v158
    v_add_u32 v158, 1024, v158
    v_mov_b32 v160, 2064
    v_add_u32 v161, -4, v159
    v_cmp_gt_u32 vcc, 8, v161
    v_mov_b32 v162, 2128
    s_nop 0
    v_cndmask_b32 v160, v160, v162, vcc
    v_cmp_eq_u32 vcc, 0, v159
    v_mov_b32 v162, 2048
    s_nop 0
    v_cndmask_b32 v160, v160, v162, vcc
    v_cmp_eq_u32 vcc, 4, v159
    v_mov_b32 v162, 2112
    s_nop 0
    v_cndmask_b32 v160, v160, v162, vcc
    v_and_b32 v161, 16, v0
    v_cmp_eq_u32 vcc, 0, v161
    v_add_u32 v162, 512, v158
    s_nop 0
    v_cndmask_b32 v2, v160, v158, vcc
    v_cndmask_b32 v3, v160, v162, vcc
    v_and_b32 v159, 11, v0
    v_cmp_eq_u32 vcc, 0, v159
    v_mov_b32 v159, 0x3f803f80
    v_mov_b32 v163, 55296
    v_cndmask_b32 v158, 0, v159, vcc
    v_mov_b32 v159, v158
    v_mov_b32 v160, v158
    v_mov_b32 v161, v158
    v_add_u32 v162, s33, v1
    v_mov_b32 v164, 0
    s_mov_b64 exec, 0xffff
    ds_write_b128 v162, v[158:161] offset:2048
    ds_write_b128 v162, v[158:161] offset:11264
    ds_write_b128 v162, v[158:161] offset:20480
    ds_write_b128 v162, v[158:161] offset:29696
    ds_write_b128 v162, v[158:161] offset:38912
    ds_write_b128 v162, v[158:161] offset:48128
    ds_write_b32 v163, v164
    s_mov_b64 exec, -1
    v_mov_b32 v126, 0
    v_mov_b32 v127, 0
    v_mov_b32 v128, 0
    v_mov_b32 v129, 0
    v_mov_b32 v130, 0
    v_mov_b32 v131, 0
    v_mov_b32 v132, 0
    v_mov_b32 v133, 0
    v_mov_b32 v134, 0
    v_mov_b32 v135, 0
    v_mov_b32 v136, 0
    v_mov_b32 v137, 0
    v_mov_b32 v138, 0
    v_mov_b32 v139, 0
    v_mov_b32 v140, 0
    v_mov_b32 v141, 0
    v_mov_b32 v142, 0
    v_mov_b32 v143, 0
    v_mov_b32 v144, 0
    v_mov_b32 v145, 0
    v_mov_b32 v146, 0
    v_mov_b32 v147, 0
    v_mov_b32 v148, 0
    v_mov_b32 v149, 0
    v_mov_b32 v150, 0
    v_mov_b32 v151, 0
    v_mov_b32 v152, 0
    v_mov_b32 v153, 0
    v_mov_b32 v154, 0
    v_mov_b32 v155, 0
    v_mov_b32 v156, 0
    v_mov_b32 v157, 0
A_PASS:
    v_mov_b32 v94, 0
    v_mov_b32 v95, 0
    v_mov_b32 v96, 0
    v_mov_b32 v97, 0
    v_mov_b32 v98, 0
    v_mov_b32 v99, 0
    v_mov_b32 v100, 0
    v_mov_b32 v101, 0
    v_mov_b32 v102, 0
    v_mov_b32 v103, 0
    v_mov_b32 v104, 0
    v_mov_b32 v105, 0
    v_mov_b32 v106, 0
    v_mov_b32 v107, 0
    v_mov_b32 v108, 0
    v_mov_b32 v109, 0
    v_mov_b32 v110, 0
    v_mov_b32 v111, 0
    v_mov_b32 v112, 0
    v_mov_b32 v113, 0
    v_mov_b32 v114, 0
    v_mov_b32 v115, 0
    v_mov_b32 v116, 0
    v_mov_b32 v117, 0
    v_mov_b32 v118, 0
    v_mov_b32 v119, 0
    v_mov_b32 v120, 0
    v_mov_b32 v121, 0
    v_mov_b32 v122, 0
    v_mov_b32 v123, 0
    v_mov_b32 v124, 0
    v_mov_b32 v125, 0
    v_mov_b32 v54, 0
    v_mov_b32 v55, 0
    v_mov_b32 v56, 0
    v_mov_b32 v57, 0
    v_mov_b32 v58, 0
    v_mov_b32 v59, 0
    v_mov_b32 v60, 0
    v_mov_b32 v61, 0
    v_mov_b32 v50, 0
    v_mov_b32 v51, 0
    v_mov_b32 v52, 0
    v_mov_b32 v53, 0
    v_mov_b32 v92, 0
    v_mov_b32 v93, 0
    v_mov_b32 v4, v1
    s_waitcnt vmcnt(4) lgkmcnt(0)
    s_barrier
    ds_read_b128 v[18:21], v4
    ds_read_b128 v[30:33], v2
    ds_read_b128 v[34:37], v3
    ds_read_b128 v[22:25], v4 offset:2304
    ds_read_b128 v[38:41], v2 offset:2304
    ds_read_b128 v[42:45], v3 offset:2304
    s_waitcnt lgkmcnt(0)
    v_mfma_f32_32x32x16_bf16 v[62:77], v[18:21], v[10:13], v[126:141]
    s_setprio 1
    s_nop 11
    v_exp_f32 v62, v62
    v_exp_f32 v63, v63
    v_cvt_pk_bf16_f32 v61, v92, v93
    v_exp_f32 v64, v64
    v_exp_f32 v65, v65
    v_cvt_pk_bf16_f32 v54, v62, v63
    v_exp_f32 v66, v66
    v_exp_f32 v67, v67
    v_cvt_pk_bf16_f32 v55, v64, v65
    v_exp_f32 v68, v68
    v_exp_f32 v69, v69
    v_cvt_pk_bf16_f32 v56, v66, v67
    v_exp_f32 v70, v70
    v_cvt_pk_bf16_f32 v57, v68, v69
    v_mfma_f32_32x32x16_bf16 v[78:93], v[18:21], v[14:17], v[142:157]
    ds_read_b128 v[46:49], v2 offset:4608
    v_exp_f32 v71, v71
    v_exp_f32 v72, v72
    v_exp_f32 v73, v73
    v_mfma_f32_32x32x16_bf16 v[110:125], v[50:53], v[58:61], v[110:125]
    ds_read_b128 v[26:29], v4 offset:4608
    v_exp_f32 v74, v74
    v_exp_f32 v75, v75
    v_exp_f32 v76, v76
    v_mfma_f32_32x32x16_bf16 v[94:109], v[30:33], v[54:57], v[94:109]
    ds_read_b128 v[50:53], v3 offset:4608
    s_waitcnt lgkmcnt(3)
    v_exp_f32 v77, v77
    v_cvt_pk_bf16_f32 v58, v70, v71
    v_cvt_pk_bf16_f32 v59, v72, v73
    v_cvt_pk_bf16_f32 v60, v74, v75
    v_exp_f32 v78, v78
    v_exp_f32 v79, v79
    v_cvt_pk_bf16_f32 v61, v76, v77
    v_exp_f32 v80, v80
    v_exp_f32 v81, v81
    v_cvt_pk_bf16_f32 v54, v78, v79
    v_exp_f32 v82, v82
    v_exp_f32 v83, v83
    v_cvt_pk_bf16_f32 v55, v80, v81
    v_exp_f32 v84, v84
    v_exp_f32 v85, v85
    v_cvt_pk_bf16_f32 v56, v82, v83
    v_exp_f32 v86, v86
    v_cvt_pk_bf16_f32 v57, v84, v85
    v_mfma_f32_32x32x16_bf16 v[62:77], v[22:25], v[10:13], v[126:141]
    v_exp_f32 v87, v87
    v_exp_f32 v88, v88
    v_exp_f32 v89, v89
    v_mfma_f32_32x32x16_bf16 v[94:109], v[34:37], v[58:61], v[94:109]
    v_exp_f32 v90, v90
    v_exp_f32 v91, v91
    v_exp_f32 v92, v92
    v_mfma_f32_32x32x16_bf16 v[110:125], v[30:33], v[54:57], v[110:125]
    v_exp_f32 v93, v93
    v_cvt_pk_bf16_f32 v58, v86, v87
    v_cvt_pk_bf16_f32 v59, v88, v89
    v_cvt_pk_bf16_f32 v60, v90, v91
    v_exp_f32 v62, v62
    v_exp_f32 v63, v63
    v_cvt_pk_bf16_f32 v61, v92, v93
    v_exp_f32 v64, v64
    v_exp_f32 v65, v65
    v_cvt_pk_bf16_f32 v54, v62, v63
    v_exp_f32 v66, v66
    v_exp_f32 v67, v67
    v_cvt_pk_bf16_f32 v55, v64, v65
    v_exp_f32 v68, v68
    v_exp_f32 v69, v69
    v_cvt_pk_bf16_f32 v56, v66, v67
    v_exp_f32 v70, v70
    v_cvt_pk_bf16_f32 v57, v68, v69
    v_mfma_f32_32x32x16_bf16 v[78:93], v[22:25], v[14:17], v[142:157]
    ds_read_b128 v[30:33], v2 offset:6912
    v_exp_f32 v71, v71
    v_exp_f32 v72, v72
    v_exp_f32 v73, v73
    v_mfma_f32_32x32x16_bf16 v[110:125], v[34:37], v[58:61], v[110:125]
    ds_read_b128 v[18:21], v4 offset:6912
    v_exp_f32 v74, v74
    v_exp_f32 v75, v75
    v_exp_f32 v76, v76
    v_mfma_f32_32x32x16_bf16 v[94:109], v[38:41], v[54:57], v[94:109]
    ds_read_b128 v[34:37], v3 offset:6912
    s_waitcnt lgkmcnt(3)
    v_exp_f32 v77, v77
    v_cvt_pk_bf16_f32 v58, v70, v71
    v_cvt_pk_bf16_f32 v59, v72, v73
    v_cvt_pk_bf16_f32 v60, v74, v75
    v_exp_f32 v78, v78
    v_exp_f32 v79, v79
    v_cvt_pk_bf16_f32 v61, v76, v77
    v_exp_f32 v80, v80
    v_exp_f32 v81, v81
    v_cvt_pk_bf16_f32 v54, v78, v79
    v_exp_f32 v82, v82
    v_exp_f32 v83, v83
    v_cvt_pk_bf16_f32 v55, v80, v81
    v_exp_f32 v84, v84
    v_exp_f32 v85, v85
    v_cvt_pk_bf16_f32 v56, v82, v83
    v_exp_f32 v86, v86
    v_cvt_pk_bf16_f32 v57, v84, v85
    v_mfma_f32_32x32x16_bf16 v[62:77], v[26:29], v[10:13], v[126:141]
    v_exp_f32 v87, v87
    v_exp_f32 v88, v88
    v_exp_f32 v89, v89
    v_mfma_f32_32x32x16_bf16 v[94:109], v[42:45], v[58:61], v[94:109]
    v_exp_f32 v90, v90
    v_exp_f32 v91, v91
    v_exp_f32 v92, v92
    v_mfma_f32_32x32x16_bf16 v[110:125], v[38:41], v[54:57], v[110:125]
    v_exp_f32 v93, v93
    v_cvt_pk_bf16_f32 v58, v86, v87
    v_cvt_pk_bf16_f32 v59, v88, v89
    v_cvt_pk_bf16_f32 v60, v90, v91
    v_exp_f32 v62, v62
    v_exp_f32 v63, v63
    v_cvt_pk_bf16_f32 v61, v92, v93
    v_exp_f32 v64, v64
    v_exp_f32 v65, v65
    v_cvt_pk_bf16_f32 v54, v62, v63
    v_exp_f32 v66, v66
    v_exp_f32 v67, v67
    v_cvt_pk_bf16_f32 v55, v64, v65
    v_exp_f32 v68, v68
    v_exp_f32 v69, v69
    v_cvt_pk_bf16_f32 v56, v66, v67
    v_exp_f32 v70, v70
    v_cvt_pk_bf16_f32 v57, v68, v69
    v_mfma_f32_32x32x16_bf16 v[78:93], v[26:29], v[14:17], v[142:157]
    ds_read_b128 v[38:41], v2 offset:9216
    v_exp_f32 v71, v71
    v_exp_f32 v72, v72
    v_exp_f32 v73, v73
    v_mfma_f32_32x32x16_bf16 v[110:125], v[42:45], v[58:61], v[110:125]
    ds_read_b128 v[22:25], v4 offset:9216
    v_exp_f32 v74, v74
    v_exp_f32 v75, v75
    v_exp_f32 v76, v76
    v_mfma_f32_32x32x16_bf16 v[94:109], v[46:49], v[54:57], v[94:109]
    ds_read_b128 v[42:45], v3 offset:9216
    s_waitcnt lgkmcnt(3)
    v_exp_f32 v77, v77
    v_cvt_pk_bf16_f32 v58, v70, v71
    v_cvt_pk_bf16_f32 v59, v72, v73
    v_cvt_pk_bf16_f32 v60, v74, v75
    v_exp_f32 v78, v78
    v_exp_f32 v79, v79
    v_cvt_pk_bf16_f32 v61, v76, v77
    v_exp_f32 v80, v80
    v_exp_f32 v81, v81
    v_cvt_pk_bf16_f32 v54, v78, v79
    v_exp_f32 v82, v82
    v_exp_f32 v83, v83
    v_cvt_pk_bf16_f32 v55, v80, v81
    v_exp_f32 v84, v84
    v_exp_f32 v85, v85
    v_cvt_pk_bf16_f32 v56, v82, v83
    v_exp_f32 v86, v86
    v_cvt_pk_bf16_f32 v57, v84, v85
    v_mfma_f32_32x32x16_bf16 v[62:77], v[18:21], v[10:13], v[126:141]
    v_exp_f32 v87, v87
    v_exp_f32 v88, v88
    v_exp_f32 v89, v89
    v_mfma_f32_32x32x16_bf16 v[94:109], v[50:53], v[58:61], v[94:109]
    v_exp_f32 v90, v90
    v_exp_f32 v91, v91
    v_exp_f32 v92, v92
    v_mfma_f32_32x32x16_bf16 v[110:125], v[46:49], v[54:57], v[110:125]
    v_exp_f32 v93, v93
    v_cvt_pk_bf16_f32 v58, v86, v87
    v_cvt_pk_bf16_f32 v59, v88, v89
    v_cvt_pk_bf16_f32 v60, v90, v91
    v_exp_f32 v62, v62
    v_exp_f32 v63, v63
    v_cvt_pk_bf16_f32 v61, v92, v93
    v_exp_f32 v64, v64
    v_exp_f32 v65, v65
    v_cvt_pk_bf16_f32 v54, v62, v63
    v_exp_f32 v66, v66
    v_exp_f32 v67, v67
    v_cvt_pk_bf16_f32 v55, v64, v65
    v_exp_f32 v68, v68
    v_exp_f32 v69, v69
    v_cvt_pk_bf16_f32 v56, v66, v67
    v_exp_f32 v70, v70
    v_cvt_pk_bf16_f32 v57, v68, v69
    v_mfma_f32_32x32x16_bf16 v[78:93], v[18:21], v[14:17], v[142:157]
    ds_read_b128 v[46:49], v2 offset:11520
    v_exp_f32 v71, v71
    v_exp_f32 v72, v72
    v_exp_f32 v73, v73
    v_mfma_f32_32x32x16_bf16 v[110:125], v[50:53], v[58:61], v[110:125]
    ds_read_b128 v[26:29], v4 offset:11520
    v_exp_f32 v74, v74
    v_exp_f32 v75, v75
    v_exp_f32 v76, v76
    v_mfma_f32_32x32x16_bf16 v[94:109], v[30:33], v[54:57], v[94:109]
    ds_read_b128 v[50:53], v3 offset:11520
    s_waitcnt lgkmcnt(3)
    v_exp_f32 v77, v77
    v_cvt_pk_bf16_f32 v58, v70, v71
    v_cvt_pk_bf16_f32 v59, v72, v73
    v_cvt_pk_bf16_f32 v60, v74, v75
    v_exp_f32 v78, v78
    v_exp_f32 v79, v79
    v_cvt_pk_bf16_f32 v61, v76, v77
    v_exp_f32 v80, v80
    v_exp_f32 v81, v81
    v_cvt_pk_bf16_f32 v54, v78, v79
    v_exp_f32 v82, v82
    v_exp_f32 v83, v83
    v_cvt_pk_bf16_f32 v55, v80, v81
    v_exp_f32 v84, v84
    v_exp_f32 v85, v85
    v_cvt_pk_bf16_f32 v56, v82, v83
    v_exp_f32 v86, v86
    v_cvt_pk_bf16_f32 v57, v84, v85
    v_mfma_f32_32x32x16_bf16 v[62:77], v[22:25], v[10:13], v[126:141]
    v_exp_f32 v87, v87
    v_exp_f32 v88, v88
    v_exp_f32 v89, v89
    v_mfma_f32_32x32x16_bf16 v[94:109], v[34:37], v[58:61], v[94:109]
    v_exp_f32 v90, v90
    v_exp_f32 v91, v91
    v_exp_f32 v92, v92
    v_mfma_f32_32x32x16_bf16 v[110:125], v[30:33], v[54:57], v[110:125]
    v_exp_f32 v93, v93
    v_cvt_pk_bf16_f32 v58, v86, v87
    v_cvt_pk_bf16_f32 v59, v88, v89
    v_cvt_pk_bf16_f32 v60, v90, v91
    v_exp_f32 v62, v62
    v_exp_f32 v63, v63
    v_cvt_pk_bf16_f32 v61, v92, v93
    v_exp_f32 v64, v64
    v_exp_f32 v65, v65
    v_cvt_pk_bf16_f32 v54, v62, v63
    v_exp_f32 v66, v66
    v_exp_f32 v67, v67
    v_cvt_pk_bf16_f32 v55, v64, v65
    v_exp_f32 v68, v68
    v_exp_f32 v69, v69
    v_cvt_pk_bf16_f32 v56, v66, v67
    v_exp_f32 v70, v70
    v_cvt_pk_bf16_f32 v57, v68, v69
    v_mfma_f32_32x32x16_bf16 v[78:93], v[22:25], v[14:17], v[142:157]
    ds_read_b128 v[30:33], v2 offset:13824
    v_exp_f32 v71, v71
    v_exp_f32 v72, v72
    v_exp_f32 v73, v73
    v_mfma_f32_32x32x16_bf16 v[110:125], v[34:37], v[58:61], v[110:125]
    ds_read_b128 v[18:21], v4 offset:13824
    v_exp_f32 v74, v74
    v_exp_f32 v75, v75
    v_exp_f32 v76, v76
    v_mfma_f32_32x32x16_bf16 v[94:109], v[38:41], v[54:57], v[94:109]
    ds_read_b128 v[34:37], v3 offset:13824
    s_waitcnt lgkmcnt(3)
    v_exp_f32 v77, v77
    v_cvt_pk_bf16_f32 v58, v70, v71
    v_cvt_pk_bf16_f32 v59, v72, v73
    v_cvt_pk_bf16_f32 v60, v74, v75
    v_exp_f32 v78, v78
    v_exp_f32 v79, v79
    v_cvt_pk_bf16_f32 v61, v76, v77
    v_exp_f32 v80, v80
    v_exp_f32 v81, v81
    v_cvt_pk_bf16_f32 v54, v78, v79
    v_exp_f32 v82, v82
    v_exp_f32 v83, v83
    v_cvt_pk_bf16_f32 v55, v80, v81
    v_exp_f32 v84, v84
    v_exp_f32 v85, v85
    v_cvt_pk_bf16_f32 v56, v82, v83
    v_exp_f32 v86, v86
    v_cvt_pk_bf16_f32 v57, v84, v85
    v_mfma_f32_32x32x16_bf16 v[62:77], v[26:29], v[10:13], v[126:141]
    v_exp_f32 v87, v87
    v_exp_f32 v88, v88
    v_exp_f32 v89, v89
    v_mfma_f32_32x32x16_bf16 v[94:109], v[42:45], v[58:61], v[94:109]
    v_exp_f32 v90, v90
    v_exp_f32 v91, v91
    v_exp_f32 v92, v92
    v_mfma_f32_32x32x16_bf16 v[110:125], v[38:41], v[54:57], v[110:125]
    v_exp_f32 v93, v93
    v_cvt_pk_bf16_f32 v58, v86, v87
    v_cvt_pk_bf16_f32 v59, v88, v89
    v_cvt_pk_bf16_f32 v60, v90, v91
    v_exp_f32 v62, v62
    v_exp_f32 v63, v63
    v_cvt_pk_bf16_f32 v61, v92, v93
    v_exp_f32 v64, v64
    v_exp_f32 v65, v65
    v_cvt_pk_bf16_f32 v54, v62, v63
    v_exp_f32 v66, v66
    v_exp_f32 v67, v67
    v_cvt_pk_bf16_f32 v55, v64, v65
    v_exp_f32 v68, v68
    v_exp_f32 v69, v69
    v_cvt_pk_bf16_f32 v56, v66, v67
    v_exp_f32 v70, v70
    v_cvt_pk_bf16_f32 v57, v68, v69
    v_mfma_f32_32x32x16_bf16 v[78:93], v[26:29], v[14:17], v[142:157]
    ds_read_b128 v[38:41], v2 offset:16128
    v_exp_f32 v71, v71
    v_exp_f32 v72, v72
    v_exp_f32 v73, v73
    v_mfma_f32_32x32x16_bf16 v[110:125], v[42:45], v[58:61], v[110:125]
    ds_read_b128 v[22:25], v4 offset:16128
    v_exp_f32 v74, v74
    v_exp_f32 v75, v75
    v_exp_f32 v76, v76
    v_mfma_f32_32x32x16_bf16 v[94:109], v[46:49], v[54:57], v[94:109]
    ds_read_b128 v[42:45], v3 offset:16128
    s_waitcnt lgkmcnt(3)
    v_exp_f32 v77, v77
    v_cvt_pk_bf16_f32 v58, v70, v71
    v_cvt_pk_bf16_f32 v59, v72, v73
    v_cvt_pk_bf16_f32 v60, v74, v75
    v_exp_f32 v78, v78
    v_exp_f32 v79, v79
    v_cvt_pk_bf16_f32 v61, v76, v77
    v_exp_f32 v80, v80
    v_exp_f32 v81, v81
    v_cvt_pk_bf16_f32 v54, v78, v79
    v_exp_f32 v82, v82
    v_exp_f32 v83, v83
    v_cvt_pk_bf16_f32 v55, v80, v81
    v_exp_f32 v84, v84
    v_exp_f32 v85, v85
    v_cvt_pk_bf16_f32 v56, v82, v83
    v_exp_f32 v86, v86
    v_cvt_pk_bf16_f32 v57, v84, v85
    v_mfma_f32_32x32x16_bf16 v[62:77], v[18:21], v[10:13], v[126:141]
    s_waitcnt vmcnt(0)
    s_barrier
    v_exp_f32 v87, v87
    v_exp_f32 v88, v88
    v_exp_f32 v89, v89
    v_mfma_f32_32x32x16_bf16 v[94:109], v[50:53], v[58:61], v[94:109]
    v_exp_f32 v90, v90
    v_exp_f32 v91, v91
    v_exp_f32 v92, v92
    v_mfma_f32_32x32x16_bf16 v[110:125], v[46:49], v[54:57], v[110:125]
    v_exp_f32 v93, v93
    v_cvt_pk_bf16_f32 v58, v86, v87
    v_cvt_pk_bf16_f32 v59, v88, v89
    v_cvt_pk_bf16_f32 v60, v90, v91
    v_exp_f32 v62, v62
    v_exp_f32 v63, v63
    v_cvt_pk_bf16_f32 v61, v92, v93
    v_exp_f32 v64, v64
    v_exp_f32 v65, v65
    v_cvt_pk_bf16_f32 v54, v62, v63
    v_exp_f32 v66, v66
    v_exp_f32 v67, v67
    v_cvt_pk_bf16_f32 v55, v64, v65
    v_exp_f32 v68, v68
    v_exp_f32 v69, v69
    v_cvt_pk_bf16_f32 v56, v66, v67
    v_exp_f32 v70, v70
    v_cvt_pk_bf16_f32 v57, v68, v69
    v_mfma_f32_32x32x16_bf16 v[78:93], v[18:21], v[14:17], v[142:157]
    ds_read_b128 v[46:49], v2 offset:18432
    v_exp_f32 v71, v71
    v_exp_f32 v72, v72
    v_exp_f32 v73, v73
    v_mfma_f32_32x32x16_bf16 v[110:125], v[50:53], v[58:61], v[110:125]
    ds_read_b128 v[26:29], v4 offset:18432
    v_exp_f32 v74, v74
    v_exp_f32 v75, v75
    v_exp_f32 v76, v76
    v_mfma_f32_32x32x16_bf16 v[94:109], v[30:33], v[54:57], v[94:109]
    ds_read_b128 v[50:53], v3 offset:18432
    s_waitcnt lgkmcnt(3)
    v_exp_f32 v77, v77
    v_cvt_pk_bf16_f32 v58, v70, v71
    v_cvt_pk_bf16_f32 v59, v72, v73
    v_cvt_pk_bf16_f32 v60, v74, v75
    v_exp_f32 v78, v78
    v_exp_f32 v79, v79
    v_cvt_pk_bf16_f32 v61, v76, v77
    v_exp_f32 v80, v80
    v_exp_f32 v81, v81
    v_cvt_pk_bf16_f32 v54, v78, v79
    v_exp_f32 v82, v82
    v_exp_f32 v83, v83
    v_cvt_pk_bf16_f32 v55, v80, v81
    v_exp_f32 v84, v84
    v_exp_f32 v85, v85
    v_cvt_pk_bf16_f32 v56, v82, v83
    v_exp_f32 v86, v86
    v_cvt_pk_bf16_f32 v57, v84, v85
    v_mfma_f32_32x32x16_bf16 v[62:77], v[22:25], v[10:13], v[126:141]
    s_add_u32 m0, s33, 36864
    s_add_u32 s31, s36, 32768
    buffer_load_dwordx4 v1, s[8:11], s31 offen offset:0 lds
    v_exp_f32 v87, v87
    v_exp_f32 v88, v88
    v_exp_f32 v89, v89
    v_mfma_f32_32x32x16_bf16 v[94:109], v[34:37], v[58:61], v[94:109]
    v_exp_f32 v90, v90
    v_exp_f32 v91, v91
    v_exp_f32 v92, v92
    v_mfma_f32_32x32x16_bf16 v[110:125], v[30:33], v[54:57], v[110:125]
    s_add_u32 m0, s33, 36864
    s_add_u32 s31, s36, 32768
    buffer_load_dwordx4 v1, s[8:11], s31 offen offset:1024 lds
    v_exp_f32 v93, v93
    v_cvt_pk_bf16_f32 v58, v86, v87
    v_cvt_pk_bf16_f32 v59, v88, v89
    v_cvt_pk_bf16_f32 v60, v90, v91
    v_exp_f32 v62, v62
    v_exp_f32 v63, v63
    v_cvt_pk_bf16_f32 v61, v92, v93
    v_exp_f32 v64, v64
    v_exp_f32 v65, v65
    v_cvt_pk_bf16_f32 v54, v62, v63
    v_exp_f32 v66, v66
    v_exp_f32 v67, v67
    v_cvt_pk_bf16_f32 v55, v64, v65
    v_exp_f32 v68, v68
    v_exp_f32 v69, v69
    v_cvt_pk_bf16_f32 v56, v66, v67
    v_exp_f32 v70, v70
    v_cvt_pk_bf16_f32 v57, v68, v69
    v_mfma_f32_32x32x16_bf16 v[78:93], v[22:25], v[14:17], v[142:157]
    ds_read_b128 v[30:33], v2 offset:20736
    v_exp_f32 v71, v71
    v_exp_f32 v72, v72
    v_exp_f32 v73, v73
    v_mfma_f32_32x32x16_bf16 v[110:125], v[34:37], v[58:61], v[110:125]
    ds_read_b128 v[18:21], v4 offset:20736
    v_exp_f32 v74, v74
    v_exp_f32 v75, v75
    v_exp_f32 v76, v76
    v_mfma_f32_32x32x16_bf16 v[94:109], v[38:41], v[54:57], v[94:109]
    ds_read_b128 v[34:37], v3 offset:20736
    s_waitcnt lgkmcnt(3)
    v_exp_f32 v77, v77
    v_cvt_pk_bf16_f32 v58, v70, v71
    v_cvt_pk_bf16_f32 v59, v72, v73
    v_cvt_pk_bf16_f32 v60, v74, v75
    v_exp_f32 v78, v78
    v_exp_f32 v79, v79
    v_cvt_pk_bf16_f32 v61, v76, v77
    v_exp_f32 v80, v80
    v_exp_f32 v81, v81
    v_cvt_pk_bf16_f32 v54, v78, v79
    v_exp_f32 v82, v82
    v_exp_f32 v83, v83
    v_cvt_pk_bf16_f32 v55, v80, v81
    v_exp_f32 v84, v84
    v_exp_f32 v85, v85
    v_cvt_pk_bf16_f32 v56, v82, v83
    v_exp_f32 v86, v86
    v_cvt_pk_bf16_f32 v57, v84, v85
    v_mfma_f32_32x32x16_bf16 v[62:77], v[26:29], v[10:13], v[126:141]
    s_add_u32 m0, s33, 46080
    s_add_u32 s31, s36, 40960
    buffer_load_dwordx4 v1, s[8:11], s31 offen offset:0 lds
    v_exp_f32 v87, v87
    v_exp_f32 v88, v88
    v_exp_f32 v89, v89
    v_mfma_f32_32x32x16_bf16 v[94:109], v[42:45], v[58:61], v[94:109]
    v_exp_f32 v90, v90
    v_exp_f32 v91, v91
    v_exp_f32 v92, v92
    v_mfma_f32_32x32x16_bf16 v[110:125], v[38:41], v[54:57], v[110:125]
    s_add_u32 m0, s33, 46080
    s_add_u32 s31, s36, 40960
    buffer_load_dwordx4 v1, s[8:11], s31 offen offset:1024 lds
    v_exp_f32 v93, v93
    v_cvt_pk_bf16_f32 v58, v86, v87
    v_cvt_pk_bf16_f32 v59, v88, v89
    v_cvt_pk_bf16_f32 v60, v90, v91
    v_exp_f32 v62, v62
    v_exp_f32 v63, v63
    v_cvt_pk_bf16_f32 v61, v92, v93
    v_exp_f32 v64, v64
    v_exp_f32 v65, v65
    v_cvt_pk_bf16_f32 v54, v62, v63
    v_exp_f32 v66, v66
    v_exp_f32 v67, v67
    v_cvt_pk_bf16_f32 v55, v64, v65
    v_exp_f32 v68, v68
    v_exp_f32 v69, v69
    v_cvt_pk_bf16_f32 v56, v66, v67
    v_exp_f32 v70, v70
    v_cvt_pk_bf16_f32 v57, v68, v69
    v_mfma_f32_32x32x16_bf16 v[78:93], v[26:29], v[14:17], v[142:157]
    ds_read_b128 v[38:41], v2 offset:23040
    v_exp_f32 v71, v71
    v_exp_f32 v72, v72
    v_exp_f32 v73, v73
    v_mfma_f32_32x32x16_bf16 v[110:125], v[42:45], v[58:61], v[110:125]
    ds_read_b128 v[22:25], v4 offset:23040
    v_exp_f32 v74, v74
    v_exp_f32 v75, v75
    v_exp_f32 v76, v76
    v_mfma_f32_32x32x16_bf16 v[94:109], v[46:49], v[54:57], v[94:109]
    ds_read_b128 v[42:45], v3 offset:23040
    s_waitcnt lgkmcnt(3)
    v_exp_f32 v77, v77
    v_cvt_pk_bf16_f32 v58, v70, v71
    v_cvt_pk_bf16_f32 v59, v72, v73
    v_cvt_pk_bf16_f32 v60, v74, v75
    v_exp_f32 v78, v78
    v_exp_f32 v79, v79
    v_cvt_pk_bf16_f32 v61, v76, v77
    v_exp_f32 v80, v80
    v_exp_f32 v81, v81
    v_cvt_pk_bf16_f32 v54, v78, v79
    v_exp_f32 v82, v82
    v_exp_f32 v83, v83
    v_cvt_pk_bf16_f32 v55, v80, v81
    v_exp_f32 v84, v84
    v_exp_f32 v85, v85
    v_cvt_pk_bf16_f32 v56, v82, v83
    v_exp_f32 v86, v86
    v_cvt_pk_bf16_f32 v57, v84, v85
    v_mfma_f32_32x32x16_bf16 v[62:77], v[18:21], v[10:13], v[126:141]
    v_exp_f32 v87, v87
    v_exp_f32 v88, v88
    v_exp_f32 v89, v89
    v_mfma_f32_32x32x16_bf16 v[94:109], v[50:53], v[58:61], v[94:109]
    v_exp_f32 v90, v90
    v_exp_f32 v91, v91
    v_exp_f32 v92, v92
    v_mfma_f32_32x32x16_bf16 v[110:125], v[46:49], v[54:57], v[110:125]
    v_exp_f32 v93, v93
    v_cvt_pk_bf16_f32 v58, v86, v87
    v_cvt_pk_bf16_f32 v59, v88, v89
    v_cvt_pk_bf16_f32 v60, v90, v91
    v_exp_f32 v62, v62
    v_exp_f32 v63, v63
    v_cvt_pk_bf16_f32 v61, v92, v93
    v_exp_f32 v64, v64
    v_exp_f32 v65, v65
    v_cvt_pk_bf16_f32 v54, v62, v63
    v_exp_f32 v66, v66
    v_exp_f32 v67, v67
    v_cvt_pk_bf16_f32 v55, v64, v65
    v_exp_f32 v68, v68
    v_exp_f32 v69, v69
    v_cvt_pk_bf16_f32 v56, v66, v67
    v_exp_f32 v70, v70
    v_cvt_pk_bf16_f32 v57, v68, v69
    v_mfma_f32_32x32x16_bf16 v[78:93], v[18:21], v[14:17], v[142:157]
    ds_read_b128 v[46:49], v2 offset:25344
    v_exp_f32 v71, v71
    v_exp_f32 v72, v72
    v_exp_f32 v73, v73
    v_mfma_f32_32x32x16_bf16 v[110:125], v[50:53], v[58:61], v[110:125]
    ds_read_b128 v[26:29], v4 offset:25344
    v_exp_f32 v74, v74
    v_exp_f32 v75, v75
    v_exp_f32 v76, v76
    v_mfma_f32_32x32x16_bf16 v[94:109], v[30:33], v[54:57], v[94:109]
    ds_read_b128 v[50:53], v3 offset:25344
    s_waitcnt lgkmcnt(3)
    v_exp_f32 v77, v77
    v_cvt_pk_bf16_f32 v58, v70, v71
    v_cvt_pk_bf16_f32 v59, v72, v73
    v_cvt_pk_bf16_f32 v60, v74, v75
    v_exp_f32 v78, v78
    v_exp_f32 v79, v79
    v_cvt_pk_bf16_f32 v61, v76, v77
    v_exp_f32 v80, v80
    v_exp_f32 v81, v81
    v_cvt_pk_bf16_f32 v54, v78, v79
    v_exp_f32 v82, v82
    v_exp_f32 v83, v83
    v_cvt_pk_bf16_f32 v55, v80, v81
    v_exp_f32 v84, v84
    v_exp_f32 v85, v85
    v_cvt_pk_bf16_f32 v56, v82, v83
    v_exp_f32 v86, v86
    v_cvt_pk_bf16_f32 v57, v84, v85
    v_mfma_f32_32x32x16_bf16 v[62:77], v[22:25], v[10:13], v[126:141]
    v_exp_f32 v87, v87
    v_exp_f32 v88, v88
    v_exp_f32 v89, v89
    v_mfma_f32_32x32x16_bf16 v[94:109], v[34:37], v[58:61], v[94:109]
    v_exp_f32 v90, v90
    v_exp_f32 v91, v91
    v_exp_f32 v92, v92
    v_mfma_f32_32x32x16_bf16 v[110:125], v[30:33], v[54:57], v[110:125]
    v_exp_f32 v93, v93
    v_cvt_pk_bf16_f32 v58, v86, v87
    v_cvt_pk_bf16_f32 v59, v88, v89
    v_cvt_pk_bf16_f32 v60, v90, v91
    v_exp_f32 v62, v62
    v_exp_f32 v63, v63
    v_cvt_pk_bf16_f32 v61, v92, v93
    v_exp_f32 v64, v64
    v_exp_f32 v65, v65
    v_cvt_pk_bf16_f32 v54, v62, v63
    v_exp_f32 v66, v66
    v_exp_f32 v67, v67
    v_cvt_pk_bf16_f32 v55, v64, v65
    v_exp_f32 v68, v68
    v_exp_f32 v69, v69
    v_cvt_pk_bf16_f32 v56, v66, v67
    v_exp_f32 v70, v70
    v_cvt_pk_bf16_f32 v57, v68, v69
    v_mfma_f32_32x32x16_bf16 v[78:93], v[22:25], v[14:17], v[142:157]
    ds_read_b128 v[30:33], v2 offset:27648
    v_exp_f32 v71, v71
    v_exp_f32 v72, v72
    v_exp_f32 v73, v73
    v_mfma_f32_32x32x16_bf16 v[110:125], v[34:37], v[58:61], v[110:125]
    ds_read_b128 v[18:21], v4 offset:27648
    v_exp_f32 v74, v74
    v_exp_f32 v75, v75
    v_exp_f32 v76, v76
    v_mfma_f32_32x32x16_bf16 v[94:109], v[38:41], v[54:57], v[94:109]
    ds_read_b128 v[34:37], v3 offset:27648
    s_waitcnt lgkmcnt(3)
    v_exp_f32 v77, v77
    v_cvt_pk_bf16_f32 v58, v70, v71
    v_cvt_pk_bf16_f32 v59, v72, v73
    v_cvt_pk_bf16_f32 v60, v74, v75
    v_exp_f32 v78, v78
    v_exp_f32 v79, v79
    v_cvt_pk_bf16_f32 v61, v76, v77
    v_exp_f32 v80, v80
    v_exp_f32 v81, v81
    v_cvt_pk_bf16_f32 v54, v78, v79
    v_exp_f32 v82, v82
    v_exp_f32 v83, v83
    v_cvt_pk_bf16_f32 v55, v80, v81
    v_exp_f32 v84, v84
    v_exp_f32 v85, v85
    v_cvt_pk_bf16_f32 v56, v82, v83
    v_exp_f32 v86, v86
    v_cvt_pk_bf16_f32 v57, v84, v85
    v_mfma_f32_32x32x16_bf16 v[62:77], v[26:29], v[10:13], v[126:141]
    v_exp_f32 v87, v87
    v_exp_f32 v88, v88
    v_exp_f32 v89, v89
    v_mfma_f32_32x32x16_bf16 v[94:109], v[42:45], v[58:61], v[94:109]
    v_exp_f32 v90, v90
    v_exp_f32 v91, v91
    v_exp_f32 v92, v92
    v_mfma_f32_32x32x16_bf16 v[110:125], v[38:41], v[54:57], v[110:125]
    v_exp_f32 v93, v93
    v_cvt_pk_bf16_f32 v58, v86, v87
    v_cvt_pk_bf16_f32 v59, v88, v89
    v_cvt_pk_bf16_f32 v60, v90, v91
    v_exp_f32 v62, v62
    v_exp_f32 v63, v63
    v_cvt_pk_bf16_f32 v61, v92, v93
    v_exp_f32 v64, v64
    v_exp_f32 v65, v65
    v_cvt_pk_bf16_f32 v54, v62, v63
    v_exp_f32 v66, v66
    v_exp_f32 v67, v67
    v_cvt_pk_bf16_f32 v55, v64, v65
    v_exp_f32 v68, v68
    v_exp_f32 v69, v69
    v_cvt_pk_bf16_f32 v56, v66, v67
    v_exp_f32 v70, v70
    v_cvt_pk_bf16_f32 v57, v68, v69
    v_mfma_f32_32x32x16_bf16 v[78:93], v[26:29], v[14:17], v[142:157]
    ds_read_b128 v[38:41], v2 offset:29952
    v_exp_f32 v71, v71
    v_exp_f32 v72, v72
    v_exp_f32 v73, v73
    v_mfma_f32_32x32x16_bf16 v[110:125], v[42:45], v[58:61], v[110:125]
    ds_read_b128 v[22:25], v4 offset:29952
    v_exp_f32 v74, v74
    v_exp_f32 v75, v75
    v_exp_f32 v76, v76
    v_mfma_f32_32x32x16_bf16 v[94:109], v[46:49], v[54:57], v[94:109]
    ds_read_b128 v[42:45], v3 offset:29952
    s_waitcnt lgkmcnt(3)
    v_exp_f32 v77, v77
    v_cvt_pk_bf16_f32 v58, v70, v71
    v_cvt_pk_bf16_f32 v59, v72, v73
    v_cvt_pk_bf16_f32 v60, v74, v75
    v_exp_f32 v78, v78
    v_exp_f32 v79, v79
    v_cvt_pk_bf16_f32 v61, v76, v77
    v_exp_f32 v80, v80
    v_exp_f32 v81, v81
    v_cvt_pk_bf16_f32 v54, v78, v79
    v_exp_f32 v82, v82
    v_exp_f32 v83, v83
    v_cvt_pk_bf16_f32 v55, v80, v81
    v_exp_f32 v84, v84
    v_exp_f32 v85, v85
    v_cvt_pk_bf16_f32 v56, v82, v83
    v_exp_f32 v86, v86
    v_cvt_pk_bf16_f32 v57, v84, v85
    v_mfma_f32_32x32x16_bf16 v[62:77], v[18:21], v[10:13], v[126:141]
    v_exp_f32 v87, v87
    v_exp_f32 v88, v88
    v_exp_f32 v89, v89
    v_mfma_f32_32x32x16_bf16 v[94:109], v[50:53], v[58:61], v[94:109]
    v_exp_f32 v90, v90
    v_exp_f32 v91, v91
    v_exp_f32 v92, v92
    v_mfma_f32_32x32x16_bf16 v[110:125], v[46:49], v[54:57], v[110:125]
    v_exp_f32 v93, v93
    v_cvt_pk_bf16_f32 v58, v86, v87
    v_cvt_pk_bf16_f32 v59, v88, v89
    v_cvt_pk_bf16_f32 v60, v90, v91
    v_exp_f32 v62, v62
    v_exp_f32 v63, v63
    v_cvt_pk_bf16_f32 v61, v92, v93
    v_exp_f32 v64, v64
    v_exp_f32 v65, v65
    v_cvt_pk_bf16_f32 v54, v62, v63
    v_exp_f32 v66, v66
    v_exp_f32 v67, v67
    v_cvt_pk_bf16_f32 v55, v64, v65
    v_exp_f32 v68, v68
    v_exp_f32 v69, v69
    v_cvt_pk_bf16_f32 v56, v66, v67
    v_exp_f32 v70, v70
    v_cvt_pk_bf16_f32 v57, v68, v69
    v_mfma_f32_32x32x16_bf16 v[78:93], v[18:21], v[14:17], v[142:157]
    ds_read_b128 v[46:49], v2 offset:32256
    v_exp_f32 v71, v71
    v_exp_f32 v72, v72
    v_exp_f32 v73, v73
    v_mfma_f32_32x32x16_bf16 v[110:125], v[50:53], v[58:61], v[110:125]
    ds_read_b128 v[26:29], v4 offset:32256
    v_exp_f32 v74, v74
    v_exp_f32 v75, v75
    v_exp_f32 v76, v76
    v_mfma_f32_32x32x16_bf16 v[94:109], v[30:33], v[54:57], v[94:109]
    ds_read_b128 v[50:53], v3 offset:32256
    s_waitcnt lgkmcnt(3)
    v_exp_f32 v77, v77
    v_cvt_pk_bf16_f32 v58, v70, v71
    v_cvt_pk_bf16_f32 v59, v72, v73
    v_cvt_pk_bf16_f32 v60, v74, v75
    v_exp_f32 v78, v78
    v_exp_f32 v79, v79
    v_cvt_pk_bf16_f32 v61, v76, v77
    v_exp_f32 v80, v80
    v_exp_f32 v81, v81
    v_cvt_pk_bf16_f32 v54, v78, v79
    v_exp_f32 v82, v82
    v_exp_f32 v83, v83
    v_cvt_pk_bf16_f32 v55, v80, v81
    v_exp_f32 v84, v84
    v_exp_f32 v85, v85
    v_cvt_pk_bf16_f32 v56, v82, v83
    v_exp_f32 v86, v86
    v_cvt_pk_bf16_f32 v57, v84, v85
    v_mfma_f32_32x32x16_bf16 v[62:77], v[22:25], v[10:13], v[126:141]
    v_exp_f32 v87, v87
    v_exp_f32 v88, v88
    v_exp_f32 v89, v89
    v_mfma_f32_32x32x16_bf16 v[94:109], v[34:37], v[58:61], v[94:109]
    v_exp_f32 v90, v90
    v_exp_f32 v91, v91
    v_exp_f32 v92, v92
    v_mfma_f32_32x32x16_bf16 v[110:125], v[30:33], v[54:57], v[110:125]
    v_exp_f32 v93, v93
    v_cvt_pk_bf16_f32 v58, v86, v87
    v_cvt_pk_bf16_f32 v59, v88, v89
    v_cvt_pk_bf16_f32 v60, v90, v91
    v_exp_f32 v62, v62
    v_exp_f32 v63, v63
    v_cvt_pk_bf16_f32 v61, v92, v93
    v_exp_f32 v64, v64
    v_exp_f32 v65, v65
    v_cvt_pk_bf16_f32 v54, v62, v63
    v_exp_f32 v66, v66
    v_exp_f32 v67, v67
    v_cvt_pk_bf16_f32 v55, v64, v65
    v_exp_f32 v68, v68
    v_exp_f32 v69, v69
    v_cvt_pk_bf16_f32 v56, v66, v67
    v_exp_f32 v70, v70
    v_cvt_pk_bf16_f32 v57, v68, v69
    v_mfma_f32_32x32x16_bf16 v[78:93], v[22:25], v[14:17], v[142:157]
    ds_read_b128 v[30:33], v2 offset:34560
    v_exp_f32 v71, v71
    v_exp_f32 v72, v72
    v_exp_f32 v73, v73
    v_mfma_f32_32x32x16_bf16 v[110:125], v[34:37], v[58:61], v[110:125]
    ds_read_b128 v[18:21], v4 offset:34560
    v_exp_f32 v74, v74
    v_exp_f32 v75, v75
    v_exp_f32 v76, v76
    v_mfma_f32_32x32x16_bf16 v[94:109], v[38:41], v[54:57], v[94:109]
    ds_read_b128 v[34:37], v3 offset:34560
    s_waitcnt lgkmcnt(3)
    v_exp_f32 v77, v77
    v_cvt_pk_bf16_f32 v58, v70, v71
    v_cvt_pk_bf16_f32 v59, v72, v73
    v_cvt_pk_bf16_f32 v60, v74, v75
    v_exp_f32 v78, v78
    v_exp_f32 v79, v79
    v_cvt_pk_bf16_f32 v61, v76, v77
    v_exp_f32 v80, v80
    v_exp_f32 v81, v81
    v_cvt_pk_bf16_f32 v54, v78, v79
    v_exp_f32 v82, v82
    v_exp_f32 v83, v83
    v_cvt_pk_bf16_f32 v55, v80, v81
    v_exp_f32 v84, v84
    v_exp_f32 v85, v85
    v_cvt_pk_bf16_f32 v56, v82, v83
    v_exp_f32 v86, v86
    v_cvt_pk_bf16_f32 v57, v84, v85
    v_mfma_f32_32x32x16_bf16 v[62:77], v[26:29], v[10:13], v[126:141]
    s_waitcnt vmcnt(0)
    s_barrier
    v_exp_f32 v87, v87
    v_exp_f32 v88, v88
    v_exp_f32 v89, v89
    v_mfma_f32_32x32x16_bf16 v[94:109], v[42:45], v[58:61], v[94:109]
    v_exp_f32 v90, v90
    v_exp_f32 v91, v91
    v_exp_f32 v92, v92
    v_mfma_f32_32x32x16_bf16 v[110:125], v[38:41], v[54:57], v[110:125]
    v_exp_f32 v93, v93
    v_cvt_pk_bf16_f32 v58, v86, v87
    v_cvt_pk_bf16_f32 v59, v88, v89
    v_cvt_pk_bf16_f32 v60, v90, v91
    v_exp_f32 v62, v62
    v_exp_f32 v63, v63
    v_cvt_pk_bf16_f32 v61, v92, v93
    v_exp_f32 v64, v64
    v_exp_f32 v65, v65
    v_cvt_pk_bf16_f32 v54, v62, v63
    v_exp_f32 v66, v66
    v_exp_f32 v67, v67
    v_cvt_pk_bf16_f32 v55, v64, v65
    v_exp_f32 v68, v68
    v_exp_f32 v69, v69
    v_cvt_pk_bf16_f32 v56, v66, v67
    v_exp_f32 v70, v70
    v_cvt_pk_bf16_f32 v57, v68, v69
    v_mfma_f32_32x32x16_bf16 v[78:93], v[26:29], v[14:17], v[142:157]
    ds_read_b128 v[38:41], v2 offset:36864
    v_exp_f32 v71, v71
    v_exp_f32 v72, v72
    v_exp_f32 v73, v73
    v_mfma_f32_32x32x16_bf16 v[110:125], v[42:45], v[58:61], v[110:125]
    ds_read_b128 v[22:25], v4 offset:36864
    v_exp_f32 v74, v74
    v_exp_f32 v75, v75
    v_exp_f32 v76, v76
    v_mfma_f32_32x32x16_bf16 v[94:109], v[46:49], v[54:57], v[94:109]
    ds_read_b128 v[42:45], v3 offset:36864
    s_waitcnt lgkmcnt(3)
    v_exp_f32 v77, v77
    v_cvt_pk_bf16_f32 v58, v70, v71
    v_cvt_pk_bf16_f32 v59, v72, v73
    v_cvt_pk_bf16_f32 v60, v74, v75
    v_exp_f32 v78, v78
    v_exp_f32 v79, v79
    v_cvt_pk_bf16_f32 v61, v76, v77
    v_exp_f32 v80, v80
    v_exp_f32 v81, v81
    v_cvt_pk_bf16_f32 v54, v78, v79
    v_exp_f32 v82, v82
    v_exp_f32 v83, v83
    v_cvt_pk_bf16_f32 v55, v80, v81
    v_exp_f32 v84, v84
    v_exp_f32 v85, v85
    v_cvt_pk_bf16_f32 v56, v82, v83
    v_exp_f32 v86, v86
    v_cvt_pk_bf16_f32 v57, v84, v85
    v_mfma_f32_32x32x16_bf16 v[62:77], v[18:21], v[10:13], v[126:141]
    s_add_u32 m0, s33, 0
    s_add_u32 s31, s36, 49152
    buffer_load_dwordx4 v1, s[8:11], s31 offen offset:0 lds
    v_exp_f32 v87, v87
    v_exp_f32 v88, v88
    v_exp_f32 v89, v89
    v_mfma_f32_32x32x16_bf16 v[94:109], v[50:53], v[58:61], v[94:109]
    v_exp_f32 v90, v90
    v_exp_f32 v91, v91
    v_exp_f32 v92, v92
    v_mfma_f32_32x32x16_bf16 v[110:125], v[46:49], v[54:57], v[110:125]
    s_add_u32 m0, s33, 0
    s_add_u32 s31, s36, 49152
    buffer_load_dwordx4 v1, s[8:11], s31 offen offset:1024 lds
    v_exp_f32 v93, v93
    v_cvt_pk_bf16_f32 v58, v86, v87
    v_cvt_pk_bf16_f32 v59, v88, v89
    v_cvt_pk_bf16_f32 v60, v90, v91
    v_exp_f32 v62, v62
    v_exp_f32 v63, v63
    v_cvt_pk_bf16_f32 v61, v92, v93
    v_exp_f32 v64, v64
    v_exp_f32 v65, v65
    v_cvt_pk_bf16_f32 v54, v62, v63
    v_exp_f32 v66, v66
    v_exp_f32 v67, v67
    v_cvt_pk_bf16_f32 v55, v64, v65
    v_exp_f32 v68, v68
    v_exp_f32 v69, v69
    v_cvt_pk_bf16_f32 v56, v66, v67
    v_exp_f32 v70, v70
    v_cvt_pk_bf16_f32 v57, v68, v69
    v_mfma_f32_32x32x16_bf16 v[78:93], v[18:21], v[14:17], v[142:157]
    ds_read_b128 v[46:49], v2 offset:39168
    v_exp_f32 v71, v71
    v_exp_f32 v72, v72
    v_exp_f32 v73, v73
    v_mfma_f32_32x32x16_bf16 v[110:125], v[50:53], v[58:61], v[110:125]
    ds_read_b128 v[26:29], v4 offset:39168
    v_exp_f32 v74, v74
    v_exp_f32 v75, v75
    v_exp_f32 v76, v76
    v_mfma_f32_32x32x16_bf16 v[94:109], v[30:33], v[54:57], v[94:109]
    ds_read_b128 v[50:53], v3 offset:39168
    s_waitcnt lgkmcnt(3)
    v_exp_f32 v77, v77
    v_cvt_pk_bf16_f32 v58, v70, v71
    v_cvt_pk_bf16_f32 v59, v72, v73
    v_cvt_pk_bf16_f32 v60, v74, v75
    v_exp_f32 v78, v78
    v_exp_f32 v79, v79
    v_cvt_pk_bf16_f32 v61, v76, v77
    v_exp_f32 v80, v80
    v_exp_f32 v81, v81
    v_cvt_pk_bf16_f32 v54, v78, v79
    v_exp_f32 v82, v82
    v_exp_f32 v83, v83
    v_cvt_pk_bf16_f32 v55, v80, v81
    v_exp_f32 v84, v84
    v_exp_f32 v85, v85
    v_cvt_pk_bf16_f32 v56, v82, v83
    v_exp_f32 v86, v86
    v_cvt_pk_bf16_f32 v57, v84, v85
    v_mfma_f32_32x32x16_bf16 v[62:77], v[22:25], v[10:13], v[126:141]
    s_add_u32 m0, s33, 9216
    s_add_u32 s31, s36, 57344
    buffer_load_dwordx4 v1, s[8:11], s31 offen offset:0 lds
    v_exp_f32 v87, v87
    v_exp_f32 v88, v88
    v_exp_f32 v89, v89
    v_mfma_f32_32x32x16_bf16 v[94:109], v[34:37], v[58:61], v[94:109]
    v_exp_f32 v90, v90
    v_exp_f32 v91, v91
    v_exp_f32 v92, v92
    v_mfma_f32_32x32x16_bf16 v[110:125], v[30:33], v[54:57], v[110:125]
    s_add_u32 m0, s33, 9216
    s_add_u32 s31, s36, 57344
    buffer_load_dwordx4 v1, s[8:11], s31 offen offset:1024 lds
    v_exp_f32 v93, v93
    v_cvt_pk_bf16_f32 v58, v86, v87
    v_cvt_pk_bf16_f32 v59, v88, v89
    v_cvt_pk_bf16_f32 v60, v90, v91
    v_exp_f32 v62, v62
    v_exp_f32 v63, v63
    v_cvt_pk_bf16_f32 v61, v92, v93
    v_exp_f32 v64, v64
    v_exp_f32 v65, v65
    v_cvt_pk_bf16_f32 v54, v62, v63
    v_exp_f32 v66, v66
    v_exp_f32 v67, v67
    v_cvt_pk_bf16_f32 v55, v64, v65
    v_exp_f32 v68, v68
    v_exp_f32 v69, v69
    v_cvt_pk_bf16_f32 v56, v66, v67
    v_exp_f32 v70, v70
    v_cvt_pk_bf16_f32 v57, v68, v69
    v_mfma_f32_32x32x16_bf16 v[78:93], v[22:25], v[14:17], v[142:157]
    ds_read_b128 v[30:33], v2 offset:41472
    v_exp_f32 v71, v71
    v_exp_f32 v72, v72
    v_exp_f32 v73, v73
    v_mfma_f32_32x32x16_bf16 v[110:125], v[34:37], v[58:61], v[110:125]
    ds_read_b128 v[18:21], v4 offset:41472
    v_exp_f32 v74, v74
    v_exp_f32 v75, v75
    v_exp_f32 v76, v76
    v_mfma_f32_32x32x16_bf16 v[94:109], v[38:41], v[54:57], v[94:109]
    ds_read_b128 v[34:37], v3 offset:41472
    s_waitcnt lgkmcnt(3)
    v_exp_f32 v77, v77
    v_cvt_pk_bf16_f32 v58, v70, v71
    v_cvt_pk_bf16_f32 v59, v72, v73
    v_cvt_pk_bf16_f32 v60, v74, v75
    v_exp_f32 v78, v78
    v_exp_f32 v79, v79
    v_cvt_pk_bf16_f32 v61, v76, v77
    v_exp_f32 v80, v80
    v_exp_f32 v81, v81
    v_cvt_pk_bf16_f32 v54, v78, v79
    v_exp_f32 v82, v82
    v_exp_f32 v83, v83
    v_cvt_pk_bf16_f32 v55, v80, v81
    v_exp_f32 v84, v84
    v_exp_f32 v85, v85
    v_cvt_pk_bf16_f32 v56, v82, v83
    v_exp_f32 v86, v86
    v_cvt_pk_bf16_f32 v57, v84, v85
    v_mfma_f32_32x32x16_bf16 v[62:77], v[26:29], v[10:13], v[126:141]
    v_exp_f32 v87, v87
    v_exp_f32 v88, v88
    v_exp_f32 v89, v89
    v_mfma_f32_32x32x16_bf16 v[94:109], v[42:45], v[58:61], v[94:109]
    v_exp_f32 v90, v90
    v_exp_f32 v91, v91
    v_exp_f32 v92, v92
    v_mfma_f32_32x32x16_bf16 v[110:125], v[38:41], v[54:57], v[110:125]
    v_exp_f32 v93, v93
    v_cvt_pk_bf16_f32 v58, v86, v87
    v_cvt_pk_bf16_f32 v59, v88, v89
    v_cvt_pk_bf16_f32 v60, v90, v91
    v_exp_f32 v62, v62
    v_exp_f32 v63, v63
    v_cvt_pk_bf16_f32 v61, v92, v93
    v_exp_f32 v64, v64
    v_exp_f32 v65, v65
    v_cvt_pk_bf16_f32 v54, v62, v63
    v_exp_f32 v66, v66
    v_exp_f32 v67, v67
    v_cvt_pk_bf16_f32 v55, v64, v65
    v_exp_f32 v68, v68
    v_exp_f32 v69, v69
    v_cvt_pk_bf16_f32 v56, v66, v67
    v_exp_f32 v70, v70
    v_cvt_pk_bf16_f32 v57, v68, v69
    v_mfma_f32_32x32x16_bf16 v[78:93], v[26:29], v[14:17], v[142:157]
    ds_read_b128 v[38:41], v2 offset:43776
    v_exp_f32 v71, v71
    v_exp_f32 v72, v72
    v_exp_f32 v73, v73
    v_mfma_f32_32x32x16_bf16 v[110:125], v[42:45], v[58:61], v[110:125]
    ds_read_b128 v[22:25], v4 offset:43776
    v_exp_f32 v74, v74
    v_exp_f32 v75, v75
    v_exp_f32 v76, v76
    v_mfma_f32_32x32x16_bf16 v[94:109], v[46:49], v[54:57], v[94:109]
    ds_read_b128 v[42:45], v3 offset:43776
    s_waitcnt lgkmcnt(3)
    v_exp_f32 v77, v77
    v_cvt_pk_bf16_f32 v58, v70, v71
    v_cvt_pk_bf16_f32 v59, v72, v73
    v_cvt_pk_bf16_f32 v60, v74, v75
    v_exp_f32 v78, v78
    v_exp_f32 v79, v79
    v_cvt_pk_bf16_f32 v61, v76, v77
    v_exp_f32 v80, v80
    v_exp_f32 v81, v81
    v_cvt_pk_bf16_f32 v54, v78, v79
    v_exp_f32 v82, v82
    v_exp_f32 v83, v83
    v_cvt_pk_bf16_f32 v55, v80, v81
    v_exp_f32 v84, v84
    v_exp_f32 v85, v85
    v_cvt_pk_bf16_f32 v56, v82, v83
    v_exp_f32 v86, v86
    v_cvt_pk_bf16_f32 v57, v84, v85
    v_mfma_f32_32x32x16_bf16 v[62:77], v[18:21], v[10:13], v[126:141]
    v_exp_f32 v87, v87
    v_exp_f32 v88, v88
    v_exp_f32 v89, v89
    v_mfma_f32_32x32x16_bf16 v[94:109], v[50:53], v[58:61], v[94:109]
    v_exp_f32 v90, v90
    v_exp_f32 v91, v91
    v_exp_f32 v92, v92
    v_mfma_f32_32x32x16_bf16 v[110:125], v[46:49], v[54:57], v[110:125]
    v_exp_f32 v93, v93
    v_cvt_pk_bf16_f32 v58, v86, v87
    v_cvt_pk_bf16_f32 v59, v88, v89
    v_cvt_pk_bf16_f32 v60, v90, v91
    v_exp_f32 v62, v62
    v_exp_f32 v63, v63
    v_cvt_pk_bf16_f32 v61, v92, v93
    v_exp_f32 v64, v64
    v_exp_f32 v65, v65
    v_cvt_pk_bf16_f32 v54, v62, v63
    v_exp_f32 v66, v66
    v_exp_f32 v67, v67
    v_cvt_pk_bf16_f32 v55, v64, v65
    v_exp_f32 v68, v68
    v_exp_f32 v69, v69
    v_cvt_pk_bf16_f32 v56, v66, v67
    v_exp_f32 v70, v70
    v_cvt_pk_bf16_f32 v57, v68, v69
    v_mfma_f32_32x32x16_bf16 v[78:93], v[18:21], v[14:17], v[142:157]
    ds_read_b128 v[46:49], v2 offset:46080
    v_exp_f32 v71, v71
    v_exp_f32 v72, v72
    v_exp_f32 v73, v73
    v_mfma_f32_32x32x16_bf16 v[110:125], v[50:53], v[58:61], v[110:125]
    ds_read_b128 v[26:29], v4 offset:46080
    v_exp_f32 v74, v74
    v_exp_f32 v75, v75
    v_exp_f32 v76, v76
    v_mfma_f32_32x32x16_bf16 v[94:109], v[30:33], v[54:57], v[94:109]
    ds_read_b128 v[50:53], v3 offset:46080
    s_waitcnt lgkmcnt(3)
    v_exp_f32 v77, v77
    v_cvt_pk_bf16_f32 v58, v70, v71
    v_cvt_pk_bf16_f32 v59, v72, v73
    v_cvt_pk_bf16_f32 v60, v74, v75
    v_exp_f32 v78, v78
    v_exp_f32 v79, v79
    v_cvt_pk_bf16_f32 v61, v76, v77
    v_exp_f32 v80, v80
    v_exp_f32 v81, v81
    v_cvt_pk_bf16_f32 v54, v78, v79
    v_exp_f32 v82, v82
    v_exp_f32 v83, v83
    v_cvt_pk_bf16_f32 v55, v80, v81
    v_exp_f32 v84, v84
    v_exp_f32 v85, v85
    v_cvt_pk_bf16_f32 v56, v82, v83
    v_exp_f32 v86, v86
    v_cvt_pk_bf16_f32 v57, v84, v85
    v_mfma_f32_32x32x16_bf16 v[62:77], v[22:25], v[10:13], v[126:141]
    v_exp_f32 v87, v87
    v_exp_f32 v88, v88
    v_exp_f32 v89, v89
    v_mfma_f32_32x32x16_bf16 v[94:109], v[34:37], v[58:61], v[94:109]
    v_exp_f32 v90, v90
    v_exp_f32 v91, v91
    v_exp_f32 v92, v92
    v_mfma_f32_32x32x16_bf16 v[110:125], v[30:33], v[54:57], v[110:125]
    v_exp_f32 v93, v93
    v_cvt_pk_bf16_f32 v58, v86, v87
    v_cvt_pk_bf16_f32 v59, v88, v89
    v_cvt_pk_bf16_f32 v60, v90, v91
    v_exp_f32 v62, v62
    v_exp_f32 v63, v63
    v_cvt_pk_bf16_f32 v61, v92, v93
    v_exp_f32 v64, v64
    v_exp_f32 v65, v65
    v_cvt_pk_bf16_f32 v54, v62, v63
    v_exp_f32 v66, v66
    v_exp_f32 v67, v67
    v_cvt_pk_bf16_f32 v55, v64, v65
    v_exp_f32 v68, v68
    v_exp_f32 v69, v69
    v_cvt_pk_bf16_f32 v56, v66, v67
    v_exp_f32 v70, v70
    v_cvt_pk_bf16_f32 v57, v68, v69
    v_mfma_f32_32x32x16_bf16 v[78:93], v[22:25], v[14:17], v[142:157]
    ds_read_b128 v[30:33], v2 offset:48384
    v_exp_f32 v71, v71
    v_exp_f32 v72, v72
    v_exp_f32 v73, v73
    v_mfma_f32_32x32x16_bf16 v[110:125], v[34:37], v[58:61], v[110:125]
    ds_read_b128 v[18:21], v4 offset:48384
    v_exp_f32 v74, v74
    v_exp_f32 v75, v75
    v_exp_f32 v76, v76
    v_mfma_f32_32x32x16_bf16 v[94:109], v[38:41], v[54:57], v[94:109]
    ds_read_b128 v[34:37], v3 offset:48384
    s_waitcnt lgkmcnt(3)
    v_exp_f32 v77, v77
    v_cvt_pk_bf16_f32 v58, v70, v71
    v_cvt_pk_bf16_f32 v59, v72, v73
    v_cvt_pk_bf16_f32 v60, v74, v75
    v_exp_f32 v78, v78
    v_exp_f32 v79, v79
    v_cvt_pk_bf16_f32 v61, v76, v77
    v_exp_f32 v80, v80
    v_exp_f32 v81, v81
    v_cvt_pk_bf16_f32 v54, v78, v79
    v_exp_f32 v82, v82
    v_exp_f32 v83, v83
    v_cvt_pk_bf16_f32 v55, v80, v81
    v_exp_f32 v84, v84
    v_exp_f32 v85, v85
    v_cvt_pk_bf16_f32 v56, v82, v83
    v_exp_f32 v86, v86
    v_cvt_pk_bf16_f32 v57, v84, v85
    v_mfma_f32_32x32x16_bf16 v[62:77], v[26:29], v[10:13], v[126:141]
    v_exp_f32 v87, v87
    v_exp_f32 v88, v88
    v_exp_f32 v89, v89
    v_mfma_f32_32x32x16_bf16 v[94:109], v[42:45], v[58:61], v[94:109]
    v_exp_f32 v90, v90
    v_exp_f32 v91, v91
    v_exp_f32 v92, v92
    v_mfma_f32_32x32x16_bf16 v[110:125], v[38:41], v[54:57], v[110:125]
    v_exp_f32 v93, v93
    v_cvt_pk_bf16_f32 v58, v86, v87
    v_cvt_pk_bf16_f32 v59, v88, v89
    v_cvt_pk_bf16_f32 v60, v90, v91
    v_exp_f32 v62, v62
    v_exp_f32 v63, v63
    v_cvt_pk_bf16_f32 v61, v92, v93
    v_exp_f32 v64, v64
    v_exp_f32 v65, v65
    v_cvt_pk_bf16_f32 v54, v62, v63
    v_exp_f32 v66, v66
    v_exp_f32 v67, v67
    v_cvt_pk_bf16_f32 v55, v64, v65
    v_exp_f32 v68, v68
    v_exp_f32 v69, v69
    v_cvt_pk_bf16_f32 v56, v66, v67
    v_exp_f32 v70, v70
    v_cvt_pk_bf16_f32 v57, v68, v69
    v_mfma_f32_32x32x16_bf16 v[78:93], v[26:29], v[14:17], v[142:157]
    ds_read_b128 v[38:41], v2 offset:50688
    v_exp_f32 v71, v71
    v_exp_f32 v72, v72
    v_exp_f32 v73, v73
    v_mfma_f32_32x32x16_bf16 v[110:125], v[42:45], v[58:61], v[110:125]
    ds_read_b128 v[22:25], v4 offset:50688
    v_exp_f32 v74, v74
    v_exp_f32 v75, v75
    v_exp_f32 v76, v76
    v_mfma_f32_32x32x16_bf16 v[94:109], v[46:49], v[54:57], v[94:109]
    ds_read_b128 v[42:45], v3 offset:50688
    s_waitcnt lgkmcnt(3)
    v_exp_f32 v77, v77
    v_cvt_pk_bf16_f32 v58, v70, v71
    v_cvt_pk_bf16_f32 v59, v72, v73
    v_cvt_pk_bf16_f32 v60, v74, v75
    v_exp_f32 v78, v78
    v_exp_f32 v79, v79
    v_cvt_pk_bf16_f32 v61, v76, v77
    v_exp_f32 v80, v80
    v_exp_f32 v81, v81
    v_cvt_pk_bf16_f32 v54, v78, v79
    v_exp_f32 v82, v82
    v_exp_f32 v83, v83
    v_cvt_pk_bf16_f32 v55, v80, v81
    v_exp_f32 v84, v84
    v_exp_f32 v85, v85
    v_cvt_pk_bf16_f32 v56, v82, v83
    v_exp_f32 v86, v86
    v_cvt_pk_bf16_f32 v57, v84, v85
    v_mfma_f32_32x32x16_bf16 v[62:77], v[18:21], v[10:13], v[126:141]
    v_exp_f32 v87, v87
    v_exp_f32 v88, v88
    v_exp_f32 v89, v89
    v_mfma_f32_32x32x16_bf16 v[94:109], v[50:53], v[58:61], v[94:109]
    v_exp_f32 v90, v90
    v_exp_f32 v91, v91
    v_exp_f32 v92, v92
    v_mfma_f32_32x32x16_bf16 v[110:125], v[46:49], v[54:57], v[110:125]
    v_exp_f32 v93, v93
    v_cvt_pk_bf16_f32 v58, v86, v87
    v_cvt_pk_bf16_f32 v59, v88, v89
    v_cvt_pk_bf16_f32 v60, v90, v91
    v_exp_f32 v62, v62
    v_exp_f32 v63, v63
    v_cvt_pk_bf16_f32 v61, v92, v93
    v_exp_f32 v64, v64
    v_exp_f32 v65, v65
    v_cvt_pk_bf16_f32 v54, v62, v63
    v_exp_f32 v66, v66
    v_exp_f32 v67, v67
    v_cvt_pk_bf16_f32 v55, v64, v65
    v_exp_f32 v68, v68
    v_exp_f32 v69, v69
    v_cvt_pk_bf16_f32 v56, v66, v67
    v_exp_f32 v70, v70
    v_cvt_pk_bf16_f32 v57, v68, v69
    v_mfma_f32_32x32x16_bf16 v[78:93], v[18:21], v[14:17], v[142:157]
    ds_read_b128 v[46:49], v2 offset:52992
    v_exp_f32 v71, v71
    v_exp_f32 v72, v72
    v_exp_f32 v73, v73
    v_mfma_f32_32x32x16_bf16 v[110:125], v[50:53], v[58:61], v[110:125]
    ds_read_b128 v[26:29], v4 offset:52992
    v_exp_f32 v74, v74
    v_exp_f32 v75, v75
    v_exp_f32 v76, v76
    v_mfma_f32_32x32x16_bf16 v[94:109], v[30:33], v[54:57], v[94:109]
    ds_read_b128 v[50:53], v3 offset:52992
    s_waitcnt lgkmcnt(3)
    v_exp_f32 v77, v77
    v_cvt_pk_bf16_f32 v58, v70, v71
    v_cvt_pk_bf16_f32 v59, v72, v73
    v_cvt_pk_bf16_f32 v60, v74, v75
    v_exp_f32 v78, v78
    v_exp_f32 v79, v79
    v_cvt_pk_bf16_f32 v61, v76, v77
    v_exp_f32 v80, v80
    v_exp_f32 v81, v81
    v_cvt_pk_bf16_f32 v54, v78, v79
    v_exp_f32 v82, v82
    v_exp_f32 v83, v83
    v_cvt_pk_bf16_f32 v55, v80, v81
    v_exp_f32 v84, v84
    v_exp_f32 v85, v85
    v_cvt_pk_bf16_f32 v56, v82, v83
    v_exp_f32 v86, v86
    v_cvt_pk_bf16_f32 v57, v84, v85
    v_mfma_f32_32x32x16_bf16 v[62:77], v[22:25], v[10:13], v[126:141]
    s_waitcnt vmcnt(0)
    s_barrier
    v_exp_f32 v87, v87
    v_exp_f32 v88, v88
    v_exp_f32 v89, v89
    v_mfma_f32_32x32x16_bf16 v[94:109], v[34:37], v[58:61], v[94:109]
    v_exp_f32 v90, v90
    v_exp_f32 v91, v91
    v_exp_f32 v92, v92
    v_mfma_f32_32x32x16_bf16 v[110:125], v[30:33], v[54:57], v[110:125]
    v_exp_f32 v93, v93
    v_cvt_pk_bf16_f32 v58, v86, v87
    v_cvt_pk_bf16_f32 v59, v88, v89
    v_cvt_pk_bf16_f32 v60, v90, v91
    v_exp_f32 v62, v62
    v_exp_f32 v63, v63
    v_cvt_pk_bf16_f32 v61, v92, v93
    v_exp_f32 v64, v64
    v_exp_f32 v65, v65
    v_cvt_pk_bf16_f32 v54, v62, v63
    v_exp_f32 v66, v66
    v_exp_f32 v67, v67
    v_cvt_pk_bf16_f32 v55, v64, v65
    v_exp_f32 v68, v68
    v_exp_f32 v69, v69
    v_cvt_pk_bf16_f32 v56, v66, v67
    v_exp_f32 v70, v70
    v_cvt_pk_bf16_f32 v57, v68, v69
    v_mfma_f32_32x32x16_bf16 v[78:93], v[22:25], v[14:17], v[142:157]
    ds_read_b128 v[30:33], v2 offset:0
    v_exp_f32 v71, v71
    v_exp_f32 v72, v72
    v_exp_f32 v73, v73
    v_mfma_f32_32x32x16_bf16 v[110:125], v[34:37], v[58:61], v[110:125]
    ds_read_b128 v[18:21], v4 offset:0
    v_exp_f32 v74, v74
    v_exp_f32 v75, v75
    v_exp_f32 v76, v76
    v_mfma_f32_32x32x16_bf16 v[94:109], v[38:41], v[54:57], v[94:109]
    ds_read_b128 v[34:37], v3 offset:0
    s_waitcnt lgkmcnt(3)
    v_exp_f32 v77, v77
    v_cvt_pk_bf16_f32 v58, v70, v71
    v_cvt_pk_bf16_f32 v59, v72, v73
    v_cvt_pk_bf16_f32 v60, v74, v75
    v_exp_f32 v78, v78
    v_exp_f32 v79, v79
    v_cvt_pk_bf16_f32 v61, v76, v77
    v_exp_f32 v80, v80
    v_exp_f32 v81, v81
    v_cvt_pk_bf16_f32 v54, v78, v79
    v_exp_f32 v82, v82
    v_exp_f32 v83, v83
    v_cvt_pk_bf16_f32 v55, v80, v81
    v_exp_f32 v84, v84
    v_exp_f32 v85, v85
    v_cvt_pk_bf16_f32 v56, v82, v83
    v_exp_f32 v86, v86
    v_cvt_pk_bf16_f32 v57, v84, v85
    v_mfma_f32_32x32x16_bf16 v[62:77], v[26:29], v[10:13], v[126:141]
    s_add_u32 m0, s33, 18432
    s_add_u32 s31, s36, 65536
    buffer_load_dwordx4 v1, s[8:11], s31 offen offset:0 lds
    v_exp_f32 v87, v87
    v_exp_f32 v88, v88
    v_exp_f32 v89, v89
    v_mfma_f32_32x32x16_bf16 v[94:109], v[42:45], v[58:61], v[94:109]
    v_exp_f32 v90, v90
    v_exp_f32 v91, v91
    v_exp_f32 v92, v92
    v_mfma_f32_32x32x16_bf16 v[110:125], v[38:41], v[54:57], v[110:125]
    s_add_u32 m0, s33, 18432
    s_add_u32 s31, s36, 65536
    buffer_load_dwordx4 v1, s[8:11], s31 offen offset:1024 lds
    v_exp_f32 v93, v93
    v_cvt_pk_bf16_f32 v58, v86, v87
    v_cvt_pk_bf16_f32 v59, v88, v89
    v_cvt_pk_bf16_f32 v60, v90, v91
    v_exp_f32 v62, v62
    v_exp_f32 v63, v63
    v_cvt_pk_bf16_f32 v61, v92, v93
    v_exp_f32 v64, v64
    v_exp_f32 v65, v65
    v_cvt_pk_bf16_f32 v54, v62, v63
    v_exp_f32 v66, v66
    v_exp_f32 v67, v67
    v_cvt_pk_bf16_f32 v55, v64, v65
    v_exp_f32 v68, v68
    v_exp_f32 v69, v69
    v_cvt_pk_bf16_f32 v56, v66, v67
    v_exp_f32 v70, v70
    v_cvt_pk_bf16_f32 v57, v68, v69
    v_mfma_f32_32x32x16_bf16 v[78:93], v[26:29], v[14:17], v[142:157]
    ds_read_b128 v[38:41], v2 offset:2304
    v_exp_f32 v71, v71
    v_exp_f32 v72, v72
    v_exp_f32 v73, v73
    v_mfma_f32_32x32x16_bf16 v[110:125], v[42:45], v[58:61], v[110:125]
    ds_read_b128 v[22:25], v4 offset:2304
    v_exp_f32 v74, v74
    v_exp_f32 v75, v75
    v_exp_f32 v76, v76
    v_mfma_f32_32x32x16_bf16 v[94:109], v[46:49], v[54:57], v[94:109]
    ds_read_b128 v[42:45], v3 offset:2304
    s_waitcnt lgkmcnt(3)
    v_exp_f32 v77, v77
    v_cvt_pk_bf16_f32 v58, v70, v71
    v_cvt_pk_bf16_f32 v59, v72, v73
    v_cvt_pk_bf16_f32 v60, v74, v75
    v_exp_f32 v78, v78
    v_exp_f32 v79, v79
    v_cvt_pk_bf16_f32 v61, v76, v77
    v_exp_f32 v80, v80
    v_exp_f32 v81, v81
    v_cvt_pk_bf16_f32 v54, v78, v79
    v_exp_f32 v82, v82
    v_exp_f32 v83, v83
    v_cvt_pk_bf16_f32 v55, v80, v81
    v_exp_f32 v84, v84
    v_exp_f32 v85, v85
    v_cvt_pk_bf16_f32 v56, v82, v83
    v_exp_f32 v86, v86
    v_cvt_pk_bf16_f32 v57, v84, v85
    v_mfma_f32_32x32x16_bf16 v[62:77], v[18:21], v[10:13], v[126:141]
    s_add_u32 m0, s33, 27648
    s_add_u32 s31, s36, 73728
    buffer_load_dwordx4 v1, s[8:11], s31 offen offset:0 lds
    v_exp_f32 v87, v87
    v_exp_f32 v88, v88
    v_exp_f32 v89, v89
    v_mfma_f32_32x32x16_bf16 v[94:109], v[50:53], v[58:61], v[94:109]
    v_exp_f32 v90, v90
    v_exp_f32 v91, v91
    v_exp_f32 v92, v92
    v_mfma_f32_32x32x16_bf16 v[110:125], v[46:49], v[54:57], v[110:125]
    s_add_u32 m0, s33, 27648
    s_add_u32 s31, s36, 73728
    buffer_load_dwordx4 v1, s[8:11], s31 offen offset:1024 lds
    v_exp_f32 v93, v93
    v_cvt_pk_bf16_f32 v58, v86, v87
    v_cvt_pk_bf16_f32 v59, v88, v89
    v_cvt_pk_bf16_f32 v60, v90, v91
    v_exp_f32 v62, v62
    v_exp_f32 v63, v63
    v_cvt_pk_bf16_f32 v61, v92, v93
    v_exp_f32 v64, v64
    v_exp_f32 v65, v65
    v_cvt_pk_bf16_f32 v54, v62, v63
    v_exp_f32 v66, v66
    v_exp_f32 v67, v67
    v_cvt_pk_bf16_f32 v55, v64, v65
    v_exp_f32 v68, v68
    v_exp_f32 v69, v69
    v_cvt_pk_bf16_f32 v56, v66, v67
    v_exp_f32 v70, v70
    v_cvt_pk_bf16_f32 v57, v68, v69
    v_mfma_f32_32x32x16_bf16 v[78:93], v[18:21], v[14:17], v[142:157]
    ds_read_b128 v[46:49], v2 offset:4608
    v_exp_f32 v71, v71
    v_exp_f32 v72, v72
    v_exp_f32 v73, v73
    v_mfma_f32_32x32x16_bf16 v[110:125], v[50:53], v[58:61], v[110:125]
    ds_read_b128 v[26:29], v4 offset:4608
    v_exp_f32 v74, v74
    v_exp_f32 v75, v75
    v_exp_f32 v76, v76
    v_mfma_f32_32x32x16_bf16 v[94:109], v[30:33], v[54:57], v[94:109]
    ds_read_b128 v[50:53], v3 offset:4608
    s_waitcnt lgkmcnt(3)
    v_exp_f32 v77, v77
    v_cvt_pk_bf16_f32 v58, v70, v71
    v_cvt_pk_bf16_f32 v59, v72, v73
    v_cvt_pk_bf16_f32 v60, v74, v75
    v_exp_f32 v78, v78
    v_exp_f32 v79, v79
    v_cvt_pk_bf16_f32 v61, v76, v77
    v_exp_f32 v80, v80
    v_exp_f32 v81, v81
    v_cvt_pk_bf16_f32 v54, v78, v79
    v_exp_f32 v82, v82
    v_exp_f32 v83, v83
    v_cvt_pk_bf16_f32 v55, v80, v81
    v_exp_f32 v84, v84
    v_exp_f32 v85, v85
    v_cvt_pk_bf16_f32 v56, v82, v83
    v_exp_f32 v86, v86
    v_cvt_pk_bf16_f32 v57, v84, v85
    v_mfma_f32_32x32x16_bf16 v[62:77], v[22:25], v[10:13], v[126:141]
    v_exp_f32 v87, v87
    v_exp_f32 v88, v88
    v_exp_f32 v89, v89
    v_mfma_f32_32x32x16_bf16 v[94:109], v[34:37], v[58:61], v[94:109]
    v_exp_f32 v90, v90
    v_exp_f32 v91, v91
    v_exp_f32 v92, v92
    v_mfma_f32_32x32x16_bf16 v[110:125], v[30:33], v[54:57], v[110:125]
    v_exp_f32 v93, v93
    v_cvt_pk_bf16_f32 v58, v86, v87
    v_cvt_pk_bf16_f32 v59, v88, v89
    v_cvt_pk_bf16_f32 v60, v90, v91
    v_exp_f32 v62, v62
    v_exp_f32 v63, v63
    v_cvt_pk_bf16_f32 v61, v92, v93
    v_exp_f32 v64, v64
    v_exp_f32 v65, v65
    v_cvt_pk_bf16_f32 v54, v62, v63
    v_exp_f32 v66, v66
    v_exp_f32 v67, v67
    v_cvt_pk_bf16_f32 v55, v64, v65
    v_exp_f32 v68, v68
    v_exp_f32 v69, v69
    v_cvt_pk_bf16_f32 v56, v66, v67
    v_exp_f32 v70, v70
    v_cvt_pk_bf16_f32 v57, v68, v69
    v_mfma_f32_32x32x16_bf16 v[78:93], v[22:25], v[14:17], v[142:157]
    ds_read_b128 v[30:33], v2 offset:6912
    v_exp_f32 v71, v71
    v_exp_f32 v72, v72
    v_exp_f32 v73, v73
    v_mfma_f32_32x32x16_bf16 v[110:125], v[34:37], v[58:61], v[110:125]
    ds_read_b128 v[18:21], v4 offset:6912
    v_exp_f32 v74, v74
    v_exp_f32 v75, v75
    v_exp_f32 v76, v76
    v_mfma_f32_32x32x16_bf16 v[94:109], v[38:41], v[54:57], v[94:109]
    ds_read_b128 v[34:37], v3 offset:6912
    s_waitcnt lgkmcnt(3)
    v_exp_f32 v77, v77
    v_cvt_pk_bf16_f32 v58, v70, v71
    v_cvt_pk_bf16_f32 v59, v72, v73
    v_cvt_pk_bf16_f32 v60, v74, v75
    v_exp_f32 v78, v78
    v_exp_f32 v79, v79
    v_cvt_pk_bf16_f32 v61, v76, v77
    v_exp_f32 v80, v80
    v_exp_f32 v81, v81
    v_cvt_pk_bf16_f32 v54, v78, v79
    v_exp_f32 v82, v82
    v_exp_f32 v83, v83
    v_cvt_pk_bf16_f32 v55, v80, v81
    v_exp_f32 v84, v84
    v_exp_f32 v85, v85
    v_cvt_pk_bf16_f32 v56, v82, v83
    v_exp_f32 v86, v86
    v_cvt_pk_bf16_f32 v57, v84, v85
    v_mfma_f32_32x32x16_bf16 v[62:77], v[26:29], v[10:13], v[126:141]
    v_exp_f32 v87, v87
    v_exp_f32 v88, v88
    v_exp_f32 v89, v89
    v_mfma_f32_32x32x16_bf16 v[94:109], v[42:45], v[58:61], v[94:109]
    v_exp_f32 v90, v90
    v_exp_f32 v91, v91
    v_exp_f32 v92, v92
    v_mfma_f32_32x32x16_bf16 v[110:125], v[38:41], v[54:57], v[110:125]
    v_exp_f32 v93, v93
    v_cvt_pk_bf16_f32 v58, v86, v87
    v_cvt_pk_bf16_f32 v59, v88, v89
    v_cvt_pk_bf16_f32 v60, v90, v91
    v_exp_f32 v62, v62
    v_exp_f32 v63, v63
    v_cvt_pk_bf16_f32 v61, v92, v93
    v_exp_f32 v64, v64
    v_exp_f32 v65, v65
    v_cvt_pk_bf16_f32 v54, v62, v63
    v_exp_f32 v66, v66
    v_exp_f32 v67, v67
    v_cvt_pk_bf16_f32 v55, v64, v65
    v_exp_f32 v68, v68
    v_exp_f32 v69, v69
    v_cvt_pk_bf16_f32 v56, v66, v67
    v_exp_f32 v70, v70
    v_cvt_pk_bf16_f32 v57, v68, v69
    v_mfma_f32_32x32x16_bf16 v[78:93], v[26:29], v[14:17], v[142:157]
    ds_read_b128 v[38:41], v2 offset:9216
    v_exp_f32 v71, v71
    v_exp_f32 v72, v72
    v_exp_f32 v73, v73
    v_mfma_f32_32x32x16_bf16 v[110:125], v[42:45], v[58:61], v[110:125]
    ds_read_b128 v[22:25], v4 offset:9216
    v_exp_f32 v74, v74
    v_exp_f32 v75, v75
    v_exp_f32 v76, v76
    v_mfma_f32_32x32x16_bf16 v[94:109], v[46:49], v[54:57], v[94:109]
    ds_read_b128 v[42:45], v3 offset:9216
    s_waitcnt lgkmcnt(3)
    v_exp_f32 v77, v77
    v_cvt_pk_bf16_f32 v58, v70, v71
    v_cvt_pk_bf16_f32 v59, v72, v73
    v_cvt_pk_bf16_f32 v60, v74, v75
    v_exp_f32 v78, v78
    v_exp_f32 v79, v79
    v_cvt_pk_bf16_f32 v61, v76, v77
    v_exp_f32 v80, v80
    v_exp_f32 v81, v81
    v_cvt_pk_bf16_f32 v54, v78, v79
    v_exp_f32 v82, v82
    v_exp_f32 v83, v83
    v_cvt_pk_bf16_f32 v55, v80, v81
    v_exp_f32 v84, v84
    v_exp_f32 v85, v85
    v_cvt_pk_bf16_f32 v56, v82, v83
    v_exp_f32 v86, v86
    v_cvt_pk_bf16_f32 v57, v84, v85
    v_mfma_f32_32x32x16_bf16 v[62:77], v[18:21], v[10:13], v[126:141]
    v_exp_f32 v87, v87
    v_exp_f32 v88, v88
    v_exp_f32 v89, v89
    v_mfma_f32_32x32x16_bf16 v[94:109], v[50:53], v[58:61], v[94:109]
    v_exp_f32 v90, v90
    v_exp_f32 v91, v91
    v_exp_f32 v92, v92
    v_mfma_f32_32x32x16_bf16 v[110:125], v[46:49], v[54:57], v[110:125]
    v_exp_f32 v93, v93
    v_cvt_pk_bf16_f32 v58, v86, v87
    v_cvt_pk_bf16_f32 v59, v88, v89
    v_cvt_pk_bf16_f32 v60, v90, v91
    v_exp_f32 v62, v62
    v_exp_f32 v63, v63
    v_cvt_pk_bf16_f32 v61, v92, v93
    v_exp_f32 v64, v64
    v_exp_f32 v65, v65
    v_cvt_pk_bf16_f32 v54, v62, v63
    v_exp_f32 v66, v66
    v_exp_f32 v67, v67
    v_cvt_pk_bf16_f32 v55, v64, v65
    v_exp_f32 v68, v68
    v_exp_f32 v69, v69
    v_cvt_pk_bf16_f32 v56, v66, v67
    v_exp_f32 v70, v70
    v_cvt_pk_bf16_f32 v57, v68, v69
    v_mfma_f32_32x32x16_bf16 v[78:93], v[18:21], v[14:17], v[142:157]
    ds_read_b128 v[46:49], v2 offset:11520
    v_exp_f32 v71, v71
    v_exp_f32 v72, v72
    v_exp_f32 v73, v73
    v_mfma_f32_32x32x16_bf16 v[110:125], v[50:53], v[58:61], v[110:125]
    ds_read_b128 v[26:29], v4 offset:11520
    v_exp_f32 v74, v74
    v_exp_f32 v75, v75
    v_exp_f32 v76, v76
    v_mfma_f32_32x32x16_bf16 v[94:109], v[30:33], v[54:57], v[94:109]
    ds_read_b128 v[50:53], v3 offset:11520
    s_waitcnt lgkmcnt(3)
    v_exp_f32 v77, v77
    v_cvt_pk_bf16_f32 v58, v70, v71
    v_cvt_pk_bf16_f32 v59, v72, v73
    v_cvt_pk_bf16_f32 v60, v74, v75
    v_exp_f32 v78, v78
    v_exp_f32 v79, v79
    v_cvt_pk_bf16_f32 v61, v76, v77
    v_exp_f32 v80, v80
    v_exp_f32 v81, v81
    v_cvt_pk_bf16_f32 v54, v78, v79
    v_exp_f32 v82, v82
    v_exp_f32 v83, v83
    v_cvt_pk_bf16_f32 v55, v80, v81
    v_exp_f32 v84, v84
    v_exp_f32 v85, v85
    v_cvt_pk_bf16_f32 v56, v82, v83
    v_exp_f32 v86, v86
    v_cvt_pk_bf16_f32 v57, v84, v85
    v_mfma_f32_32x32x16_bf16 v[62:77], v[22:25], v[10:13], v[126:141]
    v_exp_f32 v87, v87
    v_exp_f32 v88, v88
    v_exp_f32 v89, v89
    v_mfma_f32_32x32x16_bf16 v[94:109], v[34:37], v[58:61], v[94:109]
    v_exp_f32 v90, v90
    v_exp_f32 v91, v91
    v_exp_f32 v92, v92
    v_mfma_f32_32x32x16_bf16 v[110:125], v[30:33], v[54:57], v[110:125]
    v_exp_f32 v93, v93
    v_cvt_pk_bf16_f32 v58, v86, v87
    v_cvt_pk_bf16_f32 v59, v88, v89
    v_cvt_pk_bf16_f32 v60, v90, v91
    v_exp_f32 v62, v62
    v_exp_f32 v63, v63
    v_cvt_pk_bf16_f32 v61, v92, v93
    v_exp_f32 v64, v64
    v_exp_f32 v65, v65
    v_cvt_pk_bf16_f32 v54, v62, v63
    v_exp_f32 v66, v66
    v_exp_f32 v67, v67
    v_cvt_pk_bf16_f32 v55, v64, v65
    v_exp_f32 v68, v68
    v_exp_f32 v69, v69
    v_cvt_pk_bf16_f32 v56, v66, v67
    v_exp_f32 v70, v70
    v_cvt_pk_bf16_f32 v57, v68, v69
    v_mfma_f32_32x32x16_bf16 v[78:93], v[22:25], v[14:17], v[142:157]
    ds_read_b128 v[30:33], v2 offset:13824
    v_exp_f32 v71, v71
    v_exp_f32 v72, v72
    v_exp_f32 v73, v73
    v_mfma_f32_32x32x16_bf16 v[110:125], v[34:37], v[58:61], v[110:125]
    ds_read_b128 v[18:21], v4 offset:13824
    v_exp_f32 v74, v74
    v_exp_f32 v75, v75
    v_exp_f32 v76, v76
    v_mfma_f32_32x32x16_bf16 v[94:109], v[38:41], v[54:57], v[94:109]
    ds_read_b128 v[34:37], v3 offset:13824
    s_waitcnt lgkmcnt(3)
    v_exp_f32 v77, v77
    v_cvt_pk_bf16_f32 v58, v70, v71
    v_cvt_pk_bf16_f32 v59, v72, v73
    v_cvt_pk_bf16_f32 v60, v74, v75
    v_exp_f32 v78, v78
    v_exp_f32 v79, v79
    v_cvt_pk_bf16_f32 v61, v76, v77
    v_exp_f32 v80, v80
    v_exp_f32 v81, v81
    v_cvt_pk_bf16_f32 v54, v78, v79
    v_exp_f32 v82, v82
    v_exp_f32 v83, v83
    v_cvt_pk_bf16_f32 v55, v80, v81
    v_exp_f32 v84, v84
    v_exp_f32 v85, v85
    v_cvt_pk_bf16_f32 v56, v82, v83
    v_exp_f32 v86, v86
    v_cvt_pk_bf16_f32 v57, v84, v85
    v_mfma_f32_32x32x16_bf16 v[62:77], v[26:29], v[10:13], v[126:141]
    v_exp_f32 v87, v87
    v_exp_f32 v88, v88
    v_exp_f32 v89, v89
    v_mfma_f32_32x32x16_bf16 v[94:109], v[42:45], v[58:61], v[94:109]
    v_exp_f32 v90, v90
    v_exp_f32 v91, v91
    v_exp_f32 v92, v92
    v_mfma_f32_32x32x16_bf16 v[110:125], v[38:41], v[54:57], v[110:125]
    v_exp_f32 v93, v93
    v_cvt_pk_bf16_f32 v58, v86, v87
    v_cvt_pk_bf16_f32 v59, v88, v89
    v_cvt_pk_bf16_f32 v60, v90, v91
    v_exp_f32 v62, v62
    v_exp_f32 v63, v63
    v_cvt_pk_bf16_f32 v61, v92, v93
    v_exp_f32 v64, v64
    v_exp_f32 v65, v65
    v_cvt_pk_bf16_f32 v54, v62, v63
    v_exp_f32 v66, v66
    v_exp_f32 v67, v67
    v_cvt_pk_bf16_f32 v55, v64, v65
    v_exp_f32 v68, v68
    v_exp_f32 v69, v69
    v_cvt_pk_bf16_f32 v56, v66, v67
    v_exp_f32 v70, v70
    v_cvt_pk_bf16_f32 v57, v68, v69
    v_mfma_f32_32x32x16_bf16 v[78:93], v[26:29], v[14:17], v[142:157]
    ds_read_b128 v[38:41], v2 offset:16128
    v_exp_f32 v71, v71
    v_exp_f32 v72, v72
    v_exp_f32 v73, v73
    v_mfma_f32_32x32x16_bf16 v[110:125], v[42:45], v[58:61], v[110:125]
    ds_read_b128 v[22:25], v4 offset:16128
    v_exp_f32 v74, v74
    v_exp_f32 v75, v75
    v_exp_f32 v76, v76
    v_mfma_f32_32x32x16_bf16 v[94:109], v[46:49], v[54:57], v[94:109]
    ds_read_b128 v[42:45], v3 offset:16128
    s_waitcnt lgkmcnt(3)
    v_exp_f32 v77, v77
    v_cvt_pk_bf16_f32 v58, v70, v71
    v_cvt_pk_bf16_f32 v59, v72, v73
    v_cvt_pk_bf16_f32 v60, v74, v75
    v_exp_f32 v78, v78
    v_exp_f32 v79, v79
    v_cvt_pk_bf16_f32 v61, v76, v77
    v_exp_f32 v80, v80
    v_exp_f32 v81, v81
    v_cvt_pk_bf16_f32 v54, v78, v79
    v_exp_f32 v82, v82
    v_exp_f32 v83, v83
    v_cvt_pk_bf16_f32 v55, v80, v81
    v_exp_f32 v84, v84
    v_exp_f32 v85, v85
    v_cvt_pk_bf16_f32 v56, v82, v83
    v_exp_f32 v86, v86
    v_cvt_pk_bf16_f32 v57, v84, v85
    v_mfma_f32_32x32x16_bf16 v[62:77], v[18:21], v[10:13], v[126:141]
    s_waitcnt vmcnt(0)
    s_barrier
    v_exp_f32 v87, v87
    v_exp_f32 v88, v88
    v_exp_f32 v89, v89
    v_mfma_f32_32x32x16_bf16 v[94:109], v[50:53], v[58:61], v[94:109]
    v_exp_f32 v90, v90
    v_exp_f32 v91, v91
    v_exp_f32 v92, v92
    v_mfma_f32_32x32x16_bf16 v[110:125], v[46:49], v[54:57], v[110:125]
    v_exp_f32 v93, v93
    v_cvt_pk_bf16_f32 v58, v86, v87
    v_cvt_pk_bf16_f32 v59, v88, v89
    v_cvt_pk_bf16_f32 v60, v90, v91
    v_exp_f32 v62, v62
    v_exp_f32 v63, v63
    v_cvt_pk_bf16_f32 v61, v92, v93
    v_exp_f32 v64, v64
    v_exp_f32 v65, v65
    v_cvt_pk_bf16_f32 v54, v62, v63
    v_exp_f32 v66, v66
    v_exp_f32 v67, v67
    v_cvt_pk_bf16_f32 v55, v64, v65
    v_exp_f32 v68, v68
    v_exp_f32 v69, v69
    v_cvt_pk_bf16_f32 v56, v66, v67
    v_exp_f32 v70, v70
    v_cvt_pk_bf16_f32 v57, v68, v69
    v_mfma_f32_32x32x16_bf16 v[78:93], v[18:21], v[14:17], v[142:157]
    ds_read_b128 v[46:49], v2 offset:18432
    v_exp_f32 v71, v71
    v_exp_f32 v72, v72
    v_exp_f32 v73, v73
    v_mfma_f32_32x32x16_bf16 v[110:125], v[50:53], v[58:61], v[110:125]
    ds_read_b128 v[26:29], v4 offset:18432
    v_exp_f32 v74, v74
    v_exp_f32 v75, v75
    v_exp_f32 v76, v76
    v_mfma_f32_32x32x16_bf16 v[94:109], v[30:33], v[54:57], v[94:109]
    ds_read_b128 v[50:53], v3 offset:18432
    s_waitcnt lgkmcnt(3)
    v_exp_f32 v77, v77
    v_cvt_pk_bf16_f32 v58, v70, v71
    v_cvt_pk_bf16_f32 v59, v72, v73
    v_cvt_pk_bf16_f32 v60, v74, v75
    v_exp_f32 v78, v78
    v_exp_f32 v79, v79
    v_cvt_pk_bf16_f32 v61, v76, v77
    v_exp_f32 v80, v80
    v_exp_f32 v81, v81
    v_cvt_pk_bf16_f32 v54, v78, v79
    v_exp_f32 v82, v82
    v_exp_f32 v83, v83
    v_cvt_pk_bf16_f32 v55, v80, v81
    v_exp_f32 v84, v84
    v_exp_f32 v85, v85
    v_cvt_pk_bf16_f32 v56, v82, v83
    v_exp_f32 v86, v86
    v_cvt_pk_bf16_f32 v57, v84, v85
    v_mfma_f32_32x32x16_bf16 v[62:77], v[22:25], v[10:13], v[126:141]
    s_add_u32 m0, s33, 36864
    s_add_u32 s31, s36, 81920
    buffer_load_dwordx4 v1, s[8:11], s31 offen offset:0 lds
    v_exp_f32 v87, v87
    v_exp_f32 v88, v88
    v_exp_f32 v89, v89
    v_mfma_f32_32x32x16_bf16 v[94:109], v[34:37], v[58:61], v[94:109]
    v_exp_f32 v90, v90
    v_exp_f32 v91, v91
    v_exp_f32 v92, v92
    v_mfma_f32_32x32x16_bf16 v[110:125], v[30:33], v[54:57], v[110:125]
    s_add_u32 m0, s33, 36864
    s_add_u32 s31, s36, 81920
    buffer_load_dwordx4 v1, s[8:11], s31 offen offset:1024 lds
    v_exp_f32 v93, v93
    v_cvt_pk_bf16_f32 v58, v86, v87
    v_cvt_pk_bf16_f32 v59, v88, v89
    v_cvt_pk_bf16_f32 v60, v90, v91
    v_exp_f32 v62, v62
    v_exp_f32 v63, v63
    v_cvt_pk_bf16_f32 v61, v92, v93
    v_exp_f32 v64, v64
    v_exp_f32 v65, v65
    v_cvt_pk_bf16_f32 v54, v62, v63
    v_exp_f32 v66, v66
    v_exp_f32 v67, v67
    v_cvt_pk_bf16_f32 v55, v64, v65
    v_exp_f32 v68, v68
    v_exp_f32 v69, v69
    v_cvt_pk_bf16_f32 v56, v66, v67
    v_exp_f32 v70, v70
    v_cvt_pk_bf16_f32 v57, v68, v69
    v_mfma_f32_32x32x16_bf16 v[78:93], v[22:25], v[14:17], v[142:157]
    ds_read_b128 v[30:33], v2 offset:20736
    v_exp_f32 v71, v71
    v_exp_f32 v72, v72
    v_exp_f32 v73, v73
    v_mfma_f32_32x32x16_bf16 v[110:125], v[34:37], v[58:61], v[110:125]
    ds_read_b128 v[18:21], v4 offset:20736
    v_exp_f32 v74, v74
    v_exp_f32 v75, v75
    v_exp_f32 v76, v76
    v_mfma_f32_32x32x16_bf16 v[94:109], v[38:41], v[54:57], v[94:109]
    ds_read_b128 v[34:37], v3 offset:20736
    s_waitcnt lgkmcnt(3)
    v_exp_f32 v77, v77
    v_cvt_pk_bf16_f32 v58, v70, v71
    v_cvt_pk_bf16_f32 v59, v72, v73
    v_cvt_pk_bf16_f32 v60, v74, v75
    v_exp_f32 v78, v78
    v_exp_f32 v79, v79
    v_cvt_pk_bf16_f32 v61, v76, v77
    v_exp_f32 v80, v80
    v_exp_f32 v81, v81
    v_cvt_pk_bf16_f32 v54, v78, v79
    v_exp_f32 v82, v82
    v_exp_f32 v83, v83
    v_cvt_pk_bf16_f32 v55, v80, v81
    v_exp_f32 v84, v84
    v_exp_f32 v85, v85
    v_cvt_pk_bf16_f32 v56, v82, v83
    v_exp_f32 v86, v86
    v_cvt_pk_bf16_f32 v57, v84, v85
    v_mfma_f32_32x32x16_bf16 v[62:77], v[26:29], v[10:13], v[126:141]
    s_add_u32 m0, s33, 46080
    s_add_u32 s31, s36, 90112
    buffer_load_dwordx4 v1, s[8:11], s31 offen offset:0 lds
    v_exp_f32 v87, v87
    v_exp_f32 v88, v88
    v_exp_f32 v89, v89
    v_mfma_f32_32x32x16_bf16 v[94:109], v[42:45], v[58:61], v[94:109]
    v_exp_f32 v90, v90
    v_exp_f32 v91, v91
    v_exp_f32 v92, v92
    v_mfma_f32_32x32x16_bf16 v[110:125], v[38:41], v[54:57], v[110:125]
    s_add_u32 m0, s33, 46080
    s_add_u32 s31, s36, 90112
    buffer_load_dwordx4 v1, s[8:11], s31 offen offset:1024 lds
    v_exp_f32 v93, v93
    v_cvt_pk_bf16_f32 v58, v86, v87
    v_cvt_pk_bf16_f32 v59, v88, v89
    v_cvt_pk_bf16_f32 v60, v90, v91
    v_exp_f32 v62, v62
    v_exp_f32 v63, v63
    v_cvt_pk_bf16_f32 v61, v92, v93
    v_exp_f32 v64, v64
    v_exp_f32 v65, v65
    v_cvt_pk_bf16_f32 v54, v62, v63
    v_exp_f32 v66, v66
    v_exp_f32 v67, v67
    v_cvt_pk_bf16_f32 v55, v64, v65
    v_exp_f32 v68, v68
    v_exp_f32 v69, v69
    v_cvt_pk_bf16_f32 v56, v66, v67
    v_exp_f32 v70, v70
    v_cvt_pk_bf16_f32 v57, v68, v69
    v_mfma_f32_32x32x16_bf16 v[78:93], v[26:29], v[14:17], v[142:157]
    ds_read_b128 v[38:41], v2 offset:23040
    v_exp_f32 v71, v71
    v_exp_f32 v72, v72
    v_exp_f32 v73, v73
    v_mfma_f32_32x32x16_bf16 v[110:125], v[42:45], v[58:61], v[110:125]
    ds_read_b128 v[22:25], v4 offset:23040
    v_exp_f32 v74, v74
    v_exp_f32 v75, v75
    v_exp_f32 v76, v76
    v_mfma_f32_32x32x16_bf16 v[94:109], v[46:49], v[54:57], v[94:109]
    ds_read_b128 v[42:45], v3 offset:23040
    s_waitcnt lgkmcnt(3)
    v_exp_f32 v77, v77
    v_cvt_pk_bf16_f32 v58, v70, v71
    v_cvt_pk_bf16_f32 v59, v72, v73
    v_cvt_pk_bf16_f32 v60, v74, v75
    v_exp_f32 v78, v78
    v_exp_f32 v79, v79
    v_cvt_pk_bf16_f32 v61, v76, v77
    v_exp_f32 v80, v80
    v_exp_f32 v81, v81
    v_cvt_pk_bf16_f32 v54, v78, v79
    v_exp_f32 v82, v82
    v_exp_f32 v83, v83
    v_cvt_pk_bf16_f32 v55, v80, v81
    v_exp_f32 v84, v84
    v_exp_f32 v85, v85
    v_cvt_pk_bf16_f32 v56, v82, v83
    v_exp_f32 v86, v86
    v_cvt_pk_bf16_f32 v57, v84, v85
    v_mfma_f32_32x32x16_bf16 v[62:77], v[18:21], v[10:13], v[126:141]
    v_exp_f32 v87, v87
    v_exp_f32 v88, v88
    v_exp_f32 v89, v89
    v_mfma_f32_32x32x16_bf16 v[94:109], v[50:53], v[58:61], v[94:109]
    v_exp_f32 v90, v90
    v_exp_f32 v91, v91
    v_exp_f32 v92, v92
    v_mfma_f32_32x32x16_bf16 v[110:125], v[46:49], v[54:57], v[110:125]
    v_exp_f32 v93, v93
    v_cvt_pk_bf16_f32 v58, v86, v87
    v_cvt_pk_bf16_f32 v59, v88, v89
    v_cvt_pk_bf16_f32 v60, v90, v91
    v_exp_f32 v62, v62
    v_exp_f32 v63, v63
    v_cvt_pk_bf16_f32 v61, v92, v93
    v_exp_f32 v64, v64
    v_exp_f32 v65, v65
    v_cvt_pk_bf16_f32 v54, v62, v63
    v_exp_f32 v66, v66
    v_exp_f32 v67, v67
    v_cvt_pk_bf16_f32 v55, v64, v65
    v_exp_f32 v68, v68
    v_exp_f32 v69, v69
    v_cvt_pk_bf16_f32 v56, v66, v67
    v_exp_f32 v70, v70
    v_cvt_pk_bf16_f32 v57, v68, v69
    v_mfma_f32_32x32x16_bf16 v[78:93], v[18:21], v[14:17], v[142:157]
    ds_read_b128 v[46:49], v2 offset:25344
    v_exp_f32 v71, v71
    v_exp_f32 v72, v72
    v_exp_f32 v73, v73
    v_mfma_f32_32x32x16_bf16 v[110:125], v[50:53], v[58:61], v[110:125]
    ds_read_b128 v[26:29], v4 offset:25344
    v_exp_f32 v74, v74
    v_exp_f32 v75, v75
    v_exp_f32 v76, v76
    v_mfma_f32_32x32x16_bf16 v[94:109], v[30:33], v[54:57], v[94:109]
    ds_read_b128 v[50:53], v3 offset:25344
    s_waitcnt lgkmcnt(3)
    v_exp_f32 v77, v77
    v_cvt_pk_bf16_f32 v58, v70, v71
    v_cvt_pk_bf16_f32 v59, v72, v73
    v_cvt_pk_bf16_f32 v60, v74, v75
    v_exp_f32 v78, v78
    v_exp_f32 v79, v79
    v_cvt_pk_bf16_f32 v61, v76, v77
    v_exp_f32 v80, v80
    v_exp_f32 v81, v81
    v_cvt_pk_bf16_f32 v54, v78, v79
    v_exp_f32 v82, v82
    v_exp_f32 v83, v83
    v_cvt_pk_bf16_f32 v55, v80, v81
    v_exp_f32 v84, v84
    v_exp_f32 v85, v85
    v_cvt_pk_bf16_f32 v56, v82, v83
    v_exp_f32 v86, v86
    v_cvt_pk_bf16_f32 v57, v84, v85
    v_mfma_f32_32x32x16_bf16 v[62:77], v[22:25], v[10:13], v[126:141]
    v_exp_f32 v87, v87
    v_exp_f32 v88, v88
    v_exp_f32 v89, v89
    v_mfma_f32_32x32x16_bf16 v[94:109], v[34:37], v[58:61], v[94:109]
    v_exp_f32 v90, v90
    v_exp_f32 v91, v91
    v_exp_f32 v92, v92
    v_mfma_f32_32x32x16_bf16 v[110:125], v[30:33], v[54:57], v[110:125]
    v_exp_f32 v93, v93
    v_cvt_pk_bf16_f32 v58, v86, v87
    v_cvt_pk_bf16_f32 v59, v88, v89
    v_cvt_pk_bf16_f32 v60, v90, v91
    v_exp_f32 v62, v62
    v_exp_f32 v63, v63
    v_cvt_pk_bf16_f32 v61, v92, v93
    v_exp_f32 v64, v64
    v_exp_f32 v65, v65
    v_cvt_pk_bf16_f32 v54, v62, v63
    v_exp_f32 v66, v66
    v_exp_f32 v67, v67
    v_cvt_pk_bf16_f32 v55, v64, v65
    v_exp_f32 v68, v68
    v_exp_f32 v69, v69
    v_cvt_pk_bf16_f32 v56, v66, v67
    v_exp_f32 v70, v70
    v_cvt_pk_bf16_f32 v57, v68, v69
    v_mfma_f32_32x32x16_bf16 v[78:93], v[22:25], v[14:17], v[142:157]
    ds_read_b128 v[30:33], v2 offset:27648
    v_exp_f32 v71, v71
    v_exp_f32 v72, v72
    v_exp_f32 v73, v73
    v_mfma_f32_32x32x16_bf16 v[110:125], v[34:37], v[58:61], v[110:125]
    ds_read_b128 v[18:21], v4 offset:27648
    v_exp_f32 v74, v74
    v_exp_f32 v75, v75
    v_exp_f32 v76, v76
    v_mfma_f32_32x32x16_bf16 v[94:109], v[38:41], v[54:57], v[94:109]
    ds_read_b128 v[34:37], v3 offset:27648
    s_waitcnt lgkmcnt(3)
    v_exp_f32 v77, v77
    v_cvt_pk_bf16_f32 v58, v70, v71
    v_cvt_pk_bf16_f32 v59, v72, v73
    v_cvt_pk_bf16_f32 v60, v74, v75
    v_exp_f32 v78, v78
    v_exp_f32 v79, v79
    v_cvt_pk_bf16_f32 v61, v76, v77
    v_exp_f32 v80, v80
    v_exp_f32 v81, v81
    v_cvt_pk_bf16_f32 v54, v78, v79
    v_exp_f32 v82, v82
    v_exp_f32 v83, v83
    v_cvt_pk_bf16_f32 v55, v80, v81
    v_exp_f32 v84, v84
    v_exp_f32 v85, v85
    v_cvt_pk_bf16_f32 v56, v82, v83
    v_exp_f32 v86, v86
    v_cvt_pk_bf16_f32 v57, v84, v85
    v_mfma_f32_32x32x16_bf16 v[62:77], v[26:29], v[10:13], v[126:141]
    v_exp_f32 v87, v87
    v_exp_f32 v88, v88
    v_exp_f32 v89, v89
    v_mfma_f32_32x32x16_bf16 v[94:109], v[42:45], v[58:61], v[94:109]
    v_exp_f32 v90, v90
    v_exp_f32 v91, v91
    v_exp_f32 v92, v92
    v_mfma_f32_32x32x16_bf16 v[110:125], v[38:41], v[54:57], v[110:125]
    v_exp_f32 v93, v93
    v_cvt_pk_bf16_f32 v58, v86, v87
    v_cvt_pk_bf16_f32 v59, v88, v89
    v_cvt_pk_bf16_f32 v60, v90, v91
    v_exp_f32 v62, v62
    v_exp_f32 v63, v63
    v_cvt_pk_bf16_f32 v61, v92, v93
    v_exp_f32 v64, v64
    v_exp_f32 v65, v65
    v_cvt_pk_bf16_f32 v54, v62, v63
    v_exp_f32 v66, v66
    v_exp_f32 v67, v67
    v_cvt_pk_bf16_f32 v55, v64, v65
    v_exp_f32 v68, v68
    v_exp_f32 v69, v69
    v_cvt_pk_bf16_f32 v56, v66, v67
    v_exp_f32 v70, v70
    v_cvt_pk_bf16_f32 v57, v68, v69
    v_mfma_f32_32x32x16_bf16 v[78:93], v[26:29], v[14:17], v[142:157]
    ds_read_b128 v[38:41], v2 offset:29952
    v_exp_f32 v71, v71
    v_exp_f32 v72, v72
    v_exp_f32 v73, v73
    v_mfma_f32_32x32x16_bf16 v[110:125], v[42:45], v[58:61], v[110:125]
    ds_read_b128 v[22:25], v4 offset:29952
    v_exp_f32 v74, v74
    v_exp_f32 v75, v75
    v_exp_f32 v76, v76
    v_mfma_f32_32x32x16_bf16 v[94:109], v[46:49], v[54:57], v[94:109]
    ds_read_b128 v[42:45], v3 offset:29952
    s_waitcnt lgkmcnt(3)
    v_exp_f32 v77, v77
    v_cvt_pk_bf16_f32 v58, v70, v71
    v_cvt_pk_bf16_f32 v59, v72, v73
    v_cvt_pk_bf16_f32 v60, v74, v75
    v_exp_f32 v78, v78
    v_exp_f32 v79, v79
    v_cvt_pk_bf16_f32 v61, v76, v77
    v_exp_f32 v80, v80
    v_exp_f32 v81, v81
    v_cvt_pk_bf16_f32 v54, v78, v79
    v_exp_f32 v82, v82
    v_exp_f32 v83, v83
    v_cvt_pk_bf16_f32 v55, v80, v81
    v_exp_f32 v84, v84
    v_exp_f32 v85, v85
    v_cvt_pk_bf16_f32 v56, v82, v83
    v_exp_f32 v86, v86
    v_cvt_pk_bf16_f32 v57, v84, v85
    v_mfma_f32_32x32x16_bf16 v[62:77], v[18:21], v[10:13], v[126:141]
    v_exp_f32 v87, v87
    v_exp_f32 v88, v88
    v_exp_f32 v89, v89
    v_mfma_f32_32x32x16_bf16 v[94:109], v[50:53], v[58:61], v[94:109]
    v_exp_f32 v90, v90
    v_exp_f32 v91, v91
    v_exp_f32 v92, v92
    v_mfma_f32_32x32x16_bf16 v[110:125], v[46:49], v[54:57], v[110:125]
    v_exp_f32 v93, v93
    v_cvt_pk_bf16_f32 v58, v86, v87
    v_cvt_pk_bf16_f32 v59, v88, v89
    v_cvt_pk_bf16_f32 v60, v90, v91
    v_exp_f32 v62, v62
    v_exp_f32 v63, v63
    v_cvt_pk_bf16_f32 v61, v92, v93
    v_exp_f32 v64, v64
    v_exp_f32 v65, v65
    v_cvt_pk_bf16_f32 v54, v62, v63
    v_exp_f32 v66, v66
    v_exp_f32 v67, v67
    v_cvt_pk_bf16_f32 v55, v64, v65
    v_exp_f32 v68, v68
    v_exp_f32 v69, v69
    v_cvt_pk_bf16_f32 v56, v66, v67
    v_exp_f32 v70, v70
    v_cvt_pk_bf16_f32 v57, v68, v69
    v_mfma_f32_32x32x16_bf16 v[78:93], v[18:21], v[14:17], v[142:157]
    ds_read_b128 v[46:49], v2 offset:32256
    v_exp_f32 v71, v71
    v_exp_f32 v72, v72
    v_exp_f32 v73, v73
    v_mfma_f32_32x32x16_bf16 v[110:125], v[50:53], v[58:61], v[110:125]
    ds_read_b128 v[26:29], v4 offset:32256
    v_exp_f32 v74, v74
    v_exp_f32 v75, v75
    v_exp_f32 v76, v76
    v_mfma_f32_32x32x16_bf16 v[94:109], v[30:33], v[54:57], v[94:109]
    ds_read_b128 v[50:53], v3 offset:32256
    s_waitcnt lgkmcnt(3)
    v_exp_f32 v77, v77
    v_cvt_pk_bf16_f32 v58, v70, v71
    v_cvt_pk_bf16_f32 v59, v72, v73
    v_cvt_pk_bf16_f32 v60, v74, v75
    v_exp_f32 v78, v78
    v_exp_f32 v79, v79
    v_cvt_pk_bf16_f32 v61, v76, v77
    v_exp_f32 v80, v80
    v_exp_f32 v81, v81
    v_cvt_pk_bf16_f32 v54, v78, v79
    v_exp_f32 v82, v82
    v_exp_f32 v83, v83
    v_cvt_pk_bf16_f32 v55, v80, v81
    v_exp_f32 v84, v84
    v_exp_f32 v85, v85
    v_cvt_pk_bf16_f32 v56, v82, v83
    v_exp_f32 v86, v86
    v_cvt_pk_bf16_f32 v57, v84, v85
    v_mfma_f32_32x32x16_bf16 v[62:77], v[22:25], v[10:13], v[126:141]
    v_exp_f32 v87, v87
    v_exp_f32 v88, v88
    v_exp_f32 v89, v89
    v_mfma_f32_32x32x16_bf16 v[94:109], v[34:37], v[58:61], v[94:109]
    v_exp_f32 v90, v90
    v_exp_f32 v91, v91
    v_exp_f32 v92, v92
    v_mfma_f32_32x32x16_bf16 v[110:125], v[30:33], v[54:57], v[110:125]
    v_exp_f32 v93, v93
    v_cvt_pk_bf16_f32 v58, v86, v87
    v_cvt_pk_bf16_f32 v59, v88, v89
    v_cvt_pk_bf16_f32 v60, v90, v91
    v_exp_f32 v62, v62
    v_exp_f32 v63, v63
    v_cvt_pk_bf16_f32 v61, v92, v93
    v_exp_f32 v64, v64
    v_exp_f32 v65, v65
    v_cvt_pk_bf16_f32 v54, v62, v63
    v_exp_f32 v66, v66
    v_exp_f32 v67, v67
    v_cvt_pk_bf16_f32 v55, v64, v65
    v_exp_f32 v68, v68
    v_exp_f32 v69, v69
    v_cvt_pk_bf16_f32 v56, v66, v67
    v_exp_f32 v70, v70
    v_cvt_pk_bf16_f32 v57, v68, v69
    v_mfma_f32_32x32x16_bf16 v[78:93], v[22:25], v[14:17], v[142:157]
    ds_read_b128 v[30:33], v2 offset:34560
    v_exp_f32 v71, v71
    v_exp_f32 v72, v72
    v_exp_f32 v73, v73
    v_mfma_f32_32x32x16_bf16 v[110:125], v[34:37], v[58:61], v[110:125]
    ds_read_b128 v[18:21], v4 offset:34560
    v_exp_f32 v74, v74
    v_exp_f32 v75, v75
    v_exp_f32 v76, v76
    v_mfma_f32_32x32x16_bf16 v[94:109], v[38:41], v[54:57], v[94:109]
    ds_read_b128 v[34:37], v3 offset:34560
    s_waitcnt lgkmcnt(3)
    v_exp_f32 v77, v77
    v_cvt_pk_bf16_f32 v58, v70, v71
    v_cvt_pk_bf16_f32 v59, v72, v73
    v_cvt_pk_bf16_f32 v60, v74, v75
    v_exp_f32 v78, v78
    v_exp_f32 v79, v79
    v_cvt_pk_bf16_f32 v61, v76, v77
    v_exp_f32 v80, v80
    v_exp_f32 v81, v81
    v_cvt_pk_bf16_f32 v54, v78, v79
    v_exp_f32 v82, v82
    v_exp_f32 v83, v83
    v_cvt_pk_bf16_f32 v55, v80, v81
    v_exp_f32 v84, v84
    v_exp_f32 v85, v85
    v_cvt_pk_bf16_f32 v56, v82, v83
    v_exp_f32 v86, v86
    v_cvt_pk_bf16_f32 v57, v84, v85
    v_mfma_f32_32x32x16_bf16 v[62:77], v[26:29], v[10:13], v[126:141]
    s_waitcnt vmcnt(0)
    s_barrier
    v_exp_f32 v87, v87
    v_exp_f32 v88, v88
    v_exp_f32 v89, v89
    v_mfma_f32_32x32x16_bf16 v[94:109], v[42:45], v[58:61], v[94:109]
    v_exp_f32 v90, v90
    v_exp_f32 v91, v91
    v_exp_f32 v92, v92
    v_mfma_f32_32x32x16_bf16 v[110:125], v[38:41], v[54:57], v[110:125]
    v_exp_f32 v93, v93
    v_cvt_pk_bf16_f32 v58, v86, v87
    v_cvt_pk_bf16_f32 v59, v88, v89
    v_cvt_pk_bf16_f32 v60, v90, v91
    v_exp_f32 v62, v62
    v_exp_f32 v63, v63
    v_cvt_pk_bf16_f32 v61, v92, v93
    v_exp_f32 v64, v64
    v_exp_f32 v65, v65
    v_cvt_pk_bf16_f32 v54, v62, v63
    v_exp_f32 v66, v66
    v_exp_f32 v67, v67
    v_cvt_pk_bf16_f32 v55, v64, v65
    v_exp_f32 v68, v68
    v_exp_f32 v69, v69
    v_cvt_pk_bf16_f32 v56, v66, v67
    v_exp_f32 v70, v70
    v_cvt_pk_bf16_f32 v57, v68, v69
    v_mfma_f32_32x32x16_bf16 v[78:93], v[26:29], v[14:17], v[142:157]
    ds_read_b128 v[38:41], v2 offset:36864
    v_exp_f32 v71, v71
    v_exp_f32 v72, v72
    v_exp_f32 v73, v73
    v_mfma_f32_32x32x16_bf16 v[110:125], v[42:45], v[58:61], v[110:125]
    ds_read_b128 v[22:25], v4 offset:36864
    v_exp_f32 v74, v74
    v_exp_f32 v75, v75
    v_exp_f32 v76, v76
    v_mfma_f32_32x32x16_bf16 v[94:109], v[46:49], v[54:57], v[94:109]
    ds_read_b128 v[42:45], v3 offset:36864
    s_waitcnt lgkmcnt(3)
    v_exp_f32 v77, v77
    v_cvt_pk_bf16_f32 v58, v70, v71
    v_cvt_pk_bf16_f32 v59, v72, v73
    v_cvt_pk_bf16_f32 v60, v74, v75
    v_exp_f32 v78, v78
    v_exp_f32 v79, v79
    v_cvt_pk_bf16_f32 v61, v76, v77
    v_exp_f32 v80, v80
    v_exp_f32 v81, v81
    v_cvt_pk_bf16_f32 v54, v78, v79
    v_exp_f32 v82, v82
    v_exp_f32 v83, v83
    v_cvt_pk_bf16_f32 v55, v80, v81
    v_exp_f32 v84, v84
    v_exp_f32 v85, v85
    v_cvt_pk_bf16_f32 v56, v82, v83
    v_exp_f32 v86, v86
    v_cvt_pk_bf16_f32 v57, v84, v85
    v_mfma_f32_32x32x16_bf16 v[62:77], v[18:21], v[10:13], v[126:141]
    s_add_u32 m0, s33, 0
    s_add_u32 s31, s36, 98304
    buffer_load_dwordx4 v1, s[8:11], s31 offen offset:0 lds
    v_exp_f32 v87, v87
    v_exp_f32 v88, v88
    v_exp_f32 v89, v89
    v_mfma_f32_32x32x16_bf16 v[94:109], v[50:53], v[58:61], v[94:109]
    v_exp_f32 v90, v90
    v_exp_f32 v91, v91
    v_exp_f32 v92, v92
    v_mfma_f32_32x32x16_bf16 v[110:125], v[46:49], v[54:57], v[110:125]
    s_add_u32 m0, s33, 0
    s_add_u32 s31, s36, 98304
    buffer_load_dwordx4 v1, s[8:11], s31 offen offset:1024 lds
    v_exp_f32 v93, v93
    v_cvt_pk_bf16_f32 v58, v86, v87
    v_cvt_pk_bf16_f32 v59, v88, v89
    v_cvt_pk_bf16_f32 v60, v90, v91
    v_exp_f32 v62, v62
    v_exp_f32 v63, v63
    v_cvt_pk_bf16_f32 v61, v92, v93
    v_exp_f32 v64, v64
    v_exp_f32 v65, v65
    v_cvt_pk_bf16_f32 v54, v62, v63
    v_exp_f32 v66, v66
    v_exp_f32 v67, v67
    v_cvt_pk_bf16_f32 v55, v64, v65
    v_exp_f32 v68, v68
    v_exp_f32 v69, v69
    v_cvt_pk_bf16_f32 v56, v66, v67
    v_exp_f32 v70, v70
    v_cvt_pk_bf16_f32 v57, v68, v69
    v_mfma_f32_32x32x16_bf16 v[78:93], v[18:21], v[14:17], v[142:157]
    ds_read_b128 v[46:49], v2 offset:39168
    v_exp_f32 v71, v71
    v_exp_f32 v72, v72
    v_exp_f32 v73, v73
    v_mfma_f32_32x32x16_bf16 v[110:125], v[50:53], v[58:61], v[110:125]
    ds_read_b128 v[26:29], v4 offset:39168
    v_exp_f32 v74, v74
    v_exp_f32 v75, v75
    v_exp_f32 v76, v76
    v_mfma_f32_32x32x16_bf16 v[94:109], v[30:33], v[54:57], v[94:109]
    ds_read_b128 v[50:53], v3 offset:39168
    s_waitcnt lgkmcnt(3)
    v_exp_f32 v77, v77
    v_cvt_pk_bf16_f32 v58, v70, v71
    v_cvt_pk_bf16_f32 v59, v72, v73
    v_cvt_pk_bf16_f32 v60, v74, v75
    v_exp_f32 v78, v78
    v_exp_f32 v79, v79
    v_cvt_pk_bf16_f32 v61, v76, v77
    v_exp_f32 v80, v80
    v_exp_f32 v81, v81
    v_cvt_pk_bf16_f32 v54, v78, v79
    v_exp_f32 v82, v82
    v_exp_f32 v83, v83
    v_cvt_pk_bf16_f32 v55, v80, v81
    v_exp_f32 v84, v84
    v_exp_f32 v85, v85
    v_cvt_pk_bf16_f32 v56, v82, v83
    v_exp_f32 v86, v86
    v_cvt_pk_bf16_f32 v57, v84, v85
    v_mfma_f32_32x32x16_bf16 v[62:77], v[22:25], v[10:13], v[126:141]
    s_add_u32 m0, s33, 9216
    s_add_u32 s31, s36, 106496
    buffer_load_dwordx4 v1, s[8:11], s31 offen offset:0 lds
    v_exp_f32 v87, v87
    v_exp_f32 v88, v88
    v_exp_f32 v89, v89
    v_mfma_f32_32x32x16_bf16 v[94:109], v[34:37], v[58:61], v[94:109]
    v_exp_f32 v90, v90
    v_exp_f32 v91, v91
    v_exp_f32 v92, v92
    v_mfma_f32_32x32x16_bf16 v[110:125], v[30:33], v[54:57], v[110:125]
    s_add_u32 m0, s33, 9216
    s_add_u32 s31, s36, 106496
    buffer_load_dwordx4 v1, s[8:11], s31 offen offset:1024 lds
    v_exp_f32 v93, v93
    v_cvt_pk_bf16_f32 v58, v86, v87
    v_cvt_pk_bf16_f32 v59, v88, v89
    v_cvt_pk_bf16_f32 v60, v90, v91
    v_exp_f32 v62, v62
    v_exp_f32 v63, v63
    v_cvt_pk_bf16_f32 v61, v92, v93
    v_exp_f32 v64, v64
    v_exp_f32 v65, v65
    v_cvt_pk_bf16_f32 v54, v62, v63
    v_exp_f32 v66, v66
    v_exp_f32 v67, v67
    v_cvt_pk_bf16_f32 v55, v64, v65
    v_exp_f32 v68, v68
    v_exp_f32 v69, v69
    v_cvt_pk_bf16_f32 v56, v66, v67
    v_exp_f32 v70, v70
    v_cvt_pk_bf16_f32 v57, v68, v69
    v_mfma_f32_32x32x16_bf16 v[78:93], v[22:25], v[14:17], v[142:157]
    ds_read_b128 v[30:33], v2 offset:41472
    v_exp_f32 v71, v71
    v_exp_f32 v72, v72
    v_exp_f32 v73, v73
    v_mfma_f32_32x32x16_bf16 v[110:125], v[34:37], v[58:61], v[110:125]
    ds_read_b128 v[18:21], v4 offset:41472
    v_exp_f32 v74, v74
    v_exp_f32 v75, v75
    v_exp_f32 v76, v76
    v_mfma_f32_32x32x16_bf16 v[94:109], v[38:41], v[54:57], v[94:109]
    ds_read_b128 v[34:37], v3 offset:41472
    s_waitcnt lgkmcnt(3)
    v_exp_f32 v77, v77
    v_cvt_pk_bf16_f32 v58, v70, v71
    v_cvt_pk_bf16_f32 v59, v72, v73
    v_cvt_pk_bf16_f32 v60, v74, v75
    v_exp_f32 v78, v78
    v_exp_f32 v79, v79
    v_cvt_pk_bf16_f32 v61, v76, v77
    v_exp_f32 v80, v80
    v_exp_f32 v81, v81
    v_cvt_pk_bf16_f32 v54, v78, v79
    v_exp_f32 v82, v82
    v_exp_f32 v83, v83
    v_cvt_pk_bf16_f32 v55, v80, v81
    v_exp_f32 v84, v84
    v_exp_f32 v85, v85
    v_cvt_pk_bf16_f32 v56, v82, v83
    v_exp_f32 v86, v86
    v_cvt_pk_bf16_f32 v57, v84, v85
    v_mfma_f32_32x32x16_bf16 v[62:77], v[26:29], v[10:13], v[126:141]
    v_exp_f32 v87, v87
    v_exp_f32 v88, v88
    v_exp_f32 v89, v89
    v_mfma_f32_32x32x16_bf16 v[94:109], v[42:45], v[58:61], v[94:109]
    v_exp_f32 v90, v90
    v_exp_f32 v91, v91
    v_exp_f32 v92, v92
    v_mfma_f32_32x32x16_bf16 v[110:125], v[38:41], v[54:57], v[110:125]
    v_exp_f32 v93, v93
    v_cvt_pk_bf16_f32 v58, v86, v87
    v_cvt_pk_bf16_f32 v59, v88, v89
    v_cvt_pk_bf16_f32 v60, v90, v91
    v_exp_f32 v62, v62
    v_exp_f32 v63, v63
    v_cvt_pk_bf16_f32 v61, v92, v93
    v_exp_f32 v64, v64
    v_exp_f32 v65, v65
    v_cvt_pk_bf16_f32 v54, v62, v63
    v_exp_f32 v66, v66
    v_exp_f32 v67, v67
    v_cvt_pk_bf16_f32 v55, v64, v65
    v_exp_f32 v68, v68
    v_exp_f32 v69, v69
    v_cvt_pk_bf16_f32 v56, v66, v67
    v_exp_f32 v70, v70
    v_cvt_pk_bf16_f32 v57, v68, v69
    v_mfma_f32_32x32x16_bf16 v[78:93], v[26:29], v[14:17], v[142:157]
    ds_read_b128 v[38:41], v2 offset:43776
    v_exp_f32 v71, v71
    v_exp_f32 v72, v72
    v_exp_f32 v73, v73
    v_mfma_f32_32x32x16_bf16 v[110:125], v[42:45], v[58:61], v[110:125]
    ds_read_b128 v[22:25], v4 offset:43776
    v_exp_f32 v74, v74
    v_exp_f32 v75, v75
    v_exp_f32 v76, v76
    v_mfma_f32_32x32x16_bf16 v[94:109], v[46:49], v[54:57], v[94:109]
    ds_read_b128 v[42:45], v3 offset:43776
    s_waitcnt lgkmcnt(3)
    v_exp_f32 v77, v77
    v_cvt_pk_bf16_f32 v58, v70, v71
    v_cvt_pk_bf16_f32 v59, v72, v73
    v_cvt_pk_bf16_f32 v60, v74, v75
    v_exp_f32 v78, v78
    v_exp_f32 v79, v79
    v_cvt_pk_bf16_f32 v61, v76, v77
    v_exp_f32 v80, v80
    v_exp_f32 v81, v81
    v_cvt_pk_bf16_f32 v54, v78, v79
    v_exp_f32 v82, v82
    v_exp_f32 v83, v83
    v_cvt_pk_bf16_f32 v55, v80, v81
    v_exp_f32 v84, v84
    v_exp_f32 v85, v85
    v_cvt_pk_bf16_f32 v56, v82, v83
    v_exp_f32 v86, v86
    v_cvt_pk_bf16_f32 v57, v84, v85
    v_mfma_f32_32x32x16_bf16 v[62:77], v[18:21], v[10:13], v[126:141]
    v_exp_f32 v87, v87
    v_exp_f32 v88, v88
    v_exp_f32 v89, v89
    v_mfma_f32_32x32x16_bf16 v[94:109], v[50:53], v[58:61], v[94:109]
    v_exp_f32 v90, v90
    v_exp_f32 v91, v91
    v_exp_f32 v92, v92
    v_mfma_f32_32x32x16_bf16 v[110:125], v[46:49], v[54:57], v[110:125]
    v_exp_f32 v93, v93
    v_cvt_pk_bf16_f32 v58, v86, v87
    v_cvt_pk_bf16_f32 v59, v88, v89
    v_cvt_pk_bf16_f32 v60, v90, v91
    v_exp_f32 v62, v62
    v_exp_f32 v63, v63
    v_cvt_pk_bf16_f32 v61, v92, v93
    v_exp_f32 v64, v64
    v_exp_f32 v65, v65
    v_cvt_pk_bf16_f32 v54, v62, v63
    v_exp_f32 v66, v66
    v_exp_f32 v67, v67
    v_cvt_pk_bf16_f32 v55, v64, v65
    v_exp_f32 v68, v68
    v_exp_f32 v69, v69
    v_cvt_pk_bf16_f32 v56, v66, v67
    v_exp_f32 v70, v70
    v_cvt_pk_bf16_f32 v57, v68, v69
    v_mfma_f32_32x32x16_bf16 v[78:93], v[18:21], v[14:17], v[142:157]
    ds_read_b128 v[46:49], v2 offset:46080
    v_exp_f32 v71, v71
    v_exp_f32 v72, v72
    v_exp_f32 v73, v73
    v_mfma_f32_32x32x16_bf16 v[110:125], v[50:53], v[58:61], v[110:125]
    ds_read_b128 v[26:29], v4 offset:46080
    v_exp_f32 v74, v74
    v_exp_f32 v75, v75
    v_exp_f32 v76, v76
    v_mfma_f32_32x32x16_bf16 v[94:109], v[30:33], v[54:57], v[94:109]
    ds_read_b128 v[50:53], v3 offset:46080
    s_waitcnt lgkmcnt(3)
    v_exp_f32 v77, v77
    v_cvt_pk_bf16_f32 v58, v70, v71
    v_cvt_pk_bf16_f32 v59, v72, v73
    v_cvt_pk_bf16_f32 v60, v74, v75
    v_exp_f32 v78, v78
    v_exp_f32 v79, v79
    v_cvt_pk_bf16_f32 v61, v76, v77
    v_exp_f32 v80, v80
    v_exp_f32 v81, v81
    v_cvt_pk_bf16_f32 v54, v78, v79
    v_exp_f32 v82, v82
    v_exp_f32 v83, v83
    v_cvt_pk_bf16_f32 v55, v80, v81
    v_exp_f32 v84, v84
    v_exp_f32 v85, v85
    v_cvt_pk_bf16_f32 v56, v82, v83
    v_exp_f32 v86, v86
    v_cvt_pk_bf16_f32 v57, v84, v85
    v_mfma_f32_32x32x16_bf16 v[62:77], v[22:25], v[10:13], v[126:141]
    v_exp_f32 v87, v87
    v_exp_f32 v88, v88
    v_exp_f32 v89, v89
    v_mfma_f32_32x32x16_bf16 v[94:109], v[34:37], v[58:61], v[94:109]
    v_exp_f32 v90, v90
    v_exp_f32 v91, v91
    v_exp_f32 v92, v92
    v_mfma_f32_32x32x16_bf16 v[110:125], v[30:33], v[54:57], v[110:125]
    v_exp_f32 v93, v93
    v_cvt_pk_bf16_f32 v58, v86, v87
    v_cvt_pk_bf16_f32 v59, v88, v89
    v_cvt_pk_bf16_f32 v60, v90, v91
    v_exp_f32 v62, v62
    v_exp_f32 v63, v63
    v_cvt_pk_bf16_f32 v61, v92, v93
    v_exp_f32 v64, v64
    v_exp_f32 v65, v65
    v_cvt_pk_bf16_f32 v54, v62, v63
    v_exp_f32 v66, v66
    v_exp_f32 v67, v67
    v_cvt_pk_bf16_f32 v55, v64, v65
    v_exp_f32 v68, v68
    v_exp_f32 v69, v69
    v_cvt_pk_bf16_f32 v56, v66, v67
    v_exp_f32 v70, v70
    v_cvt_pk_bf16_f32 v57, v68, v69
    v_mfma_f32_32x32x16_bf16 v[78:93], v[22:25], v[14:17], v[142:157]
    ds_read_b128 v[30:33], v2 offset:48384
    v_exp_f32 v71, v71
    v_exp_f32 v72, v72
    v_exp_f32 v73, v73
    v_mfma_f32_32x32x16_bf16 v[110:125], v[34:37], v[58:61], v[110:125]
    ds_read_b128 v[18:21], v4 offset:48384
    v_exp_f32 v74, v74
    v_exp_f32 v75, v75
    v_exp_f32 v76, v76
    v_mfma_f32_32x32x16_bf16 v[94:109], v[38:41], v[54:57], v[94:109]
    ds_read_b128 v[34:37], v3 offset:48384
    s_waitcnt lgkmcnt(3)
    v_exp_f32 v77, v77
    v_cvt_pk_bf16_f32 v58, v70, v71
    v_cvt_pk_bf16_f32 v59, v72, v73
    v_cvt_pk_bf16_f32 v60, v74, v75
    v_exp_f32 v78, v78
    v_exp_f32 v79, v79
    v_cvt_pk_bf16_f32 v61, v76, v77
    v_exp_f32 v80, v80
    v_exp_f32 v81, v81
    v_cvt_pk_bf16_f32 v54, v78, v79
    v_exp_f32 v82, v82
    v_exp_f32 v83, v83
    v_cvt_pk_bf16_f32 v55, v80, v81
    v_exp_f32 v84, v84
    v_exp_f32 v85, v85
    v_cvt_pk_bf16_f32 v56, v82, v83
    v_exp_f32 v86, v86
    v_cvt_pk_bf16_f32 v57, v84, v85
    v_mfma_f32_32x32x16_bf16 v[62:77], v[26:29], v[10:13], v[126:141]
    v_exp_f32 v87, v87
    v_exp_f32 v88, v88
    v_exp_f32 v89, v89
    v_mfma_f32_32x32x16_bf16 v[94:109], v[42:45], v[58:61], v[94:109]
    v_exp_f32 v90, v90
    v_exp_f32 v91, v91
    v_exp_f32 v92, v92
    v_mfma_f32_32x32x16_bf16 v[110:125], v[38:41], v[54:57], v[110:125]
    v_exp_f32 v93, v93
    v_cvt_pk_bf16_f32 v58, v86, v87
    v_cvt_pk_bf16_f32 v59, v88, v89
    v_cvt_pk_bf16_f32 v60, v90, v91
    v_exp_f32 v62, v62
    v_exp_f32 v63, v63
    v_cvt_pk_bf16_f32 v61, v92, v93
    v_exp_f32 v64, v64
    v_exp_f32 v65, v65
    v_cvt_pk_bf16_f32 v54, v62, v63
    v_exp_f32 v66, v66
    v_exp_f32 v67, v67
    v_cvt_pk_bf16_f32 v55, v64, v65
    v_exp_f32 v68, v68
    v_exp_f32 v69, v69
    v_cvt_pk_bf16_f32 v56, v66, v67
    v_exp_f32 v70, v70
    v_cvt_pk_bf16_f32 v57, v68, v69
    v_mfma_f32_32x32x16_bf16 v[78:93], v[26:29], v[14:17], v[142:157]
    ds_read_b128 v[38:41], v2 offset:50688
    v_exp_f32 v71, v71
    v_exp_f32 v72, v72
    v_exp_f32 v73, v73
    v_mfma_f32_32x32x16_bf16 v[110:125], v[42:45], v[58:61], v[110:125]
    ds_read_b128 v[22:25], v4 offset:50688
    v_exp_f32 v74, v74
    v_exp_f32 v75, v75
    v_exp_f32 v76, v76
    v_mfma_f32_32x32x16_bf16 v[94:109], v[46:49], v[54:57], v[94:109]
    ds_read_b128 v[42:45], v3 offset:50688
    s_waitcnt lgkmcnt(3)
    v_exp_f32 v77, v77
    v_cvt_pk_bf16_f32 v58, v70, v71
    v_cvt_pk_bf16_f32 v59, v72, v73
    v_cvt_pk_bf16_f32 v60, v74, v75
    v_exp_f32 v78, v78
    v_exp_f32 v79, v79
    v_cvt_pk_bf16_f32 v61, v76, v77
    v_exp_f32 v80, v80
    v_exp_f32 v81, v81
    v_cvt_pk_bf16_f32 v54, v78, v79
    v_exp_f32 v82, v82
    v_exp_f32 v83, v83
    v_cvt_pk_bf16_f32 v55, v80, v81
    v_exp_f32 v84, v84
    v_exp_f32 v85, v85
    v_cvt_pk_bf16_f32 v56, v82, v83
    v_exp_f32 v86, v86
    v_cvt_pk_bf16_f32 v57, v84, v85
    v_mfma_f32_32x32x16_bf16 v[62:77], v[18:21], v[10:13], v[126:141]
    v_exp_f32 v87, v87
    v_exp_f32 v88, v88
    v_exp_f32 v89, v89
    v_mfma_f32_32x32x16_bf16 v[94:109], v[50:53], v[58:61], v[94:109]
    v_exp_f32 v90, v90
    v_exp_f32 v91, v91
    v_exp_f32 v92, v92
    v_mfma_f32_32x32x16_bf16 v[110:125], v[46:49], v[54:57], v[110:125]
    v_exp_f32 v93, v93
    v_cvt_pk_bf16_f32 v58, v86, v87
    v_cvt_pk_bf16_f32 v59, v88, v89
    v_cvt_pk_bf16_f32 v60, v90, v91
    v_exp_f32 v62, v62
    v_exp_f32 v63, v63
    v_cvt_pk_bf16_f32 v61, v92, v93
    v_exp_f32 v64, v64
    v_exp_f32 v65, v65
    v_cvt_pk_bf16_f32 v54, v62, v63
    v_exp_f32 v66, v66
    v_exp_f32 v67, v67
    v_cvt_pk_bf16_f32 v55, v64, v65
    v_exp_f32 v68, v68
    v_exp_f32 v69, v69
    v_cvt_pk_bf16_f32 v56, v66, v67
    v_exp_f32 v70, v70
    v_cvt_pk_bf16_f32 v57, v68, v69
    v_mfma_f32_32x32x16_bf16 v[78:93], v[18:21], v[14:17], v[142:157]
    ds_read_b128 v[46:49], v2 offset:52992
    v_exp_f32 v71, v71
    v_exp_f32 v72, v72
    v_exp_f32 v73, v73
    v_mfma_f32_32x32x16_bf16 v[110:125], v[50:53], v[58:61], v[110:125]
    ds_read_b128 v[26:29], v4 offset:52992
    v_exp_f32 v74, v74
    v_exp_f32 v75, v75
    v_exp_f32 v76, v76
    v_mfma_f32_32x32x16_bf16 v[94:109], v[30:33], v[54:57], v[94:109]
    ds_read_b128 v[50:53], v3 offset:52992
    s_waitcnt lgkmcnt(3)
    v_exp_f32 v77, v77
    v_cvt_pk_bf16_f32 v58, v70, v71
    v_cvt_pk_bf16_f32 v59, v72, v73
    v_cvt_pk_bf16_f32 v60, v74, v75
    v_exp_f32 v78, v78
    v_exp_f32 v79, v79
    v_cvt_pk_bf16_f32 v61, v76, v77
    v_exp_f32 v80, v80
    v_exp_f32 v81, v81
    v_cvt_pk_bf16_f32 v54, v78, v79
    v_exp_f32 v82, v82
    v_exp_f32 v83, v83
    v_cvt_pk_bf16_f32 v55, v80, v81
    v_exp_f32 v84, v84
    v_exp_f32 v85, v85
    v_cvt_pk_bf16_f32 v56, v82, v83
    v_exp_f32 v86, v86
    v_cvt_pk_bf16_f32 v57, v84, v85
    v_mfma_f32_32x32x16_bf16 v[62:77], v[22:25], v[10:13], v[126:141]
    s_waitcnt vmcnt(0)
    s_barrier
    v_exp_f32 v87, v87
    v_exp_f32 v88, v88
    v_exp_f32 v89, v89
    v_mfma_f32_32x32x16_bf16 v[94:109], v[34:37], v[58:61], v[94:109]
    v_exp_f32 v90, v90
    v_exp_f32 v91, v91
    v_exp_f32 v92, v92
    v_mfma_f32_32x32x16_bf16 v[110:125], v[30:33], v[54:57], v[110:125]
    v_exp_f32 v93, v93
    v_cvt_pk_bf16_f32 v58, v86, v87
    v_cvt_pk_bf16_f32 v59, v88, v89
    v_cvt_pk_bf16_f32 v60, v90, v91
    v_exp_f32 v62, v62
    v_exp_f32 v63, v63
    v_cvt_pk_bf16_f32 v61, v92, v93
    v_exp_f32 v64, v64
    v_exp_f32 v65, v65
    v_cvt_pk_bf16_f32 v54, v62, v63
    v_exp_f32 v66, v66
    v_exp_f32 v67, v67
    v_cvt_pk_bf16_f32 v55, v64, v65
    v_exp_f32 v68, v68
    v_exp_f32 v69, v69
    v_cvt_pk_bf16_f32 v56, v66, v67
    v_exp_f32 v70, v70
    v_cvt_pk_bf16_f32 v57, v68, v69
    v_mfma_f32_32x32x16_bf16 v[78:93], v[22:25], v[14:17], v[142:157]
    ds_read_b128 v[30:33], v2 offset:0
    v_exp_f32 v71, v71
    v_exp_f32 v72, v72
    v_exp_f32 v73, v73
    v_mfma_f32_32x32x16_bf16 v[110:125], v[34:37], v[58:61], v[110:125]
    ds_read_b128 v[18:21], v4 offset:0
    v_exp_f32 v74, v74
    v_exp_f32 v75, v75
    v_exp_f32 v76, v76
    v_mfma_f32_32x32x16_bf16 v[94:109], v[38:41], v[54:57], v[94:109]
    ds_read_b128 v[34:37], v3 offset:0
    s_waitcnt lgkmcnt(3)
    v_exp_f32 v77, v77
    v_cvt_pk_bf16_f32 v58, v70, v71
    v_cvt_pk_bf16_f32 v59, v72, v73
    v_cvt_pk_bf16_f32 v60, v74, v75
    v_exp_f32 v78, v78
    v_exp_f32 v79, v79
    v_cvt_pk_bf16_f32 v61, v76, v77
    v_exp_f32 v80, v80
    v_exp_f32 v81, v81
    v_cvt_pk_bf16_f32 v54, v78, v79
    v_exp_f32 v82, v82
    v_exp_f32 v83, v83
    v_cvt_pk_bf16_f32 v55, v80, v81
    v_exp_f32 v84, v84
    v_exp_f32 v85, v85
    v_cvt_pk_bf16_f32 v56, v82, v83
    v_exp_f32 v86, v86
    v_cvt_pk_bf16_f32 v57, v84, v85
    v_mfma_f32_32x32x16_bf16 v[62:77], v[26:29], v[10:13], v[126:141]
    s_add_u32 m0, s33, 18432
    s_add_u32 s31, s36, 114688
    buffer_load_dwordx4 v1, s[8:11], s31 offen offset:0 lds
    v_exp_f32 v87, v87
    v_exp_f32 v88, v88
    v_exp_f32 v89, v89
    v_mfma_f32_32x32x16_bf16 v[94:109], v[42:45], v[58:61], v[94:109]
    v_exp_f32 v90, v90
    v_exp_f32 v91, v91
    v_exp_f32 v92, v92
    v_mfma_f32_32x32x16_bf16 v[110:125], v[38:41], v[54:57], v[110:125]
    s_add_u32 m0, s33, 18432
    s_add_u32 s31, s36, 114688
    buffer_load_dwordx4 v1, s[8:11], s31 offen offset:1024 lds
    v_exp_f32 v93, v93
    v_cvt_pk_bf16_f32 v58, v86, v87
    v_cvt_pk_bf16_f32 v59, v88, v89
    v_cvt_pk_bf16_f32 v60, v90, v91
    v_exp_f32 v62, v62
    v_exp_f32 v63, v63
    v_cvt_pk_bf16_f32 v61, v92, v93
    v_exp_f32 v64, v64
    v_exp_f32 v65, v65
    v_cvt_pk_bf16_f32 v54, v62, v63
    v_exp_f32 v66, v66
    v_exp_f32 v67, v67
    v_cvt_pk_bf16_f32 v55, v64, v65
    v_exp_f32 v68, v68
    v_exp_f32 v69, v69
    v_cvt_pk_bf16_f32 v56, v66, v67
    v_exp_f32 v70, v70
    v_cvt_pk_bf16_f32 v57, v68, v69
    v_mfma_f32_32x32x16_bf16 v[78:93], v[26:29], v[14:17], v[142:157]
    ds_read_b128 v[38:41], v2 offset:2304
    v_exp_f32 v71, v71
    v_exp_f32 v72, v72
    v_exp_f32 v73, v73
    v_mfma_f32_32x32x16_bf16 v[110:125], v[42:45], v[58:61], v[110:125]
    ds_read_b128 v[22:25], v4 offset:2304
    v_exp_f32 v74, v74
    v_exp_f32 v75, v75
    v_exp_f32 v76, v76
    v_mfma_f32_32x32x16_bf16 v[94:109], v[46:49], v[54:57], v[94:109]
    ds_read_b128 v[42:45], v3 offset:2304
    s_waitcnt lgkmcnt(3)
    v_exp_f32 v77, v77
    v_cvt_pk_bf16_f32 v58, v70, v71
    v_cvt_pk_bf16_f32 v59, v72, v73
    v_cvt_pk_bf16_f32 v60, v74, v75
    v_exp_f32 v78, v78
    v_exp_f32 v79, v79
    v_cvt_pk_bf16_f32 v61, v76, v77
    v_exp_f32 v80, v80
    v_exp_f32 v81, v81
    v_cvt_pk_bf16_f32 v54, v78, v79
    v_exp_f32 v82, v82
    v_exp_f32 v83, v83
    v_cvt_pk_bf16_f32 v55, v80, v81
    v_exp_f32 v84, v84
    v_exp_f32 v85, v85
    v_cvt_pk_bf16_f32 v56, v82, v83
    v_exp_f32 v86, v86
    v_cvt_pk_bf16_f32 v57, v84, v85
    v_mfma_f32_32x32x16_bf16 v[62:77], v[18:21], v[10:13], v[126:141]
    s_add_u32 m0, s33, 27648
    s_add_u32 s31, s36, 122880
    buffer_load_dwordx4 v1, s[8:11], s31 offen offset:0 lds
    v_exp_f32 v87, v87
    v_exp_f32 v88, v88
    v_exp_f32 v89, v89
    v_mfma_f32_32x32x16_bf16 v[94:109], v[50:53], v[58:61], v[94:109]
    v_exp_f32 v90, v90
    v_exp_f32 v91, v91
    v_exp_f32 v92, v92
    v_mfma_f32_32x32x16_bf16 v[110:125], v[46:49], v[54:57], v[110:125]
    s_add_u32 m0, s33, 27648
    s_add_u32 s31, s36, 122880
    buffer_load_dwordx4 v1, s[8:11], s31 offen offset:1024 lds
    v_exp_f32 v93, v93
    v_cvt_pk_bf16_f32 v58, v86, v87
    v_cvt_pk_bf16_f32 v59, v88, v89
    v_cvt_pk_bf16_f32 v60, v90, v91
    v_exp_f32 v62, v62
    v_exp_f32 v63, v63
    v_cvt_pk_bf16_f32 v61, v92, v93
    v_exp_f32 v64, v64
    v_exp_f32 v65, v65
    v_cvt_pk_bf16_f32 v54, v62, v63
    v_exp_f32 v66, v66
    v_exp_f32 v67, v67
    v_cvt_pk_bf16_f32 v55, v64, v65
    v_exp_f32 v68, v68
    v_exp_f32 v69, v69
    v_cvt_pk_bf16_f32 v56, v66, v67
    v_exp_f32 v70, v70
    v_cvt_pk_bf16_f32 v57, v68, v69
    v_mfma_f32_32x32x16_bf16 v[78:93], v[18:21], v[14:17], v[142:157]
    ds_read_b128 v[46:49], v2 offset:4608
    v_exp_f32 v71, v71
    v_exp_f32 v72, v72
    v_exp_f32 v73, v73
    v_mfma_f32_32x32x16_bf16 v[110:125], v[50:53], v[58:61], v[110:125]
    ds_read_b128 v[26:29], v4 offset:4608
    v_exp_f32 v74, v74
    v_exp_f32 v75, v75
    v_exp_f32 v76, v76
    v_mfma_f32_32x32x16_bf16 v[94:109], v[30:33], v[54:57], v[94:109]
    ds_read_b128 v[50:53], v3 offset:4608
    s_waitcnt lgkmcnt(3)
    v_exp_f32 v77, v77
    v_cvt_pk_bf16_f32 v58, v70, v71
    v_cvt_pk_bf16_f32 v59, v72, v73
    v_cvt_pk_bf16_f32 v60, v74, v75
    v_exp_f32 v78, v78
    v_exp_f32 v79, v79
    v_cvt_pk_bf16_f32 v61, v76, v77
    v_exp_f32 v80, v80
    v_exp_f32 v81, v81
    v_cvt_pk_bf16_f32 v54, v78, v79
    v_exp_f32 v82, v82
    v_exp_f32 v83, v83
    v_cvt_pk_bf16_f32 v55, v80, v81
    v_exp_f32 v84, v84
    v_exp_f32 v85, v85
    v_cvt_pk_bf16_f32 v56, v82, v83
    v_exp_f32 v86, v86
    v_cvt_pk_bf16_f32 v57, v84, v85
    v_mfma_f32_32x32x16_bf16 v[62:77], v[22:25], v[10:13], v[126:141]
    v_exp_f32 v87, v87
    v_exp_f32 v88, v88
    v_exp_f32 v89, v89
    v_mfma_f32_32x32x16_bf16 v[94:109], v[34:37], v[58:61], v[94:109]
    v_exp_f32 v90, v90
    v_exp_f32 v91, v91
    v_exp_f32 v92, v92
    v_mfma_f32_32x32x16_bf16 v[110:125], v[30:33], v[54:57], v[110:125]
    v_exp_f32 v93, v93
    v_cvt_pk_bf16_f32 v58, v86, v87
    v_cvt_pk_bf16_f32 v59, v88, v89
    v_cvt_pk_bf16_f32 v60, v90, v91
    v_exp_f32 v62, v62
    v_exp_f32 v63, v63
    v_cvt_pk_bf16_f32 v61, v92, v93
    v_exp_f32 v64, v64
    v_exp_f32 v65, v65
    v_cvt_pk_bf16_f32 v54, v62, v63
    v_exp_f32 v66, v66
    v_exp_f32 v67, v67
    v_cvt_pk_bf16_f32 v55, v64, v65
    v_exp_f32 v68, v68
    v_exp_f32 v69, v69
    v_cvt_pk_bf16_f32 v56, v66, v67
    v_exp_f32 v70, v70
    v_cvt_pk_bf16_f32 v57, v68, v69
    v_mfma_f32_32x32x16_bf16 v[78:93], v[22:25], v[14:17], v[142:157]
    ds_read_b128 v[30:33], v2 offset:6912
    v_exp_f32 v71, v71
    v_exp_f32 v72, v72
    v_exp_f32 v73, v73
    v_mfma_f32_32x32x16_bf16 v[110:125], v[34:37], v[58:61], v[110:125]
    ds_read_b128 v[18:21], v4 offset:6912
    v_exp_f32 v74, v74
    v_exp_f32 v75, v75
    v_exp_f32 v76, v76
    v_mfma_f32_32x32x16_bf16 v[94:109], v[38:41], v[54:57], v[94:109]
    ds_read_b128 v[34:37], v3 offset:6912
    s_waitcnt lgkmcnt(3)
    v_exp_f32 v77, v77
    v_cvt_pk_bf16_f32 v58, v70, v71
    v_cvt_pk_bf16_f32 v59, v72, v73
    v_cvt_pk_bf16_f32 v60, v74, v75
    v_exp_f32 v78, v78
    v_exp_f32 v79, v79
    v_cvt_pk_bf16_f32 v61, v76, v77
    v_exp_f32 v80, v80
    v_exp_f32 v81, v81
    v_cvt_pk_bf16_f32 v54, v78, v79
    v_exp_f32 v82, v82
    v_exp_f32 v83, v83
    v_cvt_pk_bf16_f32 v55, v80, v81
    v_exp_f32 v84, v84
    v_exp_f32 v85, v85
    v_cvt_pk_bf16_f32 v56, v82, v83
    v_exp_f32 v86, v86
    v_cvt_pk_bf16_f32 v57, v84, v85
    v_mfma_f32_32x32x16_bf16 v[62:77], v[26:29], v[10:13], v[126:141]
    v_exp_f32 v87, v87
    v_exp_f32 v88, v88
    v_exp_f32 v89, v89
    v_mfma_f32_32x32x16_bf16 v[94:109], v[42:45], v[58:61], v[94:109]
    v_exp_f32 v90, v90
    v_exp_f32 v91, v91
    v_exp_f32 v92, v92
    v_mfma_f32_32x32x16_bf16 v[110:125], v[38:41], v[54:57], v[110:125]
    v_exp_f32 v93, v93
    v_cvt_pk_bf16_f32 v58, v86, v87
    v_cvt_pk_bf16_f32 v59, v88, v89
    v_cvt_pk_bf16_f32 v60, v90, v91
    v_exp_f32 v62, v62
    v_exp_f32 v63, v63
    v_cvt_pk_bf16_f32 v61, v92, v93
    v_exp_f32 v64, v64
    v_exp_f32 v65, v65
    v_cvt_pk_bf16_f32 v54, v62, v63
    v_exp_f32 v66, v66
    v_exp_f32 v67, v67
    v_cvt_pk_bf16_f32 v55, v64, v65
    v_exp_f32 v68, v68
    v_exp_f32 v69, v69
    v_cvt_pk_bf16_f32 v56, v66, v67
    v_exp_f32 v70, v70
    v_cvt_pk_bf16_f32 v57, v68, v69
    v_mfma_f32_32x32x16_bf16 v[78:93], v[26:29], v[14:17], v[142:157]
    ds_read_b128 v[38:41], v2 offset:9216
    v_exp_f32 v71, v71
    v_exp_f32 v72, v72
    v_exp_f32 v73, v73
    v_mfma_f32_32x32x16_bf16 v[110:125], v[42:45], v[58:61], v[110:125]
    ds_read_b128 v[22:25], v4 offset:9216
    v_exp_f32 v74, v74
    v_exp_f32 v75, v75
    v_exp_f32 v76, v76
    v_mfma_f32_32x32x16_bf16 v[94:109], v[46:49], v[54:57], v[94:109]
    ds_read_b128 v[42:45], v3 offset:9216
    s_waitcnt lgkmcnt(3)
    v_exp_f32 v77, v77
    v_cvt_pk_bf16_f32 v58, v70, v71
    v_cvt_pk_bf16_f32 v59, v72, v73
    v_cvt_pk_bf16_f32 v60, v74, v75
    v_exp_f32 v78, v78
    v_exp_f32 v79, v79
    v_cvt_pk_bf16_f32 v61, v76, v77
    v_exp_f32 v80, v80
    v_exp_f32 v81, v81
    v_cvt_pk_bf16_f32 v54, v78, v79
    v_exp_f32 v82, v82
    v_exp_f32 v83, v83
    v_cvt_pk_bf16_f32 v55, v80, v81
    v_exp_f32 v84, v84
    v_exp_f32 v85, v85
    v_cvt_pk_bf16_f32 v56, v82, v83
    v_exp_f32 v86, v86
    v_cvt_pk_bf16_f32 v57, v84, v85
    v_mfma_f32_32x32x16_bf16 v[62:77], v[18:21], v[10:13], v[126:141]
    v_exp_f32 v87, v87
    v_exp_f32 v88, v88
    v_exp_f32 v89, v89
    v_mfma_f32_32x32x16_bf16 v[94:109], v[50:53], v[58:61], v[94:109]
    v_exp_f32 v90, v90
    v_exp_f32 v91, v91
    v_exp_f32 v92, v92
    v_mfma_f32_32x32x16_bf16 v[110:125], v[46:49], v[54:57], v[110:125]
    v_exp_f32 v93, v93
    v_cvt_pk_bf16_f32 v58, v86, v87
    v_cvt_pk_bf16_f32 v59, v88, v89
    v_cvt_pk_bf16_f32 v60, v90, v91
    v_exp_f32 v62, v62
    v_exp_f32 v63, v63
    v_cvt_pk_bf16_f32 v61, v92, v93
    v_exp_f32 v64, v64
    v_exp_f32 v65, v65
    v_cvt_pk_bf16_f32 v54, v62, v63
    v_exp_f32 v66, v66
    v_exp_f32 v67, v67
    v_cvt_pk_bf16_f32 v55, v64, v65
    v_exp_f32 v68, v68
    v_exp_f32 v69, v69
    v_cvt_pk_bf16_f32 v56, v66, v67
    v_exp_f32 v70, v70
    v_cvt_pk_bf16_f32 v57, v68, v69
    v_mfma_f32_32x32x16_bf16 v[78:93], v[18:21], v[14:17], v[142:157]
    ds_read_b128 v[46:49], v2 offset:11520
    v_exp_f32 v71, v71
    v_exp_f32 v72, v72
    v_exp_f32 v73, v73
    v_mfma_f32_32x32x16_bf16 v[110:125], v[50:53], v[58:61], v[110:125]
    ds_read_b128 v[26:29], v4 offset:11520
    v_exp_f32 v74, v74
    v_exp_f32 v75, v75
    v_exp_f32 v76, v76
    v_mfma_f32_32x32x16_bf16 v[94:109], v[30:33], v[54:57], v[94:109]
    ds_read_b128 v[50:53], v3 offset:11520
    s_waitcnt lgkmcnt(3)
    v_exp_f32 v77, v77
    v_cvt_pk_bf16_f32 v58, v70, v71
    v_cvt_pk_bf16_f32 v59, v72, v73
    v_cvt_pk_bf16_f32 v60, v74, v75
    v_exp_f32 v78, v78
    v_exp_f32 v79, v79
    v_cvt_pk_bf16_f32 v61, v76, v77
    v_exp_f32 v80, v80
    v_exp_f32 v81, v81
    v_cvt_pk_bf16_f32 v54, v78, v79
    v_exp_f32 v82, v82
    v_exp_f32 v83, v83
    v_cvt_pk_bf16_f32 v55, v80, v81
    v_exp_f32 v84, v84
    v_exp_f32 v85, v85
    v_cvt_pk_bf16_f32 v56, v82, v83
    v_exp_f32 v86, v86
    v_cvt_pk_bf16_f32 v57, v84, v85
    v_mfma_f32_32x32x16_bf16 v[62:77], v[22:25], v[10:13], v[126:141]
    v_exp_f32 v87, v87
    v_exp_f32 v88, v88
    v_exp_f32 v89, v89
    v_mfma_f32_32x32x16_bf16 v[94:109], v[34:37], v[58:61], v[94:109]
    v_exp_f32 v90, v90
    v_exp_f32 v91, v91
    v_exp_f32 v92, v92
    v_mfma_f32_32x32x16_bf16 v[110:125], v[30:33], v[54:57], v[110:125]
    v_exp_f32 v93, v93
    v_cvt_pk_bf16_f32 v58, v86, v87
    v_cvt_pk_bf16_f32 v59, v88, v89
    v_cvt_pk_bf16_f32 v60, v90, v91
    v_exp_f32 v62, v62
    v_exp_f32 v63, v63
    v_cvt_pk_bf16_f32 v61, v92, v93
    v_exp_f32 v64, v64
    v_exp_f32 v65, v65
    v_cvt_pk_bf16_f32 v54, v62, v63
    v_exp_f32 v66, v66
    v_exp_f32 v67, v67
    v_cvt_pk_bf16_f32 v55, v64, v65
    v_exp_f32 v68, v68
    v_exp_f32 v69, v69
    v_cvt_pk_bf16_f32 v56, v66, v67
    v_exp_f32 v70, v70
    v_cvt_pk_bf16_f32 v57, v68, v69
    v_mfma_f32_32x32x16_bf16 v[78:93], v[22:25], v[14:17], v[142:157]
    ds_read_b128 v[30:33], v2 offset:13824
    v_exp_f32 v71, v71
    v_exp_f32 v72, v72
    v_exp_f32 v73, v73
    v_mfma_f32_32x32x16_bf16 v[110:125], v[34:37], v[58:61], v[110:125]
    ds_read_b128 v[18:21], v4 offset:13824
    v_exp_f32 v74, v74
    v_exp_f32 v75, v75
    v_exp_f32 v76, v76
    v_mfma_f32_32x32x16_bf16 v[94:109], v[38:41], v[54:57], v[94:109]
    ds_read_b128 v[34:37], v3 offset:13824
    s_waitcnt lgkmcnt(3)
    v_exp_f32 v77, v77
    v_cvt_pk_bf16_f32 v58, v70, v71
    v_cvt_pk_bf16_f32 v59, v72, v73
    v_cvt_pk_bf16_f32 v60, v74, v75
    v_exp_f32 v78, v78
    v_exp_f32 v79, v79
    v_cvt_pk_bf16_f32 v61, v76, v77
    v_exp_f32 v80, v80
    v_exp_f32 v81, v81
    v_cvt_pk_bf16_f32 v54, v78, v79
    v_exp_f32 v82, v82
    v_exp_f32 v83, v83
    v_cvt_pk_bf16_f32 v55, v80, v81
    v_exp_f32 v84, v84
    v_exp_f32 v85, v85
    v_cvt_pk_bf16_f32 v56, v82, v83
    v_exp_f32 v86, v86
    v_cvt_pk_bf16_f32 v57, v84, v85
    v_mfma_f32_32x32x16_bf16 v[62:77], v[26:29], v[10:13], v[126:141]
    v_exp_f32 v87, v87
    v_exp_f32 v88, v88
    v_exp_f32 v89, v89
    v_mfma_f32_32x32x16_bf16 v[94:109], v[42:45], v[58:61], v[94:109]
    v_exp_f32 v90, v90
    v_exp_f32 v91, v91
    v_exp_f32 v92, v92
    v_mfma_f32_32x32x16_bf16 v[110:125], v[38:41], v[54:57], v[110:125]
    v_exp_f32 v93, v93
    v_cvt_pk_bf16_f32 v58, v86, v87
    v_cvt_pk_bf16_f32 v59, v88, v89
    v_cvt_pk_bf16_f32 v60, v90, v91
    v_exp_f32 v62, v62
    v_exp_f32 v63, v63
    v_cvt_pk_bf16_f32 v61, v92, v93
    v_exp_f32 v64, v64
    v_exp_f32 v65, v65
    v_cvt_pk_bf16_f32 v54, v62, v63
    v_exp_f32 v66, v66
    v_exp_f32 v67, v67
    v_cvt_pk_bf16_f32 v55, v64, v65
    v_exp_f32 v68, v68
    v_exp_f32 v69, v69
    v_cvt_pk_bf16_f32 v56, v66, v67
    v_exp_f32 v70, v70
    v_cvt_pk_bf16_f32 v57, v68, v69
    v_mfma_f32_32x32x16_bf16 v[78:93], v[26:29], v[14:17], v[142:157]
    ds_read_b128 v[38:41], v2 offset:16128
    v_exp_f32 v71, v71
    v_exp_f32 v72, v72
    v_exp_f32 v73, v73
    v_mfma_f32_32x32x16_bf16 v[110:125], v[42:45], v[58:61], v[110:125]
    ds_read_b128 v[22:25], v4 offset:16128
    v_exp_f32 v74, v74
    v_exp_f32 v75, v75
    v_exp_f32 v76, v76
    v_mfma_f32_32x32x16_bf16 v[94:109], v[46:49], v[54:57], v[94:109]
    ds_read_b128 v[42:45], v3 offset:16128
    s_waitcnt lgkmcnt(3)
    v_exp_f32 v77, v77
    v_cvt_pk_bf16_f32 v58, v70, v71
    v_cvt_pk_bf16_f32 v59, v72, v73
    v_cvt_pk_bf16_f32 v60, v74, v75
    v_exp_f32 v78, v78
    v_exp_f32 v79, v79
    v_cvt_pk_bf16_f32 v61, v76, v77
    v_exp_f32 v80, v80
    v_exp_f32 v81, v81
    v_cvt_pk_bf16_f32 v54, v78, v79
    v_exp_f32 v82, v82
    v_exp_f32 v83, v83
    v_cvt_pk_bf16_f32 v55, v80, v81
    v_exp_f32 v84, v84
    v_exp_f32 v85, v85
    v_cvt_pk_bf16_f32 v56, v82, v83
    v_exp_f32 v86, v86
    v_cvt_pk_bf16_f32 v57, v84, v85
    v_mfma_f32_32x32x16_bf16 v[62:77], v[18:21], v[10:13], v[126:141]
    s_waitcnt vmcnt(0)
    s_barrier
    v_exp_f32 v87, v87
    v_exp_f32 v88, v88
    v_exp_f32 v89, v89
    v_mfma_f32_32x32x16_bf16 v[94:109], v[50:53], v[58:61], v[94:109]
    v_exp_f32 v90, v90
    v_exp_f32 v91, v91
    v_exp_f32 v92, v92
    v_mfma_f32_32x32x16_bf16 v[110:125], v[46:49], v[54:57], v[110:125]
    v_exp_f32 v93, v93
    v_cvt_pk_bf16_f32 v58, v86, v87
    v_cvt_pk_bf16_f32 v59, v88, v89
    v_cvt_pk_bf16_f32 v60, v90, v91
    v_exp_f32 v62, v62
    v_exp_f32 v63, v63
    v_cvt_pk_bf16_f32 v61, v92, v93
    v_exp_f32 v64, v64
    v_exp_f32 v65, v65
    v_cvt_pk_bf16_f32 v54, v62, v63
    v_exp_f32 v66, v66
    v_exp_f32 v67, v67
    v_cvt_pk_bf16_f32 v55, v64, v65
    v_exp_f32 v68, v68
    v_exp_f32 v69, v69
    v_cvt_pk_bf16_f32 v56, v66, v67
    v_exp_f32 v70, v70
    v_cvt_pk_bf16_f32 v57, v68, v69
    v_mfma_f32_32x32x16_bf16 v[78:93], v[18:21], v[14:17], v[142:157]
    ds_read_b128 v[46:49], v2 offset:18432
    v_exp_f32 v71, v71
    v_exp_f32 v72, v72
    v_exp_f32 v73, v73
    v_mfma_f32_32x32x16_bf16 v[110:125], v[50:53], v[58:61], v[110:125]
    ds_read_b128 v[26:29], v4 offset:18432
    v_exp_f32 v74, v74
    v_exp_f32 v75, v75
    v_exp_f32 v76, v76
    v_mfma_f32_32x32x16_bf16 v[94:109], v[30:33], v[54:57], v[94:109]
    ds_read_b128 v[50:53], v3 offset:18432
    s_waitcnt lgkmcnt(3)
    v_exp_f32 v77, v77
    v_cvt_pk_bf16_f32 v58, v70, v71
    v_cvt_pk_bf16_f32 v59, v72, v73
    v_cvt_pk_bf16_f32 v60, v74, v75
    v_exp_f32 v78, v78
    v_exp_f32 v79, v79
    v_cvt_pk_bf16_f32 v61, v76, v77
    v_exp_f32 v80, v80
    v_exp_f32 v81, v81
    v_cvt_pk_bf16_f32 v54, v78, v79
    v_exp_f32 v82, v82
    v_exp_f32 v83, v83
    v_cvt_pk_bf16_f32 v55, v80, v81
    v_exp_f32 v84, v84
    v_exp_f32 v85, v85
    v_cvt_pk_bf16_f32 v56, v82, v83
    v_exp_f32 v86, v86
    v_cvt_pk_bf16_f32 v57, v84, v85
    v_mfma_f32_32x32x16_bf16 v[62:77], v[22:25], v[10:13], v[126:141]
    v_exp_f32 v87, v87
    v_exp_f32 v88, v88
    v_exp_f32 v89, v89
    v_mfma_f32_32x32x16_bf16 v[94:109], v[34:37], v[58:61], v[94:109]
    v_exp_f32 v90, v90
    v_exp_f32 v91, v91
    v_exp_f32 v92, v92
    v_mfma_f32_32x32x16_bf16 v[110:125], v[30:33], v[54:57], v[110:125]
    v_exp_f32 v93, v93
    v_cvt_pk_bf16_f32 v58, v86, v87
    v_cvt_pk_bf16_f32 v59, v88, v89
    v_cvt_pk_bf16_f32 v60, v90, v91
    v_exp_f32 v62, v62
    v_exp_f32 v63, v63
    v_cvt_pk_bf16_f32 v61, v92, v93
    v_exp_f32 v64, v64
    v_exp_f32 v65, v65
    v_cvt_pk_bf16_f32 v54, v62, v63
    v_exp_f32 v66, v66
    v_exp_f32 v67, v67
    v_cvt_pk_bf16_f32 v55, v64, v65
    v_exp_f32 v68, v68
    v_exp_f32 v69, v69
    v_cvt_pk_bf16_f32 v56, v66, v67
    v_exp_f32 v70, v70
    v_cvt_pk_bf16_f32 v57, v68, v69
    v_mfma_f32_32x32x16_bf16 v[78:93], v[22:25], v[14:17], v[142:157]
    ds_read_b128 v[30:33], v2 offset:20736
    v_exp_f32 v71, v71
    v_exp_f32 v72, v72
    v_exp_f32 v73, v73
    v_mfma_f32_32x32x16_bf16 v[110:125], v[34:37], v[58:61], v[110:125]
    ds_read_b128 v[18:21], v4 offset:20736
    v_exp_f32 v74, v74
    v_exp_f32 v75, v75
    v_exp_f32 v76, v76
    v_mfma_f32_32x32x16_bf16 v[94:109], v[38:41], v[54:57], v[94:109]
    ds_read_b128 v[34:37], v3 offset:20736
    s_waitcnt lgkmcnt(3)
    v_exp_f32 v77, v77
    v_cvt_pk_bf16_f32 v58, v70, v71
    v_cvt_pk_bf16_f32 v59, v72, v73
    v_cvt_pk_bf16_f32 v60, v74, v75
    v_exp_f32 v78, v78
    v_exp_f32 v79, v79
    v_cvt_pk_bf16_f32 v61, v76, v77
    v_exp_f32 v80, v80
    v_exp_f32 v81, v81
    v_cvt_pk_bf16_f32 v54, v78, v79
    v_exp_f32 v82, v82
    v_exp_f32 v83, v83
    v_cvt_pk_bf16_f32 v55, v80, v81
    v_exp_f32 v84, v84
    v_exp_f32 v85, v85
    v_cvt_pk_bf16_f32 v56, v82, v83
    v_exp_f32 v86, v86
    v_cvt_pk_bf16_f32 v57, v84, v85
    v_mfma_f32_32x32x16_bf16 v[62:77], v[26:29], v[10:13], v[126:141]
    v_exp_f32 v87, v87
    v_exp_f32 v88, v88
    v_exp_f32 v89, v89
    v_mfma_f32_32x32x16_bf16 v[94:109], v[42:45], v[58:61], v[94:109]
    v_exp_f32 v90, v90
    v_exp_f32 v91, v91
    v_exp_f32 v92, v92
    v_mfma_f32_32x32x16_bf16 v[110:125], v[38:41], v[54:57], v[110:125]
    v_exp_f32 v93, v93
    v_cvt_pk_bf16_f32 v58, v86, v87
    v_cvt_pk_bf16_f32 v59, v88, v89
    v_cvt_pk_bf16_f32 v60, v90, v91
    v_exp_f32 v62, v62
    v_exp_f32 v63, v63
    v_cvt_pk_bf16_f32 v61, v92, v93
    v_exp_f32 v64, v64
    v_exp_f32 v65, v65
    v_cvt_pk_bf16_f32 v54, v62, v63
    v_exp_f32 v66, v66
    v_exp_f32 v67, v67
    v_cvt_pk_bf16_f32 v55, v64, v65
    v_exp_f32 v68, v68
    v_exp_f32 v69, v69
    v_cvt_pk_bf16_f32 v56, v66, v67
    v_exp_f32 v70, v70
    v_cvt_pk_bf16_f32 v57, v68, v69
    v_mfma_f32_32x32x16_bf16 v[78:93], v[26:29], v[14:17], v[142:157]
    ds_read_b128 v[38:41], v2 offset:23040
    v_exp_f32 v71, v71
    v_exp_f32 v72, v72
    v_exp_f32 v73, v73
    v_mfma_f32_32x32x16_bf16 v[110:125], v[42:45], v[58:61], v[110:125]
    ds_read_b128 v[22:25], v4 offset:23040
    v_exp_f32 v74, v74
    v_exp_f32 v75, v75
    v_exp_f32 v76, v76
    v_mfma_f32_32x32x16_bf16 v[94:109], v[46:49], v[54:57], v[94:109]
    ds_read_b128 v[42:45], v3 offset:23040
    s_waitcnt lgkmcnt(3)
    v_exp_f32 v77, v77
    v_cvt_pk_bf16_f32 v58, v70, v71
    v_cvt_pk_bf16_f32 v59, v72, v73
    v_cvt_pk_bf16_f32 v60, v74, v75
    v_exp_f32 v78, v78
    v_exp_f32 v79, v79
    v_cvt_pk_bf16_f32 v61, v76, v77
    v_exp_f32 v80, v80
    v_exp_f32 v81, v81
    v_cvt_pk_bf16_f32 v54, v78, v79
    v_exp_f32 v82, v82
    v_exp_f32 v83, v83
    v_cvt_pk_bf16_f32 v55, v80, v81
    v_exp_f32 v84, v84
    v_exp_f32 v85, v85
    v_cvt_pk_bf16_f32 v56, v82, v83
    v_exp_f32 v86, v86
    v_cvt_pk_bf16_f32 v57, v84, v85
    v_mfma_f32_32x32x16_bf16 v[62:77], v[18:21], v[10:13], v[126:141]
    v_exp_f32 v87, v87
    v_exp_f32 v88, v88
    v_exp_f32 v89, v89
    v_mfma_f32_32x32x16_bf16 v[94:109], v[50:53], v[58:61], v[94:109]
    v_exp_f32 v90, v90
    v_exp_f32 v91, v91
    v_exp_f32 v92, v92
    v_mfma_f32_32x32x16_bf16 v[110:125], v[46:49], v[54:57], v[110:125]
    v_exp_f32 v93, v93
    v_cvt_pk_bf16_f32 v58, v86, v87
    v_cvt_pk_bf16_f32 v59, v88, v89
    v_cvt_pk_bf16_f32 v60, v90, v91
    v_exp_f32 v62, v62
    v_exp_f32 v63, v63
    v_cvt_pk_bf16_f32 v61, v92, v93
    v_exp_f32 v64, v64
    v_exp_f32 v65, v65
    v_cvt_pk_bf16_f32 v54, v62, v63
    v_exp_f32 v66, v66
    v_exp_f32 v67, v67
    v_cvt_pk_bf16_f32 v55, v64, v65
    v_exp_f32 v68, v68
    v_exp_f32 v69, v69
    v_cvt_pk_bf16_f32 v56, v66, v67
    v_exp_f32 v70, v70
    v_cvt_pk_bf16_f32 v57, v68, v69
    v_mfma_f32_32x32x16_bf16 v[78:93], v[18:21], v[14:17], v[142:157]
    ds_read_b128 v[46:49], v2 offset:25344
    v_exp_f32 v71, v71
    v_exp_f32 v72, v72
    v_exp_f32 v73, v73
    v_mfma_f32_32x32x16_bf16 v[110:125], v[50:53], v[58:61], v[110:125]
    ds_read_b128 v[26:29], v4 offset:25344
    v_exp_f32 v74, v74
    v_exp_f32 v75, v75
    v_exp_f32 v76, v76
    v_mfma_f32_32x32x16_bf16 v[94:109], v[30:33], v[54:57], v[94:109]
    ds_read_b128 v[50:53], v3 offset:25344
    s_waitcnt lgkmcnt(3)
    v_exp_f32 v77, v77
    v_cvt_pk_bf16_f32 v58, v70, v71
    v_cvt_pk_bf16_f32 v59, v72, v73
    v_cvt_pk_bf16_f32 v60, v74, v75
    v_exp_f32 v78, v78
    v_exp_f32 v79, v79
    v_cvt_pk_bf16_f32 v61, v76, v77
    v_exp_f32 v80, v80
    v_exp_f32 v81, v81
    v_cvt_pk_bf16_f32 v54, v78, v79
    v_exp_f32 v82, v82
    v_exp_f32 v83, v83
    v_cvt_pk_bf16_f32 v55, v80, v81
    v_exp_f32 v84, v84
    v_exp_f32 v85, v85
    v_cvt_pk_bf16_f32 v56, v82, v83
    v_exp_f32 v86, v86
    v_cvt_pk_bf16_f32 v57, v84, v85
    v_mfma_f32_32x32x16_bf16 v[62:77], v[22:25], v[10:13], v[126:141]
    v_exp_f32 v87, v87
    v_exp_f32 v88, v88
    v_exp_f32 v89, v89
    v_mfma_f32_32x32x16_bf16 v[94:109], v[34:37], v[58:61], v[94:109]
    v_exp_f32 v90, v90
    v_exp_f32 v91, v91
    v_exp_f32 v92, v92
    v_mfma_f32_32x32x16_bf16 v[110:125], v[30:33], v[54:57], v[110:125]
    v_exp_f32 v93, v93
    v_cvt_pk_bf16_f32 v58, v86, v87
    v_cvt_pk_bf16_f32 v59, v88, v89
    v_cvt_pk_bf16_f32 v60, v90, v91
    v_exp_f32 v62, v62
    v_exp_f32 v63, v63
    v_cvt_pk_bf16_f32 v61, v92, v93
    v_exp_f32 v64, v64
    v_exp_f32 v65, v65
    v_cvt_pk_bf16_f32 v54, v62, v63
    v_exp_f32 v66, v66
    v_exp_f32 v67, v67
    v_cvt_pk_bf16_f32 v55, v64, v65
    v_exp_f32 v68, v68
    v_exp_f32 v69, v69
    v_cvt_pk_bf16_f32 v56, v66, v67
    v_exp_f32 v70, v70
    v_cvt_pk_bf16_f32 v57, v68, v69
    v_mfma_f32_32x32x16_bf16 v[78:93], v[22:25], v[14:17], v[142:157]
    ds_read_b128 v[30:33], v2 offset:27648
    v_exp_f32 v71, v71
    v_exp_f32 v72, v72
    v_exp_f32 v73, v73
    v_mfma_f32_32x32x16_bf16 v[110:125], v[34:37], v[58:61], v[110:125]
    ds_read_b128 v[18:21], v4 offset:27648
    v_exp_f32 v74, v74
    v_exp_f32 v75, v75
    v_exp_f32 v76, v76
    v_mfma_f32_32x32x16_bf16 v[94:109], v[38:41], v[54:57], v[94:109]
    ds_read_b128 v[34:37], v3 offset:27648
    s_waitcnt lgkmcnt(3)
    v_exp_f32 v77, v77
    v_cvt_pk_bf16_f32 v58, v70, v71
    v_cvt_pk_bf16_f32 v59, v72, v73
    v_cvt_pk_bf16_f32 v60, v74, v75
    v_exp_f32 v78, v78
    v_exp_f32 v79, v79
    v_cvt_pk_bf16_f32 v61, v76, v77
    v_exp_f32 v80, v80
    v_exp_f32 v81, v81
    v_cvt_pk_bf16_f32 v54, v78, v79
    v_exp_f32 v82, v82
    v_exp_f32 v83, v83
    v_cvt_pk_bf16_f32 v55, v80, v81
    v_exp_f32 v84, v84
    v_exp_f32 v85, v85
    v_cvt_pk_bf16_f32 v56, v82, v83
    v_exp_f32 v86, v86
    v_cvt_pk_bf16_f32 v57, v84, v85
    v_mfma_f32_32x32x16_bf16 v[62:77], v[26:29], v[10:13], v[126:141]
    v_exp_f32 v87, v87
    v_exp_f32 v88, v88
    v_exp_f32 v89, v89
    v_mfma_f32_32x32x16_bf16 v[94:109], v[42:45], v[58:61], v[94:109]
    v_exp_f32 v90, v90
    v_exp_f32 v91, v91
    v_exp_f32 v92, v92
    v_mfma_f32_32x32x16_bf16 v[110:125], v[38:41], v[54:57], v[110:125]
    v_exp_f32 v93, v93
    v_cvt_pk_bf16_f32 v58, v86, v87
    v_cvt_pk_bf16_f32 v59, v88, v89
    v_cvt_pk_bf16_f32 v60, v90, v91
    v_exp_f32 v62, v62
    v_exp_f32 v63, v63
    v_cvt_pk_bf16_f32 v61, v92, v93
    v_exp_f32 v64, v64
    v_exp_f32 v65, v65
    v_cvt_pk_bf16_f32 v54, v62, v63
    v_exp_f32 v66, v66
    v_exp_f32 v67, v67
    v_cvt_pk_bf16_f32 v55, v64, v65
    v_exp_f32 v68, v68
    v_exp_f32 v69, v69
    v_cvt_pk_bf16_f32 v56, v66, v67
    v_exp_f32 v70, v70
    v_cvt_pk_bf16_f32 v57, v68, v69
    v_mfma_f32_32x32x16_bf16 v[78:93], v[26:29], v[14:17], v[142:157]
    ds_read_b128 v[38:41], v2 offset:29952
    v_exp_f32 v71, v71
    v_exp_f32 v72, v72
    v_exp_f32 v73, v73
    v_mfma_f32_32x32x16_bf16 v[110:125], v[42:45], v[58:61], v[110:125]
    ds_read_b128 v[22:25], v4 offset:29952
    v_exp_f32 v74, v74
    v_exp_f32 v75, v75
    v_exp_f32 v76, v76
    v_mfma_f32_32x32x16_bf16 v[94:109], v[46:49], v[54:57], v[94:109]
    ds_read_b128 v[42:45], v3 offset:29952
    s_waitcnt lgkmcnt(3)
    v_exp_f32 v77, v77
    v_cvt_pk_bf16_f32 v58, v70, v71
    v_cvt_pk_bf16_f32 v59, v72, v73
    v_cvt_pk_bf16_f32 v60, v74, v75
    v_exp_f32 v78, v78
    v_exp_f32 v79, v79
    v_cvt_pk_bf16_f32 v61, v76, v77
    v_exp_f32 v80, v80
    v_exp_f32 v81, v81
    v_cvt_pk_bf16_f32 v54, v78, v79
    v_exp_f32 v82, v82
    v_exp_f32 v83, v83
    v_cvt_pk_bf16_f32 v55, v80, v81
    v_exp_f32 v84, v84
    v_exp_f32 v85, v85
    v_cvt_pk_bf16_f32 v56, v82, v83
    v_exp_f32 v86, v86
    v_cvt_pk_bf16_f32 v57, v84, v85
    v_mfma_f32_32x32x16_bf16 v[62:77], v[18:21], v[10:13], v[126:141]
    v_exp_f32 v87, v87
    v_exp_f32 v88, v88
    v_exp_f32 v89, v89
    v_mfma_f32_32x32x16_bf16 v[94:109], v[50:53], v[58:61], v[94:109]
    v_exp_f32 v90, v90
    v_exp_f32 v91, v91
    v_exp_f32 v92, v92
    v_mfma_f32_32x32x16_bf16 v[110:125], v[46:49], v[54:57], v[110:125]
    v_exp_f32 v93, v93
    v_cvt_pk_bf16_f32 v58, v86, v87
    v_cvt_pk_bf16_f32 v59, v88, v89
    v_cvt_pk_bf16_f32 v60, v90, v91
    v_exp_f32 v62, v62
    v_exp_f32 v63, v63
    v_cvt_pk_bf16_f32 v61, v92, v93
    v_exp_f32 v64, v64
    v_exp_f32 v65, v65
    v_cvt_pk_bf16_f32 v54, v62, v63
    v_exp_f32 v66, v66
    v_exp_f32 v67, v67
    v_cvt_pk_bf16_f32 v55, v64, v65
    v_exp_f32 v68, v68
    v_exp_f32 v69, v69
    v_cvt_pk_bf16_f32 v56, v66, v67
    v_exp_f32 v70, v70
    v_cvt_pk_bf16_f32 v57, v68, v69
    v_mfma_f32_32x32x16_bf16 v[78:93], v[18:21], v[14:17], v[142:157]
    ds_read_b128 v[46:49], v2 offset:32256
    v_exp_f32 v71, v71
    v_exp_f32 v72, v72
    v_exp_f32 v73, v73
    v_mfma_f32_32x32x16_bf16 v[110:125], v[50:53], v[58:61], v[110:125]
    ds_read_b128 v[26:29], v4 offset:32256
    v_exp_f32 v74, v74
    v_exp_f32 v75, v75
    v_exp_f32 v76, v76
    v_mfma_f32_32x32x16_bf16 v[94:109], v[30:33], v[54:57], v[94:109]
    ds_read_b128 v[50:53], v3 offset:32256
    s_waitcnt lgkmcnt(3)
    v_exp_f32 v77, v77
    v_cvt_pk_bf16_f32 v58, v70, v71
    v_cvt_pk_bf16_f32 v59, v72, v73
    v_cvt_pk_bf16_f32 v60, v74, v75
    v_exp_f32 v78, v78
    v_exp_f32 v79, v79
    v_cvt_pk_bf16_f32 v61, v76, v77
    v_exp_f32 v80, v80
    v_exp_f32 v81, v81
    v_cvt_pk_bf16_f32 v54, v78, v79
    v_exp_f32 v82, v82
    v_exp_f32 v83, v83
    v_cvt_pk_bf16_f32 v55, v80, v81
    v_exp_f32 v84, v84
    v_exp_f32 v85, v85
    v_cvt_pk_bf16_f32 v56, v82, v83
    v_exp_f32 v86, v86
    v_cvt_pk_bf16_f32 v57, v84, v85
    v_mfma_f32_32x32x16_bf16 v[62:77], v[22:25], v[10:13], v[126:141]
    v_exp_f32 v87, v87
    v_exp_f32 v88, v88
    v_exp_f32 v89, v89
    v_mfma_f32_32x32x16_bf16 v[94:109], v[34:37], v[58:61], v[94:109]
    v_exp_f32 v90, v90
    v_exp_f32 v91, v91
    v_exp_f32 v92, v92
    v_mfma_f32_32x32x16_bf16 v[110:125], v[30:33], v[54:57], v[110:125]
    v_exp_f32 v93, v93
    v_cvt_pk_bf16_f32 v58, v86, v87
    v_cvt_pk_bf16_f32 v59, v88, v89
    v_cvt_pk_bf16_f32 v60, v90, v91
    v_exp_f32 v62, v62
    v_exp_f32 v63, v63
    v_cvt_pk_bf16_f32 v61, v92, v93
    v_exp_f32 v64, v64
    v_exp_f32 v65, v65
    v_cvt_pk_bf16_f32 v54, v62, v63
    v_exp_f32 v66, v66
    v_exp_f32 v67, v67
    v_cvt_pk_bf16_f32 v55, v64, v65
    v_exp_f32 v68, v68
    v_exp_f32 v69, v69
    v_cvt_pk_bf16_f32 v56, v66, v67
    v_exp_f32 v70, v70
    v_cvt_pk_bf16_f32 v57, v68, v69
    v_mfma_f32_32x32x16_bf16 v[78:93], v[22:25], v[14:17], v[142:157]
    ds_read_b128 v[30:33], v2 offset:34560
    v_exp_f32 v71, v71
    v_exp_f32 v72, v72
    v_exp_f32 v73, v73
    v_mfma_f32_32x32x16_bf16 v[110:125], v[34:37], v[58:61], v[110:125]
    ds_read_b128 v[18:21], v4 offset:34560
    v_exp_f32 v74, v74
    v_exp_f32 v75, v75
    v_exp_f32 v76, v76
    v_mfma_f32_32x32x16_bf16 v[94:109], v[38:41], v[54:57], v[94:109]
    ds_read_b128 v[34:37], v3 offset:34560
    s_waitcnt lgkmcnt(3)
    v_exp_f32 v77, v77
    v_cvt_pk_bf16_f32 v58, v70, v71
    v_cvt_pk_bf16_f32 v59, v72, v73
    v_cvt_pk_bf16_f32 v60, v74, v75
    v_exp_f32 v78, v78
    v_exp_f32 v79, v79
    v_cvt_pk_bf16_f32 v61, v76, v77
    v_exp_f32 v80, v80
    v_exp_f32 v81, v81
    v_cvt_pk_bf16_f32 v54, v78, v79
    v_exp_f32 v82, v82
    v_exp_f32 v83, v83
    v_cvt_pk_bf16_f32 v55, v80, v81
    v_exp_f32 v84, v84
    v_exp_f32 v85, v85
    v_cvt_pk_bf16_f32 v56, v82, v83
    v_exp_f32 v86, v86
    v_cvt_pk_bf16_f32 v57, v84, v85
    v_mfma_f32_32x32x16_bf16 v[62:77], v[26:29], v[10:13], v[126:141]
    v_exp_f32 v87, v87
    v_exp_f32 v88, v88
    v_exp_f32 v89, v89
    v_mfma_f32_32x32x16_bf16 v[94:109], v[42:45], v[58:61], v[94:109]
    v_exp_f32 v90, v90
    v_exp_f32 v91, v91
    v_exp_f32 v92, v92
    v_mfma_f32_32x32x16_bf16 v[110:125], v[38:41], v[54:57], v[110:125]
    v_exp_f32 v93, v93
    v_cvt_pk_bf16_f32 v58, v86, v87
    v_cvt_pk_bf16_f32 v59, v88, v89
    v_cvt_pk_bf16_f32 v60, v90, v91
    v_exp_f32 v62, v62
    v_exp_f32 v63, v63
    v_cvt_pk_bf16_f32 v61, v92, v93
    v_exp_f32 v64, v64
    v_exp_f32 v65, v65
    v_cvt_pk_bf16_f32 v54, v62, v63
    v_exp_f32 v66, v66
    v_exp_f32 v67, v67
    v_cvt_pk_bf16_f32 v55, v64, v65
    v_exp_f32 v68, v68
    v_exp_f32 v69, v69
    v_cvt_pk_bf16_f32 v56, v66, v67
    v_exp_f32 v70, v70
    v_cvt_pk_bf16_f32 v57, v68, v69
    v_mfma_f32_32x32x16_bf16 v[78:93], v[26:29], v[14:17], v[142:157]
    v_exp_f32 v71, v71
    v_exp_f32 v72, v72
    v_exp_f32 v73, v73
    v_mfma_f32_32x32x16_bf16 v[110:125], v[42:45], v[58:61], v[110:125]
    v_exp_f32 v74, v74
    v_exp_f32 v75, v75
    v_exp_f32 v76, v76
    v_mfma_f32_32x32x16_bf16 v[94:109], v[46:49], v[54:57], v[94:109]
    s_waitcnt lgkmcnt(0)
    v_exp_f32 v77, v77
    v_cvt_pk_bf16_f32 v58, v70, v71
    v_cvt_pk_bf16_f32 v59, v72, v73
    v_cvt_pk_bf16_f32 v60, v74, v75
    v_exp_f32 v78, v78
    v_exp_f32 v79, v79
    v_cvt_pk_bf16_f32 v61, v76, v77
    v_exp_f32 v80, v80
    v_exp_f32 v81, v81
    v_cvt_pk_bf16_f32 v54, v78, v79
    v_exp_f32 v82, v82
    v_exp_f32 v83, v83
    v_cvt_pk_bf16_f32 v55, v80, v81
    v_exp_f32 v84, v84
    v_exp_f32 v85, v85
    v_cvt_pk_bf16_f32 v56, v82, v83
    v_exp_f32 v86, v86
    v_cvt_pk_bf16_f32 v57, v84, v85
    v_mfma_f32_32x32x16_bf16 v[62:77], v[18:21], v[10:13], v[126:141]
    v_exp_f32 v87, v87
    v_exp_f32 v88, v88
    v_exp_f32 v89, v89
    v_mfma_f32_32x32x16_bf16 v[94:109], v[50:53], v[58:61], v[94:109]
    v_exp_f32 v90, v90
    v_exp_f32 v91, v91
    v_exp_f32 v92, v92
    v_mfma_f32_32x32x16_bf16 v[110:125], v[46:49], v[54:57], v[110:125]
    v_exp_f32 v93, v93
    v_cvt_pk_bf16_f32 v58, v86, v87
    v_cvt_pk_bf16_f32 v59, v88, v89
    v_cvt_pk_bf16_f32 v60, v90, v91
    v_exp_f32 v62, v62
    v_exp_f32 v63, v63
    v_cvt_pk_bf16_f32 v61, v92, v93
    v_exp_f32 v64, v64
    v_exp_f32 v65, v65
    v_cvt_pk_bf16_f32 v54, v62, v63
    v_exp_f32 v66, v66
    v_exp_f32 v67, v67
    v_cvt_pk_bf16_f32 v55, v64, v65
    v_exp_f32 v68, v68
    v_exp_f32 v69, v69
    v_cvt_pk_bf16_f32 v56, v66, v67
    v_exp_f32 v70, v70
    v_cvt_pk_bf16_f32 v57, v68, v69
    v_mfma_f32_32x32x16_bf16 v[78:93], v[18:21], v[14:17], v[142:157]
    v_exp_f32 v71, v71
    v_exp_f32 v72, v72
    v_exp_f32 v73, v73
    v_mfma_f32_32x32x16_bf16 v[110:125], v[50:53], v[58:61], v[110:125]
    v_exp_f32 v74, v74
    v_exp_f32 v75, v75
    v_exp_f32 v76, v76
    v_mfma_f32_32x32x16_bf16 v[94:109], v[30:33], v[54:57], v[94:109]
    v_exp_f32 v77, v77
    v_cvt_pk_bf16_f32 v58, v70, v71
    v_cvt_pk_bf16_f32 v59, v72, v73
    v_cvt_pk_bf16_f32 v60, v74, v75
    v_exp_f32 v78, v78
    v_exp_f32 v79, v79
    v_cvt_pk_bf16_f32 v61, v76, v77
    v_exp_f32 v80, v80
    v_exp_f32 v81, v81
    v_cvt_pk_bf16_f32 v54, v78, v79
    v_exp_f32 v82, v82
    v_exp_f32 v83, v83
    v_cvt_pk_bf16_f32 v55, v80, v81
    v_exp_f32 v84, v84
    v_exp_f32 v85, v85
    v_cvt_pk_bf16_f32 v56, v82, v83
    v_exp_f32 v86, v86
    v_cvt_pk_bf16_f32 v57, v84, v85
    v_exp_f32 v87, v87
    v_exp_f32 v88, v88
    v_exp_f32 v89, v89
    v_mfma_f32_32x32x16_bf16 v[94:109], v[34:37], v[58:61], v[94:109]
    v_exp_f32 v90, v90
    v_exp_f32 v91, v91
    v_exp_f32 v92, v92
    v_mfma_f32_32x32x16_bf16 v[110:125], v[30:33], v[54:57], v[110:125]
    v_exp_f32 v93, v93
    v_cvt_pk_bf16_f32 v58, v86, v87
    v_cvt_pk_bf16_f32 v59, v88, v89
    v_cvt_pk_bf16_f32 v60, v90, v91
    v_cvt_pk_bf16_f32 v61, v92, v93
    s_nop 1
    v_mfma_f32_32x32x16_bf16 v[110:125], v[34:37], v[58:61], v[110:125]
    s_nop 11
    v_rcp_f32 v158, v102
    v_rcp_f32 v159, v118
    s_lshl_b32 s31, s24, 3
    s_lshl_b32 s32, s22, 1
    s_add_u32 s31, s31, s32
    s_lshl_b32 s31, s31, 5
    s_add_u32 s31, s31, s23
    s_lshl_b32 s31, s31, 10
    v_mul_f32 v62, v94, v158
    v_mul_f32 v63, v95, v158
    v_mul_f32 v64, v96, v158
    v_mul_f32 v65, v97, v158
    v_mul_f32 v66, v98, v158
    v_mul_f32 v67, v99, v158
    v_mul_f32 v68, v100, v158
    v_mul_f32 v69, v101, v158
    v_cvt_pk_bf16_f32 v54, v62, v63
    v_cvt_pk_bf16_f32 v55, v64, v65
    v_cvt_pk_bf16_f32 v56, v66, v67
    v_cvt_pk_bf16_f32 v57, v68, v69
    buffer_store_dwordx4 v[54:57], v1, s[16:19], s31 offen sc1
    s_add_u32 s31, s31, 32768
    v_mul_f32 v70, v110, v159
    v_mul_f32 v71, v111, v159
    v_mul_f32 v72, v112, v159
    v_mul_f32 v73, v113, v159
    v_mul_f32 v74, v114, v159
    v_mul_f32 v75, v115, v159
    v_mul_f32 v76, v116, v159
    v_mul_f32 v77, v117, v159
    v_cvt_pk_bf16_f32 v58, v70, v71
    v_cvt_pk_bf16_f32 v59, v72, v73
    v_cvt_pk_bf16_f32 v60, v74, v75
    v_cvt_pk_bf16_f32 v61, v76, v77
    buffer_store_dwordx4 v[58:61], v1, s[16:19], s31 offen sc1
    s_cmp_lg_u32 s30, 0
    s_cbranch_scc1 A_DONE
    v_mul_f32 v160, 0, v102
    v_fma_f32 v160, v94, 0, v160
    v_fma_f32 v160, v95, 0, v160
    v_fma_f32 v160, v96, 0, v160
    v_fma_f32 v160, v97, 0, v160
    v_fma_f32 v160, v98, 0, v160
    v_fma_f32 v160, v99, 0, v160
    v_fma_f32 v160, v100, 0, v160
    v_fma_f32 v160, v101, 0, v160
    v_fma_f32 v160, v110, 0, v160
    v_fma_f32 v160, v111, 0, v160
    v_fma_f32 v160, v112, 0, v160
    v_fma_f32 v160, v113, 0, v160
    v_fma_f32 v160, v114, 0, v160
    v_fma_f32 v160, v115, 0, v160
    v_fma_f32 v160, v116, 0, v160
    v_fma_f32 v160, v117, 0, v160
    v_fma_f32 v160, v118, 0, v160
    v_cmp_u_f32 vcc, v160, v160
    s_mov_b64 s[38:39], vcc
    v_min_f32 v160, v102, v118
    v_mov_b32 v161, 0x2b800000
    v_cmp_nge_f32 vcc, v160, v161
    s_or_b64 vcc, vcc, s[38:39]
    s_cbranch_vccz A_OK
    v_mov_b32 v160, 55296
    v_mov_b32 v161, 1
    ds_write_b32 v160, v161
A_OK:
    s_waitcnt lgkmcnt(0)
    s_barrier
    v_mov_b32 v160, 55296
    ds_read_b32 v161, v160
    s_waitcnt lgkmcnt(0)
    v_readfirstlane_b32 s31, v161
    s_cmp_lg_u32 s31, 0
    s_cbranch_scc1 A_SLOW
A_DONE:
    s_lshl_b32 s31, s24, 2
    s_add_u32 s31, s31, s22
    s_add_u32 s38, s20, 0x1d02800
    s_addc_u32 s39, s21, 0
    s_lshl_b32 vcc_lo, s31, 7
    v_mov_b32 v158, vcc_lo
    v_mov_b32 v159, 1
    s_waitcnt vmcnt(0)
    s_mov_b64 exec, 1
    global_atomic_add v158, v159, s[38:39] sc1
    s_mov_b64 exec, -1
    s_endpgm
A_SLOW:
    s_waitcnt vmcnt(0)
    s_mov_b32 s30, 1
    v_mov_b32 v162, 0xff800000
    v_mov_b32 v163, 0xff800000
    s_mov_b32 s28, s36
    s_mov_b32 s29, 0
A_SLOW_C:
    s_barrier
    s_mov_b32 s27, 0
    s_add_u32 m0, s27, s33
    s_add_u32 s31, s28, 8192
    buffer_load_dwordx4 v1, s[8:11], s28 offen lds
    buffer_load_dwordx4 v1, s[8:11], s28 offen offset:1024 lds
    s_add_u32 m0, m0, 9216
    s_add_u32 s28, s28, 16384
    buffer_load_dwordx4 v1, s[8:11], s31 offen lds
    buffer_load_dwordx4 v1, s[8:11], s31 offen offset:1024 lds
    s_waitcnt vmcnt(0)
    s_barrier
    v_mov_b32 v4, v1
    s_mov_b32 s32, 0
A_SLOW_T:
    ds_read_b128 v[18:21], v4
    s_waitcnt lgkmcnt(0)
    v_mfma_f32_32x32x16_bf16 v[62:77], v[18:21], v[10:13], 0
    v_mfma_f32_32x32x16_bf16 v[78:93], v[18:21], v[14:17], 0
    v_add_u32 v4, 2304, v4
    s_nop 11
    v_max3_f32 v162, v62, v63, v162
    v_max3_f32 v162, v64, v65, v162
    v_max3_f32 v162, v66, v67, v162
    v_max3_f32 v162, v68, v69, v162
    v_max3_f32 v162, v70, v71, v162
    v_max3_f32 v162, v72, v73, v162
    v_max3_f32 v162, v74, v75, v162
    v_max3_f32 v162, v76, v77, v162
    v_max3_f32 v163, v78, v79, v163
    v_max3_f32 v163, v80, v81, v163
    v_max3_f32 v163, v82, v83, v163
    v_max3_f32 v163, v84, v85, v163
    v_max3_f32 v163, v86, v87, v163
    v_max3_f32 v163, v88, v89, v163
    v_max3_f32 v163, v90, v91, v163
    v_max3_f32 v163, v92, v93, v163
    s_add_u32 s32, s32, 1
    s_cmp_lt_u32 s32, 8
    s_cbranch_scc1 A_SLOW_T
    s_add_u32 s29, s29, 1
    s_cmp_lt_u32 s29, 8
    s_cbranch_scc1 A_SLOW_C
    v_mov_b32 v164, v162
    s_nop 1
    v_permlane32_swap_b32 v164, v162
    v_max_f32 v162, v162, v164
    v_sub_f32 v126, 0, v162
    v_sub_f32 v127, 0, v162
    v_sub_f32 v128, 0, v162
    v_sub_f32 v129, 0, v162
    v_sub_f32 v130, 0, v162
    v_sub_f32 v131, 0, v162
    v_sub_f32 v132, 0, v162
    v_sub_f32 v133, 0, v162
    v_sub_f32 v134, 0, v162
    v_sub_f32 v135, 0, v162
    v_sub_f32 v136, 0, v162
    v_sub_f32 v137, 0, v162
    v_sub_f32 v138, 0, v162
    v_sub_f32 v139, 0, v162
    v_sub_f32 v140, 0, v162
    v_sub_f32 v141, 0, v162
    v_mov_b32 v164, v163
    s_nop 1
    v_permlane32_swap_b32 v164, v163
    v_max_f32 v163, v163, v164
    v_sub_f32 v142, 0, v163
    v_sub_f32 v143, 0, v163
    v_sub_f32 v144, 0, v163
    v_sub_f32 v145, 0, v163
    v_sub_f32 v146, 0, v163
    v_sub_f32 v147, 0, v163
    v_sub_f32 v148, 0, v163
    v_sub_f32 v149, 0, v163
    v_sub_f32 v150, 0, v163
    v_sub_f32 v151, 0, v163
    v_sub_f32 v152, 0, v163
    v_sub_f32 v153, 0, v163
    v_sub_f32 v154, 0, v163
    v_sub_f32 v155, 0, v163
    v_sub_f32 v156, 0, v163
    v_sub_f32 v157, 0, v163
    s_barrier
    s_mov_b32 s28, s36
    s_mov_b32 s27, 0
    s_add_u32 m0, s27, s33
    s_add_u32 s31, s28, 8192
    buffer_load_dwordx4 v1, s[8:11], s28 offen lds
    buffer_load_dwordx4 v1, s[8:11], s28 offen offset:1024 lds
    s_add_u32 m0, m0, 9216
    s_add_u32 s28, s28, 16384
    buffer_load_dwordx4 v1, s[8:11], s31 offen lds
    buffer_load_dwordx4 v1, s[8:11], s31 offen offset:1024 lds
    s_mov_b32 s27, 18432
    s_add_u32 m0, s27, s33
    s_add_u32 s31, s28, 8192
    buffer_load_dwordx4 v1, s[8:11], s28 offen lds
    buffer_load_dwordx4 v1, s[8:11], s28 offen offset:1024 lds
    s_add_u32 m0, m0, 9216
    s_add_u32 s28, s28, 16384
    buffer_load_dwordx4 v1, s[8:11], s31 offen lds
    buffer_load_dwordx4 v1, s[8:11], s31 offen offset:1024 lds
    s_branch A_PASS
K2_B:
    s_sub_u32 s2, s2, 256
    s_setprio 2
    s_load_dwordx2 s[28:29], s[0:1], 88
    s_load_dwordx2 s[40:41], s[0:1], 0
    s_load_dwordx2 s[42:43], s[0:1], 72
    s_load_dwordx2 s[56:57], s[0:1], 16
    s_load_dwordx4 s[60:63], s[0:1], 48
    v_lshrrev_b32 v1, 6, v0
    v_and_b32 v0, 63, v0
    s_and_b32 s35, s2, 7
    v_readfirstlane_b32 s32, v1
    s_lshl_b32 s35, s35, 2
    s_bfe_u32 s36, s2, 0x20006
    s_add_u32 s30, s35, s36
    s_bfe_u32 s31, s2, 0x30003
    v_lshlrev_b32 v1, 4, v0
    v_and_b32 v2, 31, v0
    v_lshrrev_b32 v3, 5, v0
    s_lshr_b32 s33, s32, 1
    s_and_b32 s34, s32, 1
    s_mul_i32 s47, s31, 6
    s_mul_i32 s35, s31, 5
    s_add_u32 s35, s35, 3
    s_cmp_lt_u32 s31, 3
    s_cselect_b32 s47, s47, s35
    s_cselect_b32 s46, 6, 5
    s_lshl_b32 s35, s30, 1
    s_add_u32 s35, s35, s33
    s_lshl_b32 s35, s35, 5
    v_add_u32 v237, s35, v2
    s_waitcnt lgkmcnt(0)
    s_add_u32 s12, s28, 0x1200000
    s_addc_u32 s13, s29, 0
    s_mov_b32 s14, 0x3b0000
    s_mov_b32 s15, 0x20000
    s_add_u32 s8, s28, 0x600000
    s_addc_u32 s9, s29, 0
    s_mov_b32 s10, 0x200000
    s_mov_b32 s11, 0x20000
    s_mov_b32 s20, s40
    s_mov_b32 s21, s41
    s_mov_b32 s22, 0x200000
    s_mov_b32 s23, 0x20000
    s_lshl_b32 s35, s31, 6
    s_lshl_b32 s36, s32, 3
    s_add_u32 s35, s35, s36
    s_add_u32 s35, s35, 0
    s_lshl_b32 s49, s35, 10
    s_add_u32 s50, s49, 32768
    s_lshl_b32 s35, s30, 6
    s_add_u32 s35, s35, s36
    s_lshl_b32 s54, s35, 10
    s_add_u32 s55, s54, 32768
    s_lshl_b32 s35, s31, 7
    s_lshl_b32 s36, s34, 6
    s_add_u32 s35, s35, s36
    v_lshlrev_b32 v236, 10, v237
    v_lshl_add_u32 v236, v3, 3, v236
    s_setprio 0
    buffer_load_dwordx4 v[72:75], v1, s[8:11], s54 offen offset:0
    buffer_load_dwordx4 v[76:79], v1, s[8:11], s55 offen offset:0
    buffer_load_dwordx4 v[136:139], v1, s[12:15], s49 offen offset:0
    buffer_load_dwordx4 v[140:143], v1, s[12:15], s50 offen offset:0
    buffer_load_dwordx4 v[80:83], v1, s[8:11], s54 offen offset:1024
    buffer_load_dwordx4 v[84:87], v1, s[8:11], s55 offen offset:1024
    buffer_load_dwordx4 v[144:147], v1, s[12:15], s49 offen offset:1024
    buffer_load_dwordx4 v[148:151], v1, s[12:15], s50 offen offset:1024
    buffer_load_dwordx4 v[88:91], v1, s[8:11], s54 offen offset:2048
    buffer_load_dwordx4 v[92:95], v1, s[8:11], s55 offen offset:2048
    buffer_load_dwordx4 v[152:155], v1, s[12:15], s49 offen offset:2048
    buffer_load_dwordx4 v[156:159], v1, s[12:15], s50 offen offset:2048
    buffer_load_dwordx4 v[96:99], v1, s[8:11], s54 offen offset:3072
    buffer_load_dwordx4 v[100:103], v1, s[8:11], s55 offen offset:3072
    buffer_load_dwordx4 v[160:163], v1, s[12:15], s49 offen offset:3072
    buffer_load_dwordx4 v[164:167], v1, s[12:15], s50 offen offset:3072
    s_add_u32 s49, s49, 4096
    s_add_u32 s50, s50, 4096
    s_add_u32 s54, s54, 4096
    s_add_u32 s55, s55, 4096
    buffer_load_dwordx4 v[104:107], v1, s[8:11], s54 offen offset:0
    buffer_load_dwordx4 v[108:111], v1, s[8:11], s55 offen offset:0
    buffer_load_dwordx4 v[168:171], v1, s[12:15], s49 offen offset:0
    buffer_load_dwordx4 v[172:175], v1, s[12:15], s50 offen offset:0
    buffer_load_dwordx4 v[112:115], v1, s[8:11], s54 offen offset:1024
    buffer_load_dwordx4 v[116:119], v1, s[8:11], s55 offen offset:1024
    buffer_load_dwordx4 v[176:179], v1, s[12:15], s49 offen offset:1024
    buffer_load_dwordx4 v[180:183], v1, s[12:15], s50 offen offset:1024
    buffer_load_dwordx4 v[120:123], v1, s[8:11], s54 offen offset:2048
    buffer_load_dwordx4 v[124:127], v1, s[8:11], s55 offen offset:2048
    buffer_load_dwordx4 v[184:187], v1, s[12:15], s49 offen offset:2048
    buffer_load_dwordx4 v[188:191], v1, s[12:15], s50 offen offset:2048
    buffer_load_dwordx4 v[128:131], v1, s[8:11], s54 offen offset:3072
    buffer_load_dwordx4 v[132:135], v1, s[8:11], s55 offen offset:3072
    buffer_load_dwordx4 v[192:195], v1, s[12:15], s49 offen offset:3072
    buffer_load_dwordx4 v[196:199], v1, s[12:15], s50 offen offset:3072
    buffer_load_dwordx2 v[232:233], v236, s[20:23], s35 offen offset:0
    buffer_load_dwordx2 v[234:235], v236, s[20:23], s35 offen offset:16
    buffer_load_dwordx2 v[4:5], v236, s[20:23], s35 offen offset:32
    buffer_load_dwordx2 v[6:7], v236, s[20:23], s35 offen offset:48
    s_setprio 0
    s_waitcnt vmcnt(32)
    v_mfma_f32_32x32x16_bf16 v[8:23], v[136:139], v[72:75], 0
    v_mfma_f32_32x32x16_bf16 v[24:39], v[140:143], v[72:75], 0
    v_mfma_f32_32x32x16_bf16 v[40:55], v[136:139], v[76:79], 0
    v_mfma_f32_32x32x16_bf16 v[56:71], v[140:143], v[76:79], 0
    s_waitcnt vmcnt(28)
    v_mfma_f32_32x32x16_bf16 v[8:23], v[144:147], v[80:83], v[8:23]
    v_mfma_f32_32x32x16_bf16 v[24:39], v[148:151], v[80:83], v[24:39]
    v_mfma_f32_32x32x16_bf16 v[40:55], v[144:147], v[84:87], v[40:55]
    v_mfma_f32_32x32x16_bf16 v[56:71], v[148:151], v[84:87], v[56:71]
    s_waitcnt vmcnt(24)
    v_mfma_f32_32x32x16_bf16 v[8:23], v[152:155], v[88:91], v[8:23]
    v_mfma_f32_32x32x16_bf16 v[24:39], v[156:159], v[88:91], v[24:39]
    v_mfma_f32_32x32x16_bf16 v[40:55], v[152:155], v[92:95], v[40:55]
    v_mfma_f32_32x32x16_bf16 v[56:71], v[156:159], v[92:95], v[56:71]
    s_waitcnt vmcnt(20)
    v_mfma_f32_32x32x16_bf16 v[8:23], v[160:163], v[96:99], v[8:23]
    v_mfma_f32_32x32x16_bf16 v[24:39], v[164:167], v[96:99], v[24:39]
    v_mfma_f32_32x32x16_bf16 v[40:55], v[160:163], v[100:103], v[40:55]
    v_mfma_f32_32x32x16_bf16 v[56:71], v[164:167], v[100:103], v[56:71]
    s_waitcnt vmcnt(16)
    v_mfma_f32_32x32x16_bf16 v[8:23], v[168:171], v[104:107], v[8:23]
    v_mfma_f32_32x32x16_bf16 v[24:39], v[172:175], v[104:107], v[24:39]
    v_mfma_f32_32x32x16_bf16 v[40:55], v[168:171], v[108:111], v[40:55]
    v_mfma_f32_32x32x16_bf16 v[56:71], v[172:175], v[108:111], v[56:71]
    s_waitcnt vmcnt(12)
    v_mfma_f32_32x32x16_bf16 v[8:23], v[176:179], v[112:115], v[8:23]
    v_mfma_f32_32x32x16_bf16 v[24:39], v[180:183], v[112:115], v[24:39]
    v_mfma_f32_32x32x16_bf16 v[40:55], v[176:179], v[116:119], v[40:55]
    v_mfma_f32_32x32x16_bf16 v[56:71], v[180:183], v[116:119], v[56:71]
    s_waitcnt vmcnt(8)
    v_mfma_f32_32x32x16_bf16 v[8:23], v[184:187], v[120:123], v[8:23]
    v_mfma_f32_32x32x16_bf16 v[24:39], v[188:191], v[120:123], v[24:39]
    v_mfma_f32_32x32x16_bf16 v[40:55], v[184:187], v[124:127], v[40:55]
    v_mfma_f32_32x32x16_bf16 v[56:71], v[188:191], v[124:127], v[56:71]
    s_waitcnt vmcnt(4)
    v_mfma_f32_32x32x16_bf16 v[8:23], v[192:195], v[128:131], v[8:23]
    v_mfma_f32_32x32x16_bf16 v[24:39], v[196:199], v[128:131], v[24:39]
    v_mfma_f32_32x32x16_bf16 v[40:55], v[192:195], v[132:135], v[40:55]
    v_mfma_f32_32x32x16_bf16 v[56:71], v[196:199], v[132:135], v[56:71]
    s_setprio 2
    s_nop 7
    s_lshl_b32 s35, s32, 12
    v_add_u32 v236, s35, v1
    ds_write_b128 v236, v[8:11] offset:0
    ds_write_b128 v236, v[12:15] offset:1024
    ds_write_b128 v236, v[16:19] offset:2048
    ds_write_b128 v236, v[20:23] offset:3072
    ds_write_b128 v236, v[24:27] offset:16384
    ds_write_b128 v236, v[28:31] offset:17408
    ds_write_b128 v236, v[32:35] offset:18432
    ds_write_b128 v236, v[36:39] offset:19456
    ds_write_b128 v236, v[40:43] offset:32768
    ds_write_b128 v236, v[44:47] offset:33792
    ds_write_b128 v236, v[48:51] offset:34816
    ds_write_b128 v236, v[52:55] offset:35840
    ds_write_b128 v236, v[56:59] offset:49152
    ds_write_b128 v236, v[60:63] offset:50176
    ds_write_b128 v236, v[64:67] offset:51200
    ds_write_b128 v236, v[68:71] offset:52224
    s_lshl_b32 s35, s32, 14
    v_add_u32 v236, s35, v1
    s_waitcnt lgkmcnt(0)
    s_barrier
    ds_read_b128 v[8:11], v236 offset:0
    ds_read_b128 v[12:15], v236 offset:1024
    ds_read_b128 v[16:19], v236 offset:2048
    ds_read_b128 v[20:23], v236 offset:3072
    ds_read_b128 v[24:27], v236 offset:4096
    ds_read_b128 v[28:31], v236 offset:5120
    ds_read_b128 v[32:35], v236 offset:6144
    ds_read_b128 v[36:39], v236 offset:7168
    ds_read_b128 v[40:43], v236 offset:8192
    ds_read_b128 v[44:47], v236 offset:9216
    ds_read_b128 v[48:51], v236 offset:10240
    ds_read_b128 v[52:55], v236 offset:11264
    ds_read_b128 v[56:59], v236 offset:12288
    ds_read_b128 v[60:63], v236 offset:13312
    ds_read_b128 v[64:67], v236 offset:14336
    ds_read_b128 v[68:71], v236 offset:15360
    s_waitcnt lgkmcnt(8)
    v_pk_add_f32 v[8:9], v[8:9], v[24:25]
    v_pk_add_f32 v[10:11], v[10:11], v[26:27]
    v_pk_add_f32 v[12:13], v[12:13], v[28:29]
    v_pk_add_f32 v[14:15], v[14:15], v[30:31]
    v_pk_add_f32 v[16:17], v[16:17], v[32:33]
    v_pk_add_f32 v[18:19], v[18:19], v[34:35]
    v_pk_add_f32 v[20:21], v[20:21], v[36:37]
    v_pk_add_f32 v[22:23], v[22:23], v[38:39]
    s_waitcnt lgkmcnt(0)
    v_pk_add_f32 v[40:41], v[40:41], v[56:57]
    v_pk_add_f32 v[42:43], v[42:43], v[58:59]
    v_pk_add_f32 v[44:45], v[44:45], v[60:61]
    v_pk_add_f32 v[46:47], v[46:47], v[62:63]
    v_pk_add_f32 v[48:49], v[48:49], v[64:65]
    v_pk_add_f32 v[50:51], v[50:51], v[66:67]
    v_pk_add_f32 v[52:53], v[52:53], v[68:69]
    v_pk_add_f32 v[54:55], v[54:55], v[70:71]
    v_pk_add_f32 v[8:9], v[8:9], v[40:41]
    v_pk_add_f32 v[10:11], v[10:11], v[42:43]
    v_pk_add_f32 v[12:13], v[12:13], v[44:45]
    v_pk_add_f32 v[14:15], v[14:15], v[46:47]
    v_pk_add_f32 v[16:17], v[16:17], v[48:49]
    v_pk_add_f32 v[18:19], v[18:19], v[50:51]
    v_pk_add_f32 v[20:21], v[20:21], v[52:53]
    v_pk_add_f32 v[22:23], v[22:23], v[54:55]
    s_waitcnt vmcnt(0)
    v_lshlrev_b32 v72, 16, v232
    v_and_b32 v73, 0xffff0000, v232
    v_lshlrev_b32 v74, 16, v233
    v_and_b32 v75, 0xffff0000, v233
    v_lshlrev_b32 v76, 16, v234
    v_and_b32 v77, 0xffff0000, v234
    v_lshlrev_b32 v78, 16, v235
    v_and_b32 v79, 0xffff0000, v235
    v_lshlrev_b32 v80, 16, v4
    v_and_b32 v81, 0xffff0000, v4
    v_lshlrev_b32 v82, 16, v5
    v_and_b32 v83, 0xffff0000, v5
    v_lshlrev_b32 v84, 16, v6
    v_and_b32 v85, 0xffff0000, v6
    v_lshlrev_b32 v86, 16, v7
    v_and_b32 v87, 0xffff0000, v7
    v_pk_add_f32 v[240:241], v[8:9], v[72:73]
    v_pk_add_f32 v[242:243], v[10:11], v[74:75]
    v_pk_add_f32 v[244:245], v[12:13], v[76:77]
    v_pk_add_f32 v[246:247], v[14:15], v[78:79]
    v_pk_add_f32 v[248:249], v[16:17], v[80:81]
    v_pk_add_f32 v[250:251], v[18:19], v[82:83]
    v_pk_add_f32 v[252:253], v[20:21], v[84:85]
    v_pk_add_f32 v[254:255], v[22:23], v[86:87]
    v_add_f32 v4, v240, v241
    v_mul_f32 v5, v240, v240
    v_fmac_f32 v5, v241, v241
    v_add_f32 v4, v4, v242
    v_fmac_f32 v5, v242, v242
    v_add_f32 v4, v4, v243
    v_fmac_f32 v5, v243, v243
    v_add_f32 v4, v4, v244
    v_fmac_f32 v5, v244, v244
    v_add_f32 v4, v4, v245
    v_fmac_f32 v5, v245, v245
    v_add_f32 v4, v4, v246
    v_fmac_f32 v5, v246, v246
    v_add_f32 v4, v4, v247
    v_fmac_f32 v5, v247, v247
    v_add_f32 v4, v4, v248
    v_fmac_f32 v5, v248, v248
    v_add_f32 v4, v4, v249
    v_fmac_f32 v5, v249, v249
    v_add_f32 v4, v4, v250
    v_fmac_f32 v5, v250, v250
    v_add_f32 v4, v4, v251
    v_fmac_f32 v5, v251, v251
    v_add_f32 v4, v4, v252
    v_fmac_f32 v5, v252, v252
    v_add_f32 v4, v4, v253
    v_fmac_f32 v5, v253, v253
    v_add_f32 v4, v4, v254
    v_fmac_f32 v5, v254, v254
    v_add_f32 v4, v4, v255
    v_fmac_f32 v5, v255, v255
    v_mov_b32 v6, v4
    s_nop 1
    v_permlane32_swap_b32 v6, v4
    v_add_f32 v4, v4, v6
    v_mov_b32 v6, v5
    s_nop 1
    v_permlane32_swap_b32 v6, v5
    v_add_f32 v5, v5, v6
    s_add_u32 s16, s28, 0x800000
    s_addc_u32 s17, s29, 0
    s_mov_b32 s18, 0x200000
    s_mov_b32 s19, 0x20000
    s_add_u32 s24, s28, 0x1c10000
    s_addc_u32 s25, s29, 0
    s_mov_b32 s26, 0x40000
    s_mov_b32 s27, 0x20000
    s_lshl_b32 s35, s30, 1
    s_add_u32 s35, s35, s33
    s_lshl_b32 s35, s35, 5
    s_lshl_b32 s36, s31, 2
    s_add_u32 s35, s35, s36
    s_lshl_b32 s36, s34, 1
    s_add_u32 s35, s35, s36
    s_lshl_b32 s35, s35, 10
    s_lshl_b32 s37, s31, 4
    s_lshl_b32 s36, s34, 3
    s_add_u32 s37, s37, s36
    v_lshlrev_b32 v7, 7, v237
    v_cvt_pk_bf16_f32 v72, v240, v241
    v_cvt_pk_bf16_f32 v73, v242, v243
    v_cvt_pk_bf16_f32 v74, v244, v245
    v_cvt_pk_bf16_f32 v75, v246, v247
    buffer_store_dwordx4 v[72:75], v1, s[16:19], s35 offen offset:0 sc1
    v_cvt_pk_bf16_f32 v76, v248, v249
    v_cvt_pk_bf16_f32 v77, v250, v251
    v_cvt_pk_bf16_f32 v78, v252, v253
    v_cvt_pk_bf16_f32 v79, v254, v255
    buffer_store_dwordx4 v[76:79], v1, s[16:19], s35 offen offset:1024 sc1
    s_mov_b32 exec_hi, 0
    buffer_store_dwordx2 v[4:5], v7, s[24:27], s37 offen sc1
    s_mov_b64 exec, -1
    s_waitcnt vmcnt(0)
    s_barrier
    s_cmp_lg_u32 s32, 0
    s_cbranch_scc1 SIG_3
    s_add_u32 s52, s28, 0x1d00000
    s_addc_u32 s53, s29, 0
    s_lshl_b32 vcc_lo, s30, 7
    v_mov_b32 v6, vcc_lo
    v_mov_b32 v7, 1
    s_mov_b64 exec, 1
    global_atomic_add v6, v7, s[52:53] sc1
    s_mov_b64 exec, -1
SIG_3:
    s_add_u32 s35, s47, s32
    s_lshl_b32 s35, s35, 5
    s_add_u32 s35, s35, 512
    s_lshl_b32 s49, s35, 10
    s_add_u32 s36, s33, 4
    s_sub_u32 s37, s46, 1
    s_min_u32 s36, s36, s37
    s_add_u32 s36, s36, s47
    s_lshl_b32 s38, s36, 7
    s_lshl_b32 s36, s36, 5
    s_add_u32 s36, s36, 512
    s_lshl_b32 s50, s36, 10
    s_setprio 0
    buffer_load_dwordx4 v[80:83], v1, s[12:15], s49 offen offset:0
    buffer_load_dwordx4 v[84:87], v1, s[12:15], s50 offen offset:0
    buffer_load_dwordx4 v[88:91], v1, s[12:15], s49 offen offset:1024
    buffer_load_dwordx4 v[92:95], v1, s[12:15], s50 offen offset:1024
    buffer_load_dwordx4 v[96:99], v1, s[12:15], s49 offen offset:2048
    buffer_load_dwordx4 v[100:103], v1, s[12:15], s50 offen offset:2048
    buffer_load_dwordx4 v[104:107], v1, s[12:15], s49 offen offset:3072
    buffer_load_dwordx4 v[108:111], v1, s[12:15], s50 offen offset:3072
    s_add_u32 s49, s49, 4096
    s_add_u32 s50, s50, 4096
    buffer_load_dwordx4 v[112:115], v1, s[12:15], s49 offen offset:0
    buffer_load_dwordx4 v[116:119], v1, s[12:15], s50 offen offset:0
    buffer_load_dwordx4 v[120:123], v1, s[12:15], s49 offen offset:1024
    buffer_load_dwordx4 v[124:127], v1, s[12:15], s50 offen offset:1024
    buffer_load_dwordx4 v[128:131], v1, s[12:15], s49 offen offset:2048
    buffer_load_dwordx4 v[132:135], v1, s[12:15], s50 offen offset:2048
    buffer_load_dwordx4 v[136:139], v1, s[12:15], s49 offen offset:3072
    buffer_load_dwordx4 v[140:143], v1, s[12:15], s50 offen offset:3072
    s_setprio 2
    s_add_u32 s24, s28, 0x1c50000
    s_addc_u32 s25, s29, 0
    s_mov_b32 s26, 0x1580
    s_mov_b32 s27, 0x20000
    s_add_u32 s35, s47, s32
    s_lshl_b32 s35, s35, 7
    v_lshlrev_b32 v4, 4, v3
    buffer_load_dwordx4 v[144:147], v4, s[24:27], s35 offen offset:0
    buffer_load_dwordx4 v[148:151], v4, s[24:27], s35 offen offset:32
    buffer_load_dwordx4 v[152:155], v4, s[24:27], s35 offen offset:64
    buffer_load_dwordx4 v[156:159], v4, s[24:27], s35 offen offset:96
    buffer_load_dwordx4 v[160:163], v4, s[24:27], s38 offen offset:0
    buffer_load_dwordx4 v[164:167], v4, s[24:27], s38 offen offset:32
    buffer_load_dwordx4 v[168:171], v4, s[24:27], s38 offen offset:64
    buffer_load_dwordx4 v[172:175], v4, s[24:27], s38 offen offset:96
    s_lshl_b32 s35, s34, 15
    v_add_u32 v214, s35, v1
    v_xor_b32 v215, 0x8000, v214
    v_lshlrev_b32 v5, 7, v2
    v_lshl_add_u32 v5, v3, 6, v5
    s_add_u32 s8, s28, 0x800000
    s_addc_u32 s9, s29, 0
    s_mov_b32 s10, 0x200000
    s_mov_b32 s11, 0x20000
    s_add_u32 s20, s28, 0x1c10000
    s_addc_u32 s21, s29, 0
    s_mov_b32 s22, 0x40000
    s_mov_b32 s23, 0x20000
    s_cmp_lg_u32 s32, 0
    s_cbranch_scc1 WT_4_done
    s_add_u32 s52, s28, 0x1d00000
    s_addc_u32 s53, s29, 0
    s_lshl_b32 vcc_lo, s30, 7
    v_mov_b32 v6, vcc_lo
    s_mov_b32 vcc_hi, 0x40000
WT_4:
    global_load_dword v7, v6, s[52:53] sc1
    s_waitcnt vmcnt(0)
    v_readfirstlane_b32 vcc_lo, v7
    s_cmp_ge_u32 vcc_lo, 8
    s_cbranch_scc1 WT_4_done
    s_sub_u32 vcc_hi, vcc_hi, 1
    s_cmp_eq_u32 vcc_hi, 0
    s_cbranch_scc1 WT_4_done
    s_sleep 0
    s_branch WT_4
WT_4_done:
    s_barrier
    s_setprio 0
    s_lshl_b32 s35, s30, 16
    s_lshl_b32 s36, s32, 10
    s_add_u32 s35, s35, s36
    s_add_u32 m0, s36, 0
    s_add_u32 s37, s35, 0
    buffer_load_dwordx4 v1, s[8:11], s37 offen sc1 lds
    s_add_u32 m0, s36, 4096
    s_add_u32 s37, s35, 4096
    buffer_load_dwordx4 v1, s[8:11], s37 offen sc1 lds
    s_add_u32 m0, s36, 8192
    s_add_u32 s37, s35, 8192
    buffer_load_dwordx4 v1, s[8:11], s37 offen sc1 lds
    s_add_u32 m0, s36, 12288
    s_add_u32 s37, s35, 12288
    buffer_load_dwordx4 v1, s[8:11], s37 offen sc1 lds
    s_add_u32 m0, s36, 16384
    s_add_u32 s37, s35, 16384
    buffer_load_dwordx4 v1, s[8:11], s37 offen sc1 lds
    s_add_u32 m0, s36, 20480
    s_add_u32 s37, s35, 20480
    buffer_load_dwordx4 v1, s[8:11], s37 offen sc1 lds
    s_add_u32 m0, s36, 24576
    s_add_u32 s37, s35, 24576
    buffer_load_dwordx4 v1, s[8:11], s37 offen sc1 lds
    s_add_u32 m0, s36, 28672
    s_add_u32 s37, s35, 28672
    buffer_load_dwordx4 v1, s[8:11], s37 offen sc1 lds
    s_add_u32 m0, s36, 32768
    s_add_u32 s37, s35, 32768
    buffer_load_dwordx4 v1, s[8:11], s37 offen sc1 lds
    s_add_u32 m0, s36, 36864
    s_add_u32 s37, s35, 36864
    buffer_load_dwordx4 v1, s[8:11], s37 offen sc1 lds
    s_add_u32 m0, s36, 40960
    s_add_u32 s37, s35, 40960
    buffer_load_dwordx4 v1, s[8:11], s37 offen sc1 lds
    s_add_u32 m0, s36, 45056
    s_add_u32 s37, s35, 45056
    buffer_load_dwordx4 v1, s[8:11], s37 offen sc1 lds
    s_add_u32 m0, s36, 49152
    s_add_u32 s37, s35, 49152
    buffer_load_dwordx4 v1, s[8:11], s37 offen sc1 lds
    s_add_u32 m0, s36, 53248
    s_add_u32 s37, s35, 53248
    buffer_load_dwordx4 v1, s[8:11], s37 offen sc1 lds
    s_add_u32 m0, s36, 57344
    s_add_u32 s37, s35, 57344
    buffer_load_dwordx4 v1, s[8:11], s37 offen sc1 lds
    s_add_u32 m0, s36, 61440
    s_add_u32 s37, s35, 61440
    buffer_load_dwordx4 v1, s[8:11], s37 offen sc1 lds
    s_lshl_b32 s35, s30, 13
    s_lshl_b32 s36, s34, 12
    s_add_u32 s36, s36, s35
    s_xor_b32 s37, s36, 0x1000
    buffer_load_dwordx4 v[176:179], v5, s[20:23], s36 offen offset:0 sc1
    buffer_load_dwordx4 v[180:183], v5, s[20:23], s36 offen offset:16 sc1
    buffer_load_dwordx4 v[184:187], v5, s[20:23], s36 offen offset:32 sc1
    buffer_load_dwordx4 v[188:191], v5, s[20:23], s36 offen offset:48 sc1
    buffer_load_dwordx4 v[192:195], v5, s[20:23], s37 offen offset:0 sc1
    buffer_load_dwordx4 v[196:199], v5, s[20:23], s37 offen offset:16 sc1
    buffer_load_dwordx4 v[200:203], v5, s[20:23], s37 offen offset:32 sc1
    buffer_load_dwordx4 v[204:207], v5, s[20:23], s37 offen offset:48 sc1
    s_waitcnt vmcnt(8)
    s_barrier
    s_setprio 0
    s_add_u32 s35, s33, 4
    s_cmp_ge_u32 s35, s46
    s_cbranch_scc1 B_W3TWO_5
    ds_read_b128 v[56:59], v214 offset:0
    ds_read_b128 v[60:63], v215 offset:0
    ds_read_b128 v[64:67], v214 offset:1024
    ds_read_b128 v[68:71], v215 offset:1024
    s_waitcnt lgkmcnt(2)
    v_mfma_f32_32x32x16_bf16 v[8:23], v[80:83], v[56:59], 0
    ds_read_b128 v[72:75], v214 offset:2048
    ds_read_b128 v[76:79], v215 offset:2048
    v_mfma_f32_32x32x16_bf16 v[24:39], v[80:83], v[60:63], 0
    v_mfma_f32_32x32x16_bf16 v[40:55], v[84:87], v[56:59], 0
    s_add_u32 s49, s49, 4096
    s_add_u32 s50, s50, 4096
    buffer_load_dwordx4 v[80:83], v1, s[12:15], s49 offen offset:0
    buffer_load_dwordx4 v[84:87], v1, s[12:15], s50 offen offset:0
    s_waitcnt lgkmcnt(2)
    v_mfma_f32_32x32x16_bf16 v[8:23], v[88:91], v[64:67], v[8:23]
    ds_read_b128 v[56:59], v214 offset:3072
    ds_read_b128 v[60:63], v215 offset:3072
    v_mfma_f32_32x32x16_bf16 v[24:39], v[88:91], v[68:71], v[24:39]
    v_mfma_f32_32x32x16_bf16 v[40:55], v[92:95], v[64:67], v[40:55]
    buffer_load_dwordx4 v[88:91], v1, s[12:15], s49 offen offset:1024
    buffer_load_dwordx4 v[92:95], v1, s[12:15], s50 offen offset:1024
    s_waitcnt lgkmcnt(2)
    v_mfma_f32_32x32x16_bf16 v[8:23], v[96:99], v[72:75], v[8:23]
    ds_read_b128 v[64:67], v214 offset:4096
    ds_read_b128 v[68:71], v215 offset:4096
    v_mfma_f32_32x32x16_bf16 v[24:39], v[96:99], v[76:79], v[24:39]
    v_mfma_f32_32x32x16_bf16 v[40:55], v[100:103], v[72:75], v[40:55]
    buffer_load_dwordx4 v[96:99], v1, s[12:15], s49 offen offset:2048
    buffer_load_dwordx4 v[100:103], v1, s[12:15], s50 offen offset:2048
    s_waitcnt lgkmcnt(2)
    v_mfma_f32_32x32x16_bf16 v[8:23], v[104:107], v[56:59], v[8:23]
    ds_read_b128 v[72:75], v214 offset:5120
    ds_read_b128 v[76:79], v215 offset:5120
    v_mfma_f32_32x32x16_bf16 v[24:39], v[104:107], v[60:63], v[24:39]
    v_mfma_f32_32x32x16_bf16 v[40:55], v[108:111], v[56:59], v[40:55]
    buffer_load_dwordx4 v[104:107], v1, s[12:15], s49 offen offset:3072
    buffer_load_dwordx4 v[108:111], v1, s[12:15], s50 offen offset:3072
    s_waitcnt lgkmcnt(2)
    v_mfma_f32_32x32x16_bf16 v[8:23], v[112:115], v[64:67], v[8:23]
    ds_read_b128 v[56:59], v214 offset:6144
    ds_read_b128 v[60:63], v215 offset:6144
    v_mfma_f32_32x32x16_bf16 v[24:39], v[112:115], v[68:71], v[24:39]
    v_mfma_f32_32x32x16_bf16 v[40:55], v[116:119], v[64:67], v[40:55]
    s_add_u32 s49, s49, 4096
    s_add_u32 s50, s50, 4096
    buffer_load_dwordx4 v[112:115], v1, s[12:15], s49 offen offset:0
    buffer_load_dwordx4 v[116:119], v1, s[12:15], s50 offen offset:0
    s_waitcnt lgkmcnt(2)
    v_mfma_f32_32x32x16_bf16 v[8:23], v[120:123], v[72:75], v[8:23]
    ds_read_b128 v[64:67], v214 offset:7168
    ds_read_b128 v[68:71], v215 offset:7168
    v_mfma_f32_32x32x16_bf16 v[24:39], v[120:123], v[76:79], v[24:39]
    v_mfma_f32_32x32x16_bf16 v[40:55], v[124:127], v[72:75], v[40:55]
    buffer_load_dwordx4 v[120:123], v1, s[12:15], s49 offen offset:1024
    buffer_load_dwordx4 v[124:127], v1, s[12:15], s50 offen offset:1024
    s_waitcnt lgkmcnt(2)
    v_mfma_f32_32x32x16_bf16 v[8:23], v[128:131], v[56:59], v[8:23]
    ds_read_b128 v[72:75], v214 offset:8192
    ds_read_b128 v[76:79], v215 offset:8192
    v_mfma_f32_32x32x16_bf16 v[24:39], v[128:131], v[60:63], v[24:39]
    v_mfma_f32_32x32x16_bf16 v[40:55], v[132:135], v[56:59], v[40:55]
    buffer_load_dwordx4 v[128:131], v1, s[12:15], s49 offen offset:2048
    buffer_load_dwordx4 v[132:135], v1, s[12:15], s50 offen offset:2048
    s_waitcnt lgkmcnt(2)
    v_mfma_f32_32x32x16_bf16 v[8:23], v[136:139], v[64:67], v[8:23]
    ds_read_b128 v[56:59], v214 offset:9216
    ds_read_b128 v[60:63], v215 offset:9216
    v_mfma_f32_32x32x16_bf16 v[24:39], v[136:139], v[68:71], v[24:39]
    v_mfma_f32_32x32x16_bf16 v[40:55], v[140:143], v[64:67], v[40:55]
    buffer_load_dwordx4 v[136:139], v1, s[12:15], s49 offen offset:3072
    buffer_load_dwordx4 v[140:143], v1, s[12:15], s50 offen offset:3072
    s_waitcnt vmcnt(14) lgkmcnt(2)
    v_mfma_f32_32x32x16_bf16 v[8:23], v[80:83], v[72:75], v[8:23]
    ds_read_b128 v[64:67], v214 offset:10240
    ds_read_b128 v[68:71], v215 offset:10240
    v_mfma_f32_32x32x16_bf16 v[24:39], v[80:83], v[76:79], v[24:39]
    v_mfma_f32_32x32x16_bf16 v[40:55], v[84:87], v[72:75], v[40:55]
    s_add_u32 s49, s49, 4096
    s_add_u32 s50, s50, 4096
    buffer_load_dwordx4 v[80:83], v1, s[12:15], s49 offen offset:0
    buffer_load_dwordx4 v[84:87], v1, s[12:15], s50 offen offset:0
    s_waitcnt vmcnt(14) lgkmcnt(2)
    v_mfma_f32_32x32x16_bf16 v[8:23], v[88:91], v[56:59], v[8:23]
    ds_read_b128 v[72:75], v214 offset:11264
    ds_read_b128 v[76:79], v215 offset:11264
    v_mfma_f32_32x32x16_bf16 v[24:39], v[88:91], v[60:63], v[24:39]
    v_mfma_f32_32x32x16_bf16 v[40:55], v[92:95], v[56:59], v[40:55]
    buffer_load_dwordx4 v[88:91], v1, s[12:15], s49 offen offset:1024
    buffer_load_dwordx4 v[92:95], v1, s[12:15], s50 offen offset:1024
    s_waitcnt vmcnt(14) lgkmcnt(2)
    v_mfma_f32_32x32x16_bf16 v[8:23], v[96:99], v[64:67], v[8:23]
    ds_read_b128 v[56:59], v214 offset:12288
    ds_read_b128 v[60:63], v215 offset:12288
    v_mfma_f32_32x32x16_bf16 v[24:39], v[96:99], v[68:71], v[24:39]
    v_mfma_f32_32x32x16_bf16 v[40:55], v[100:103], v[64:67], v[40:55]
    buffer_load_dwordx4 v[96:99], v1, s[12:15], s49 offen offset:2048
    buffer_load_dwordx4 v[100:103], v1, s[12:15], s50 offen offset:2048
    s_waitcnt vmcnt(14) lgkmcnt(2)
    v_mfma_f32_32x32x16_bf16 v[8:23], v[104:107], v[72:75], v[8:23]
    ds_read_b128 v[64:67], v214 offset:13312
    ds_read_b128 v[68:71], v215 offset:13312
    v_mfma_f32_32x32x16_bf16 v[24:39], v[104:107], v[76:79], v[24:39]
    v_mfma_f32_32x32x16_bf16 v[40:55], v[108:111], v[72:75], v[40:55]
    buffer_load_dwordx4 v[104:107], v1, s[12:15], s49 offen offset:3072
    buffer_load_dwordx4 v[108:111], v1, s[12:15], s50 offen offset:3072
    s_waitcnt vmcnt(14) lgkmcnt(2)
    v_mfma_f32_32x32x16_bf16 v[8:23], v[112:115], v[56:59], v[8:23]
    ds_read_b128 v[72:75], v214 offset:14336
    ds_read_b128 v[76:79], v215 offset:14336
    v_mfma_f32_32x32x16_bf16 v[24:39], v[112:115], v[60:63], v[24:39]
    v_mfma_f32_32x32x16_bf16 v[40:55], v[116:119], v[56:59], v[40:55]
    s_add_u32 s49, s49, 4096
    s_add_u32 s50, s50, 4096
    buffer_load_dwordx4 v[112:115], v1, s[12:15], s49 offen offset:0
    buffer_load_dwordx4 v[116:119], v1, s[12:15], s50 offen offset:0
    s_waitcnt vmcnt(14) lgkmcnt(2)
    v_mfma_f32_32x32x16_bf16 v[8:23], v[120:123], v[64:67], v[8:23]
    ds_read_b128 v[56:59], v214 offset:15360
    ds_read_b128 v[60:63], v215 offset:15360
    v_mfma_f32_32x32x16_bf16 v[24:39], v[120:123], v[68:71], v[24:39]
    v_mfma_f32_32x32x16_bf16 v[40:55], v[124:127], v[64:67], v[40:55]
    buffer_load_dwordx4 v[120:123], v1, s[12:15], s49 offen offset:1024
    buffer_load_dwordx4 v[124:127], v1, s[12:15], s50 offen offset:1024
    s_waitcnt vmcnt(14) lgkmcnt(2)
    v_mfma_f32_32x32x16_bf16 v[8:23], v[128:131], v[72:75], v[8:23]
    ds_read_b128 v[64:67], v214 offset:16384
    ds_read_b128 v[68:71], v215 offset:16384
    v_mfma_f32_32x32x16_bf16 v[24:39], v[128:131], v[76:79], v[24:39]
    v_mfma_f32_32x32x16_bf16 v[40:55], v[132:135], v[72:75], v[40:55]
    buffer_load_dwordx4 v[128:131], v1, s[12:15], s49 offen offset:2048
    buffer_load_dwordx4 v[132:135], v1, s[12:15], s50 offen offset:2048
    s_waitcnt vmcnt(14) lgkmcnt(2)
    v_mfma_f32_32x32x16_bf16 v[8:23], v[136:139], v[56:59], v[8:23]
    ds_read_b128 v[72:75], v214 offset:17408
    ds_read_b128 v[76:79], v215 offset:17408
    v_mfma_f32_32x32x16_bf16 v[24:39], v[136:139], v[60:63], v[24:39]
    v_mfma_f32_32x32x16_bf16 v[40:55], v[140:143], v[56:59], v[40:55]
    buffer_load_dwordx4 v[136:139], v1, s[12:15], s49 offen offset:3072
    buffer_load_dwordx4 v[140:143], v1, s[12:15], s50 offen offset:3072
    s_waitcnt vmcnt(14) lgkmcnt(2)
    v_mfma_f32_32x32x16_bf16 v[8:23], v[80:83], v[64:67], v[8:23]
    ds_read_b128 v[56:59], v214 offset:18432
    ds_read_b128 v[60:63], v215 offset:18432
    v_mfma_f32_32x32x16_bf16 v[24:39], v[80:83], v[68:71], v[24:39]
    v_mfma_f32_32x32x16_bf16 v[40:55], v[84:87], v[64:67], v[40:55]
    s_add_u32 s49, s49, 4096
    s_add_u32 s50, s50, 4096
    buffer_load_dwordx4 v[80:83], v1, s[12:15], s49 offen offset:0
    buffer_load_dwordx4 v[84:87], v1, s[12:15], s50 offen offset:0
    s_waitcnt vmcnt(14) lgkmcnt(2)
    v_mfma_f32_32x32x16_bf16 v[8:23], v[88:91], v[72:75], v[8:23]
    ds_read_b128 v[64:67], v214 offset:19456
    ds_read_b128 v[68:71], v215 offset:19456
    v_mfma_f32_32x32x16_bf16 v[24:39], v[88:91], v[76:79], v[24:39]
    v_mfma_f32_32x32x16_bf16 v[40:55], v[92:95], v[72:75], v[40:55]
    buffer_load_dwordx4 v[88:91], v1, s[12:15], s49 offen offset:1024
    buffer_load_dwordx4 v[92:95], v1, s[12:15], s50 offen offset:1024
    s_waitcnt vmcnt(14) lgkmcnt(2)
    v_mfma_f32_32x32x16_bf16 v[8:23], v[96:99], v[56:59], v[8:23]
    ds_read_b128 v[72:75], v214 offset:20480
    ds_read_b128 v[76:79], v215 offset:20480
    v_mfma_f32_32x32x16_bf16 v[24:39], v[96:99], v[60:63], v[24:39]
    v_mfma_f32_32x32x16_bf16 v[40:55], v[100:103], v[56:59], v[40:55]
    buffer_load_dwordx4 v[96:99], v1, s[12:15], s49 offen offset:2048
    buffer_load_dwordx4 v[100:103], v1, s[12:15], s50 offen offset:2048
    s_waitcnt vmcnt(14) lgkmcnt(2)
    v_mfma_f32_32x32x16_bf16 v[8:23], v[104:107], v[64:67], v[8:23]
    ds_read_b128 v[56:59], v214 offset:21504
    ds_read_b128 v[60:63], v215 offset:21504
    v_mfma_f32_32x32x16_bf16 v[24:39], v[104:107], v[68:71], v[24:39]
    v_mfma_f32_32x32x16_bf16 v[40:55], v[108:111], v[64:67], v[40:55]
    buffer_load_dwordx4 v[104:107], v1, s[12:15], s49 offen offset:3072
    buffer_load_dwordx4 v[108:111], v1, s[12:15], s50 offen offset:3072
    s_waitcnt vmcnt(14) lgkmcnt(2)
    v_mfma_f32_32x32x16_bf16 v[8:23], v[112:115], v[72:75], v[8:23]
    ds_read_b128 v[64:67], v214 offset:22528
    ds_read_b128 v[68:71], v215 offset:22528
    v_mfma_f32_32x32x16_bf16 v[24:39], v[112:115], v[76:79], v[24:39]
    v_mfma_f32_32x32x16_bf16 v[40:55], v[116:119], v[72:75], v[40:55]
    s_add_u32 s49, s49, 4096
    s_add_u32 s50, s50, 4096
    buffer_load_dwordx4 v[112:115], v1, s[12:15], s49 offen offset:0
    buffer_load_dwordx4 v[116:119], v1, s[12:15], s50 offen offset:0
    s_waitcnt vmcnt(14) lgkmcnt(2)
    v_mfma_f32_32x32x16_bf16 v[8:23], v[120:123], v[56:59], v[8:23]
    ds_read_b128 v[72:75], v214 offset:23552
    ds_read_b128 v[76:79], v215 offset:23552
    v_mfma_f32_32x32x16_bf16 v[24:39], v[120:123], v[60:63], v[24:39]
    v_mfma_f32_32x32x16_bf16 v[40:55], v[124:127], v[56:59], v[40:55]
    buffer_load_dwordx4 v[120:123], v1, s[12:15], s49 offen offset:1024
    buffer_load_dwordx4 v[124:127], v1, s[12:15], s50 offen offset:1024
    s_waitcnt vmcnt(14) lgkmcnt(2)
    v_mfma_f32_32x32x16_bf16 v[8:23], v[128:131], v[64:67], v[8:23]
    ds_read_b128 v[56:59], v214 offset:24576
    ds_read_b128 v[60:63], v215 offset:24576
    v_mfma_f32_32x32x16_bf16 v[24:39], v[128:131], v[68:71], v[24:39]
    v_mfma_f32_32x32x16_bf16 v[40:55], v[132:135], v[64:67], v[40:55]
    buffer_load_dwordx4 v[128:131], v1, s[12:15], s49 offen offset:2048
    buffer_load_dwordx4 v[132:135], v1, s[12:15], s50 offen offset:2048
    s_waitcnt vmcnt(14) lgkmcnt(2)
    v_mfma_f32_32x32x16_bf16 v[8:23], v[136:139], v[72:75], v[8:23]
    ds_read_b128 v[64:67], v214 offset:25600
    ds_read_b128 v[68:71], v215 offset:25600
    v_mfma_f32_32x32x16_bf16 v[24:39], v[136:139], v[76:79], v[24:39]
    v_mfma_f32_32x32x16_bf16 v[40:55], v[140:143], v[72:75], v[40:55]
    buffer_load_dwordx4 v[136:139], v1, s[12:15], s49 offen offset:3072
    buffer_load_dwordx4 v[140:143], v1, s[12:15], s50 offen offset:3072
    s_waitcnt vmcnt(14) lgkmcnt(2)
    v_mfma_f32_32x32x16_bf16 v[8:23], v[80:83], v[56:59], v[8:23]
    ds_read_b128 v[72:75], v214 offset:26624
    ds_read_b128 v[76:79], v215 offset:26624
    v_mfma_f32_32x32x16_bf16 v[24:39], v[80:83], v[60:63], v[24:39]
    v_mfma_f32_32x32x16_bf16 v[40:55], v[84:87], v[56:59], v[40:55]
    s_waitcnt vmcnt(12) lgkmcnt(2)
    v_mfma_f32_32x32x16_bf16 v[8:23], v[88:91], v[64:67], v[8:23]
    ds_read_b128 v[56:59], v214 offset:27648
    ds_read_b128 v[60:63], v215 offset:27648
    v_mfma_f32_32x32x16_bf16 v[24:39], v[88:91], v[68:71], v[24:39]
    v_mfma_f32_32x32x16_bf16 v[40:55], v[92:95], v[64:67], v[40:55]
    s_waitcnt vmcnt(10) lgkmcnt(2)
    v_mfma_f32_32x32x16_bf16 v[8:23], v[96:99], v[72:75], v[8:23]
    ds_read_b128 v[64:67], v214 offset:28672
    ds_read_b128 v[68:71], v215 offset:28672
    v_mfma_f32_32x32x16_bf16 v[24:39], v[96:99], v[76:79], v[24:39]
    v_mfma_f32_32x32x16_bf16 v[40:55], v[100:103], v[72:75], v[40:55]
    s_waitcnt vmcnt(8) lgkmcnt(2)
    v_mfma_f32_32x32x16_bf16 v[8:23], v[104:107], v[56:59], v[8:23]
    ds_read_b128 v[72:75], v214 offset:29696
    ds_read_b128 v[76:79], v215 offset:29696
    v_mfma_f32_32x32x16_bf16 v[24:39], v[104:107], v[60:63], v[24:39]
    v_mfma_f32_32x32x16_bf16 v[40:55], v[108:111], v[56:59], v[40:55]
    s_waitcnt vmcnt(6) lgkmcnt(2)
    v_mfma_f32_32x32x16_bf16 v[8:23], v[112:115], v[64:67], v[8:23]
    ds_read_b128 v[56:59], v214 offset:30720
    ds_read_b128 v[60:63], v215 offset:30720
    v_mfma_f32_32x32x16_bf16 v[24:39], v[112:115], v[68:71], v[24:39]
    v_mfma_f32_32x32x16_bf16 v[40:55], v[116:119], v[64:67], v[40:55]
    s_waitcnt vmcnt(4) lgkmcnt(2)
    v_mfma_f32_32x32x16_bf16 v[8:23], v[120:123], v[72:75], v[8:23]
    ds_read_b128 v[64:67], v214 offset:31744
    ds_read_b128 v[68:71], v215 offset:31744
    v_mfma_f32_32x32x16_bf16 v[24:39], v[120:123], v[76:79], v[24:39]
    v_mfma_f32_32x32x16_bf16 v[40:55], v[124:127], v[72:75], v[40:55]
    s_waitcnt vmcnt(2) lgkmcnt(2)
    v_mfma_f32_32x32x16_bf16 v[8:23], v[128:131], v[56:59], v[8:23]
    v_mfma_f32_32x32x16_bf16 v[24:39], v[128:131], v[60:63], v[24:39]
    v_mfma_f32_32x32x16_bf16 v[40:55], v[132:135], v[56:59], v[40:55]
    s_waitcnt vmcnt(0) lgkmcnt(0)
    v_mfma_f32_32x32x16_bf16 v[8:23], v[136:139], v[64:67], v[8:23]
    v_mfma_f32_32x32x16_bf16 v[24:39], v[136:139], v[68:71], v[24:39]
    v_mfma_f32_32x32x16_bf16 v[40:55], v[140:143], v[64:67], v[40:55]
    s_branch B_W3J_6
B_W3TWO_5:
    ds_read_b128 v[56:59], v214 offset:0
    ds_read_b128 v[60:63], v215 offset:0
    ds_read_b128 v[64:67], v214 offset:1024
    ds_read_b128 v[68:71], v215 offset:1024
    s_waitcnt lgkmcnt(2)
    v_mfma_f32_32x32x16_bf16 v[8:23], v[80:83], v[56:59], 0
    ds_read_b128 v[72:75], v214 offset:2048
    ds_read_b128 v[76:79], v215 offset:2048
    v_mfma_f32_32x32x16_bf16 v[24:39], v[80:83], v[60:63], 0
    s_add_u32 s49, s49, 4096
    s_add_u32 s50, s50, 4096
    buffer_load_dwordx4 v[80:83], v1, s[12:15], s49 offen offset:0
    buffer_load_dwordx4 v[84:87], v1, s[12:15], s50 offen offset:0
    s_waitcnt lgkmcnt(2)
    v_mfma_f32_32x32x16_bf16 v[8:23], v[88:91], v[64:67], v[8:23]
    ds_read_b128 v[56:59], v214 offset:3072
    ds_read_b128 v[60:63], v215 offset:3072
    v_mfma_f32_32x32x16_bf16 v[24:39], v[88:91], v[68:71], v[24:39]
    buffer_load_dwordx4 v[88:91], v1, s[12:15], s49 offen offset:1024
    buffer_load_dwordx4 v[92:95], v1, s[12:15], s50 offen offset:1024
    s_waitcnt lgkmcnt(2)
    v_mfma_f32_32x32x16_bf16 v[8:23], v[96:99], v[72:75], v[8:23]
    ds_read_b128 v[64:67], v214 offset:4096
    ds_read_b128 v[68:71], v215 offset:4096
    v_mfma_f32_32x32x16_bf16 v[24:39], v[96:99], v[76:79], v[24:39]
    buffer_load_dwordx4 v[96:99], v1, s[12:15], s49 offen offset:2048
    buffer_load_dwordx4 v[100:103], v1, s[12:15], s50 offen offset:2048
    s_waitcnt lgkmcnt(2)
    v_mfma_f32_32x32x16_bf16 v[8:23], v[104:107], v[56:59], v[8:23]
    ds_read_b128 v[72:75], v214 offset:5120
    ds_read_b128 v[76:79], v215 offset:5120
    v_mfma_f32_32x32x16_bf16 v[24:39], v[104:107], v[60:63], v[24:39]
    buffer_load_dwordx4 v[104:107], v1, s[12:15], s49 offen offset:3072
    buffer_load_dwordx4 v[108:111], v1, s[12:15], s50 offen offset:3072
    s_waitcnt lgkmcnt(2)
    v_mfma_f32_32x32x16_bf16 v[8:23], v[112:115], v[64:67], v[8:23]
    ds_read_b128 v[56:59], v214 offset:6144
    ds_read_b128 v[60:63], v215 offset:6144
    v_mfma_f32_32x32x16_bf16 v[24:39], v[112:115], v[68:71], v[24:39]
    s_add_u32 s49, s49, 4096
    s_add_u32 s50, s50, 4096
    buffer_load_dwordx4 v[112:115], v1, s[12:15], s49 offen offset:0
    buffer_load_dwordx4 v[116:119], v1, s[12:15], s50 offen offset:0
    s_waitcnt lgkmcnt(2)
    v_mfma_f32_32x32x16_bf16 v[8:23], v[120:123], v[72:75], v[8:23]
    ds_read_b128 v[64:67], v214 offset:7168
    ds_read_b128 v[68:71], v215 offset:7168
    v_mfma_f32_32x32x16_bf16 v[24:39], v[120:123], v[76:79], v[24:39]
    buffer_load_dwordx4 v[120:123], v1, s[12:15], s49 offen offset:1024
    buffer_load_dwordx4 v[124:127], v1, s[12:15], s50 offen offset:1024
    s_waitcnt lgkmcnt(2)
    v_mfma_f32_32x32x16_bf16 v[8:23], v[128:131], v[56:59], v[8:23]
    ds_read_b128 v[72:75], v214 offset:8192
    ds_read_b128 v[76:79], v215 offset:8192
    v_mfma_f32_32x32x16_bf16 v[24:39], v[128:131], v[60:63], v[24:39]
    buffer_load_dwordx4 v[128:131], v1, s[12:15], s49 offen offset:2048
    buffer_load_dwordx4 v[132:135], v1, s[12:15], s50 offen offset:2048
    s_waitcnt lgkmcnt(2)
    v_mfma_f32_32x32x16_bf16 v[8:23], v[136:139], v[64:67], v[8:23]
    ds_read_b128 v[56:59], v214 offset:9216
    ds_read_b128 v[60:63], v215 offset:9216
    v_mfma_f32_32x32x16_bf16 v[24:39], v[136:139], v[68:71], v[24:39]
    buffer_load_dwordx4 v[136:139], v1, s[12:15], s49 offen offset:3072
    buffer_load_dwordx4 v[140:143], v1, s[12:15], s50 offen offset:3072
    s_waitcnt vmcnt(14) lgkmcnt(2)
    v_mfma_f32_32x32x16_bf16 v[8:23], v[80:83], v[72:75], v[8:23]
    ds_read_b128 v[64:67], v214 offset:10240
    ds_read_b128 v[68:71], v215 offset:10240
    v_mfma_f32_32x32x16_bf16 v[24:39], v[80:83], v[76:79], v[24:39]
    s_add_u32 s49, s49, 4096
    s_add_u32 s50, s50, 4096
    buffer_load_dwordx4 v[80:83], v1, s[12:15], s49 offen offset:0
    buffer_load_dwordx4 v[84:87], v1, s[12:15], s50 offen offset:0
    s_waitcnt vmcnt(14) lgkmcnt(2)
    v_mfma_f32_32x32x16_bf16 v[8:23], v[88:91], v[56:59], v[8:23]
    ds_read_b128 v[72:75], v214 offset:11264
    ds_read_b128 v[76:79], v215 offset:11264
    v_mfma_f32_32x32x16_bf16 v[24:39], v[88:91], v[60:63], v[24:39]
    buffer_load_dwordx4 v[88:91], v1, s[12:15], s49 offen offset:1024
    buffer_load_dwordx4 v[92:95], v1, s[12:15], s50 offen offset:1024
    s_waitcnt vmcnt(14) lgkmcnt(2)
    v_mfma_f32_32x32x16_bf16 v[8:23], v[96:99], v[64:67], v[8:23]
    ds_read_b128 v[56:59], v214 offset:12288
    ds_read_b128 v[60:63], v215 offset:12288
    v_mfma_f32_32x32x16_bf16 v[24:39], v[96:99], v[68:71], v[24:39]
    buffer_load_dwordx4 v[96:99], v1, s[12:15], s49 offen offset:2048
    buffer_load_dwordx4 v[100:103], v1, s[12:15], s50 offen offset:2048
    s_waitcnt vmcnt(14) lgkmcnt(2)
    v_mfma_f32_32x32x16_bf16 v[8:23], v[104:107], v[72:75], v[8:23]
    ds_read_b128 v[64:67], v214 offset:13312
    ds_read_b128 v[68:71], v215 offset:13312
    v_mfma_f32_32x32x16_bf16 v[24:39], v[104:107], v[76:79], v[24:39]
    buffer_load_dwordx4 v[104:107], v1, s[12:15], s49 offen offset:3072
    buffer_load_dwordx4 v[108:111], v1, s[12:15], s50 offen offset:3072
    s_waitcnt vmcnt(14) lgkmcnt(2)
    v_mfma_f32_32x32x16_bf16 v[8:23], v[112:115], v[56:59], v[8:23]
    ds_read_b128 v[72:75], v214 offset:14336
    ds_read_b128 v[76:79], v215 offset:14336
    v_mfma_f32_32x32x16_bf16 v[24:39], v[112:115], v[60:63], v[24:39]
    s_add_u32 s49, s49, 4096
    s_add_u32 s50, s50, 4096
    buffer_load_dwordx4 v[112:115], v1, s[12:15], s49 offen offset:0
    buffer_load_dwordx4 v[116:119], v1, s[12:15], s50 offen offset:0
    s_waitcnt vmcnt(14) lgkmcnt(2)
    v_mfma_f32_32x32x16_bf16 v[8:23], v[120:123], v[64:67], v[8:23]
    ds_read_b128 v[56:59], v214 offset:15360
    ds_read_b128 v[60:63], v215 offset:15360
    v_mfma_f32_32x32x16_bf16 v[24:39], v[120:123], v[68:71], v[24:39]
    buffer_load_dwordx4 v[120:123], v1, s[12:15], s49 offen offset:1024
    buffer_load_dwordx4 v[124:127], v1, s[12:15], s50 offen offset:1024
    s_waitcnt vmcnt(14) lgkmcnt(2)
    v_mfma_f32_32x32x16_bf16 v[8:23], v[128:131], v[72:75], v[8:23]
    ds_read_b128 v[64:67], v214 offset:16384
    ds_read_b128 v[68:71], v215 offset:16384
    v_mfma_f32_32x32x16_bf16 v[24:39], v[128:131], v[76:79], v[24:39]
    buffer_load_dwordx4 v[128:131], v1, s[12:15], s49 offen offset:2048
    buffer_load_dwordx4 v[132:135], v1, s[12:15], s50 offen offset:2048
    s_waitcnt vmcnt(14) lgkmcnt(2)
    v_mfma_f32_32x32x16_bf16 v[8:23], v[136:139], v[56:59], v[8:23]
    ds_read_b128 v[72:75], v214 offset:17408
    ds_read_b128 v[76:79], v215 offset:17408
    v_mfma_f32_32x32x16_bf16 v[24:39], v[136:139], v[60:63], v[24:39]
    buffer_load_dwordx4 v[136:139], v1, s[12:15], s49 offen offset:3072
    buffer_load_dwordx4 v[140:143], v1, s[12:15], s50 offen offset:3072
    s_waitcnt vmcnt(14) lgkmcnt(2)
    v_mfma_f32_32x32x16_bf16 v[8:23], v[80:83], v[64:67], v[8:23]
    ds_read_b128 v[56:59], v214 offset:18432
    ds_read_b128 v[60:63], v215 offset:18432
    v_mfma_f32_32x32x16_bf16 v[24:39], v[80:83], v[68:71], v[24:39]
    s_add_u32 s49, s49, 4096
    s_add_u32 s50, s50, 4096
    buffer_load_dwordx4 v[80:83], v1, s[12:15], s49 offen offset:0
    buffer_load_dwordx4 v[84:87], v1, s[12:15], s50 offen offset:0
    s_waitcnt vmcnt(14) lgkmcnt(2)
    v_mfma_f32_32x32x16_bf16 v[8:23], v[88:91], v[72:75], v[8:23]
    ds_read_b128 v[64:67], v214 offset:19456
    ds_read_b128 v[68:71], v215 offset:19456
    v_mfma_f32_32x32x16_bf16 v[24:39], v[88:91], v[76:79], v[24:39]
    buffer_load_dwordx4 v[88:91], v1, s[12:15], s49 offen offset:1024
    buffer_load_dwordx4 v[92:95], v1, s[12:15], s50 offen offset:1024
    s_waitcnt vmcnt(14) lgkmcnt(2)
    v_mfma_f32_32x32x16_bf16 v[8:23], v[96:99], v[56:59], v[8:23]
    ds_read_b128 v[72:75], v214 offset:20480
    ds_read_b128 v[76:79], v215 offset:20480
    v_mfma_f32_32x32x16_bf16 v[24:39], v[96:99], v[60:63], v[24:39]
    buffer_load_dwordx4 v[96:99], v1, s[12:15], s49 offen offset:2048
    buffer_load_dwordx4 v[100:103], v1, s[12:15], s50 offen offset:2048
    s_waitcnt vmcnt(14) lgkmcnt(2)
    v_mfma_f32_32x32x16_bf16 v[8:23], v[104:107], v[64:67], v[8:23]
    ds_read_b128 v[56:59], v214 offset:21504
    ds_read_b128 v[60:63], v215 offset:21504
    v_mfma_f32_32x32x16_bf16 v[24:39], v[104:107], v[68:71], v[24:39]
    buffer_load_dwordx4 v[104:107], v1, s[12:15], s49 offen offset:3072
    buffer_load_dwordx4 v[108:111], v1, s[12:15], s50 offen offset:3072
    s_waitcnt vmcnt(14) lgkmcnt(2)
    v_mfma_f32_32x32x16_bf16 v[8:23], v[112:115], v[72:75], v[8:23]
    ds_read_b128 v[64:67], v214 offset:22528
    ds_read_b128 v[68:71], v215 offset:22528
    v_mfma_f32_32x32x16_bf16 v[24:39], v[112:115], v[76:79], v[24:39]
    s_add_u32 s49, s49, 4096
    s_add_u32 s50, s50, 4096
    buffer_load_dwordx4 v[112:115], v1, s[12:15], s49 offen offset:0
    buffer_load_dwordx4 v[116:119], v1, s[12:15], s50 offen offset:0
    s_waitcnt vmcnt(14) lgkmcnt(2)
    v_mfma_f32_32x32x16_bf16 v[8:23], v[120:123], v[56:59], v[8:23]
    ds_read_b128 v[72:75], v214 offset:23552
    ds_read_b128 v[76:79], v215 offset:23552
    v_mfma_f32_32x32x16_bf16 v[24:39], v[120:123], v[60:63], v[24:39]
    buffer_load_dwordx4 v[120:123], v1, s[12:15], s49 offen offset:1024
    buffer_load_dwordx4 v[124:127], v1, s[12:15], s50 offen offset:1024
    s_waitcnt vmcnt(14) lgkmcnt(2)
    v_mfma_f32_32x32x16_bf16 v[8:23], v[128:131], v[64:67], v[8:23]
    ds_read_b128 v[56:59], v214 offset:24576
    ds_read_b128 v[60:63], v215 offset:24576
    v_mfma_f32_32x32x16_bf16 v[24:39], v[128:131], v[68:71], v[24:39]
    buffer_load_dwordx4 v[128:131], v1, s[12:15], s49 offen offset:2048
    buffer_load_dwordx4 v[132:135], v1, s[12:15], s50 offen offset:2048
    s_waitcnt vmcnt(14) lgkmcnt(2)
    v_mfma_f32_32x32x16_bf16 v[8:23], v[136:139], v[72:75], v[8:23]
    ds_read_b128 v[64:67], v214 offset:25600
    ds_read_b128 v[68:71], v215 offset:25600
    v_mfma_f32_32x32x16_bf16 v[24:39], v[136:139], v[76:79], v[24:39]
    buffer_load_dwordx4 v[136:139], v1, s[12:15], s49 offen offset:3072
    buffer_load_dwordx4 v[140:143], v1, s[12:15], s50 offen offset:3072
    s_waitcnt vmcnt(14) lgkmcnt(2)
    v_mfma_f32_32x32x16_bf16 v[8:23], v[80:83], v[56:59], v[8:23]
    ds_read_b128 v[72:75], v214 offset:26624
    ds_read_b128 v[76:79], v215 offset:26624
    v_mfma_f32_32x32x16_bf16 v[24:39], v[80:83], v[60:63], v[24:39]
    s_waitcnt vmcnt(12) lgkmcnt(2)
    v_mfma_f32_32x32x16_bf16 v[8:23], v[88:91], v[64:67], v[8:23]
    ds_read_b128 v[56:59], v214 offset:27648
    ds_read_b128 v[60:63], v215 offset:27648
    v_mfma_f32_32x32x16_bf16 v[24:39], v[88:91], v[68:71], v[24:39]
    s_waitcnt vmcnt(10) lgkmcnt(2)
    v_mfma_f32_32x32x16_bf16 v[8:23], v[96:99], v[72:75], v[8:23]
    ds_read_b128 v[64:67], v214 offset:28672
    ds_read_b128 v[68:71], v215 offset:28672
    v_mfma_f32_32x32x16_bf16 v[24:39], v[96:99], v[76:79], v[24:39]
    s_waitcnt vmcnt(8) lgkmcnt(2)
    v_mfma_f32_32x32x16_bf16 v[8:23], v[104:107], v[56:59], v[8:23]
    ds_read_b128 v[72:75], v214 offset:29696
    ds_read_b128 v[76:79], v215 offset:29696
    v_mfma_f32_32x32x16_bf16 v[24:39], v[104:107], v[60:63], v[24:39]
    s_waitcnt vmcnt(6) lgkmcnt(2)
    v_mfma_f32_32x32x16_bf16 v[8:23], v[112:115], v[64:67], v[8:23]
    ds_read_b128 v[56:59], v214 offset:30720
    ds_read_b128 v[60:63], v215 offset:30720
    v_mfma_f32_32x32x16_bf16 v[24:39], v[112:115], v[68:71], v[24:39]
    s_waitcnt vmcnt(4) lgkmcnt(2)
    v_mfma_f32_32x32x16_bf16 v[8:23], v[120:123], v[72:75], v[8:23]
    ds_read_b128 v[64:67], v214 offset:31744
    ds_read_b128 v[68:71], v215 offset:31744
    v_mfma_f32_32x32x16_bf16 v[24:39], v[120:123], v[76:79], v[24:39]
    s_waitcnt vmcnt(2) lgkmcnt(2)
    v_mfma_f32_32x32x16_bf16 v[8:23], v[128:131], v[56:59], v[8:23]
    v_mfma_f32_32x32x16_bf16 v[24:39], v[128:131], v[60:63], v[24:39]
    s_waitcnt vmcnt(0) lgkmcnt(0)
    v_mfma_f32_32x32x16_bf16 v[8:23], v[136:139], v[64:67], v[8:23]
    v_mfma_f32_32x32x16_bf16 v[24:39], v[136:139], v[68:71], v[24:39]
B_W3J_6:
    s_setprio 2
    v_pk_add_f32 v[176:177], v[176:177], v[178:179]
    v_pk_add_f32 v[176:177], v[176:177], v[180:181]
    v_pk_add_f32 v[176:177], v[176:177], v[182:183]
    v_pk_add_f32 v[176:177], v[176:177], v[184:185]
    v_pk_add_f32 v[176:177], v[176:177], v[186:187]
    v_pk_add_f32 v[176:177], v[176:177], v[188:189]
    v_pk_add_f32 v[176:177], v[176:177], v[190:191]
    v_mov_b32 v4, v176
    s_nop 1
    v_permlane32_swap_b32 v4, v176
    v_add_f32 v176, v176, v4
    v_mov_b32 v4, v177
    s_nop 1
    v_permlane32_swap_b32 v4, v177
    v_add_f32 v177, v177, v4
    v_mul_f32 v208, 0x3b000000, v176
    v_mul_f32 v209, 0x3b000000, v177
    v_fma_f32 v209, -v208, v208, v209
    v_max_f32 v209, 0, v209
    v_add_f32 v209, 0x3727c5ac, v209
    v_rsq_f32 v209, v209
    v_pk_add_f32 v[192:193], v[192:193], v[194:195]
    v_pk_add_f32 v[192:193], v[192:193], v[196:197]
    v_pk_add_f32 v[192:193], v[192:193], v[198:199]
    v_pk_add_f32 v[192:193], v[192:193], v[200:201]
    v_pk_add_f32 v[192:193], v[192:193], v[202:203]
    v_pk_add_f32 v[192:193], v[192:193], v[204:205]
    v_pk_add_f32 v[192:193], v[192:193], v[206:207]
    v_mov_b32 v4, v192
    s_nop 1
    v_permlane32_swap_b32 v4, v192
    v_add_f32 v192, v192, v4
    v_mov_b32 v4, v193
    s_nop 1
    v_permlane32_swap_b32 v4, v193
    v_add_f32 v193, v193, v4
    v_mul_f32 v210, 0x3b000000, v192
    v_mul_f32 v211, 0x3b000000, v193
    v_fma_f32 v211, -v210, v210, v211
    v_max_f32 v211, 0, v211
    v_add_f32 v211, 0x3727c5ac, v211
    v_rsq_f32 v211, v211
    s_add_u32 s16, s28, 0xc00000
    s_addc_u32 s17, s29, 0
    s_mov_b32 s18, 0x560000
    s_mov_b32 s19, 0x20000
    s_lshl_b32 s35, s30, 1
    s_add_u32 s36, s35, s34
    s_mul_i32 s54, s36, 86
    s_xor_b32 s36, s36, 1
    s_mul_i32 s55, s36, 86
    s_add_u32 s35, s47, s32
    s_lshl_b32 s35, s35, 1
    s_add_u32 s37, s47, s33
    s_add_u32 s37, s37, 4
    s_lshl_b32 s37, s37, 1
    s_add_u32 s37, s37, s54
    s_lshl_b32 s37, s37, 10
    s_add_u32 s54, s54, s35
    s_lshl_b32 s54, s54, 10
    s_add_u32 s55, s55, s35
    s_lshl_b32 s55, s55, 10
    v_mov_b32 v212, 0xc0135761
    v_mov_b32 v213, 0xc0135761
    s_mov_b32 s44, 0xbdd2d3e8
    s_mov_b32 s45, 0xbdd2d3e8
    v_pk_fma_f32 v[8:9], v[208:209], v[144:145], v[8:9] op_sel_hi:[0,1,1] neg_lo:[1,0,0] neg_hi:[1,0,0]
    v_pk_fma_f32 v[10:11], v[208:209], v[146:147], v[10:11] op_sel_hi:[0,1,1] neg_lo:[1,0,0] neg_hi:[1,0,0]
    v_pk_fma_f32 v[12:13], v[208:209], v[148:149], v[12:13] op_sel_hi:[0,1,1] neg_lo:[1,0,0] neg_hi:[1,0,0]
    v_pk_fma_f32 v[14:15], v[208:209], v[150:151], v[14:15] op_sel_hi:[0,1,1] neg_lo:[1,0,0] neg_hi:[1,0,0]
    v_pk_fma_f32 v[16:17], v[208:209], v[152:153], v[16:17] op_sel_hi:[0,1,1] neg_lo:[1,0,0] neg_hi:[1,0,0]
    v_pk_fma_f32 v[18:19], v[208:209], v[154:155], v[18:19] op_sel_hi:[0,1,1] neg_lo:[1,0,0] neg_hi:[1,0,0]
    v_pk_fma_f32 v[20:21], v[208:209], v[156:157], v[20:21] op_sel_hi:[0,1,1] neg_lo:[1,0,0] neg_hi:[1,0,0]
    v_pk_fma_f32 v[22:23], v[208:209], v[158:159], v[22:23] op_sel_hi:[0,1,1] neg_lo:[1,0,0] neg_hi:[1,0,0]
    v_pk_mul_f32 v[8:9], v[8:9], v[208:209] op_sel:[0,1] op_sel_hi:[1,1]
    v_pk_mul_f32 v[10:11], v[10:11], v[208:209] op_sel:[0,1] op_sel_hi:[1,1]
    v_pk_mul_f32 v[12:13], v[12:13], v[208:209] op_sel:[0,1] op_sel_hi:[1,1]
    v_pk_mul_f32 v[14:15], v[14:15], v[208:209] op_sel:[0,1] op_sel_hi:[1,1]
    v_pk_mul_f32 v[16:17], v[16:17], v[208:209] op_sel:[0,1] op_sel_hi:[1,1]
    v_pk_mul_f32 v[18:19], v[18:19], v[208:209] op_sel:[0,1] op_sel_hi:[1,1]
    v_pk_mul_f32 v[20:21], v[20:21], v[208:209] op_sel:[0,1] op_sel_hi:[1,1]
    v_pk_mul_f32 v[22:23], v[22:23], v[208:209] op_sel:[0,1] op_sel_hi:[1,1]
    v_pk_mul_f32 v[56:57], v[8:9], v[8:9]
    v_pk_mul_f32 v[58:59], v[10:11], v[10:11]
    v_pk_mul_f32 v[60:61], v[12:13], v[12:13]
    v_pk_mul_f32 v[62:63], v[14:15], v[14:15]
    v_pk_mul_f32 v[64:65], v[16:17], v[16:17]
    v_pk_mul_f32 v[66:67], v[18:19], v[18:19]
    v_pk_mul_f32 v[68:69], v[20:21], v[20:21]
    v_pk_mul_f32 v[70:71], v[22:23], v[22:23]
    v_pk_fma_f32 v[56:57], v[56:57], s[44:45], v[212:213]
    v_pk_fma_f32 v[58:59], v[58:59], s[44:45], v[212:213]
    v_pk_fma_f32 v[60:61], v[60:61], s[44:45], v[212:213]
    v_pk_fma_f32 v[62:63], v[62:63], s[44:45], v[212:213]
    v_pk_fma_f32 v[64:65], v[64:65], s[44:45], v[212:213]
    v_pk_fma_f32 v[66:67], v[66:67], s[44:45], v[212:213]
    v_pk_fma_f32 v[68:69], v[68:69], s[44:45], v[212:213]
    v_pk_fma_f32 v[70:71], v[70:71], s[44:45], v[212:213]
    v_pk_mul_f32 v[56:57], v[56:57], v[8:9]
    v_pk_mul_f32 v[58:59], v[58:59], v[10:11]
    v_pk_mul_f32 v[60:61], v[60:61], v[12:13]
    v_pk_mul_f32 v[62:63], v[62:63], v[14:15]
    v_pk_mul_f32 v[64:65], v[64:65], v[16:17]
    v_pk_mul_f32 v[66:67], v[66:67], v[18:19]
    v_pk_mul_f32 v[68:69], v[68:69], v[20:21]
    v_pk_mul_f32 v[70:71], v[70:71], v[22:23]
    v_exp_f32 v56, v56
    v_exp_f32 v57, v57
    v_exp_f32 v58, v58
    v_exp_f32 v59, v59
    v_exp_f32 v60, v60
    v_exp_f32 v61, v61
    v_exp_f32 v62, v62
    v_exp_f32 v63, v63
    v_exp_f32 v64, v64
    v_exp_f32 v65, v65
    v_exp_f32 v66, v66
    v_exp_f32 v67, v67
    v_exp_f32 v68, v68
    v_exp_f32 v69, v69
    v_exp_f32 v70, v70
    v_exp_f32 v71, v71
    v_pk_add_f32 v[56:57], v[56:57], 1.0 op_sel_hi:[1,0]
    v_pk_add_f32 v[58:59], v[58:59], 1.0 op_sel_hi:[1,0]
    v_pk_add_f32 v[60:61], v[60:61], 1.0 op_sel_hi:[1,0]
    v_pk_add_f32 v[62:63], v[62:63], 1.0 op_sel_hi:[1,0]
    v_pk_add_f32 v[64:65], v[64:65], 1.0 op_sel_hi:[1,0]
    v_pk_add_f32 v[66:67], v[66:67], 1.0 op_sel_hi:[1,0]
    v_pk_add_f32 v[68:69], v[68:69], 1.0 op_sel_hi:[1,0]
    v_pk_add_f32 v[70:71], v[70:71], 1.0 op_sel_hi:[1,0]
    v_rcp_f32 v56, v56
    v_rcp_f32 v57, v57
    v_rcp_f32 v58, v58
    v_rcp_f32 v59, v59
    v_rcp_f32 v60, v60
    v_rcp_f32 v61, v61
    v_rcp_f32 v62, v62
    v_rcp_f32 v63, v63
    v_rcp_f32 v64, v64
    v_rcp_f32 v65, v65
    v_rcp_f32 v66, v66
    v_rcp_f32 v67, v67
    v_rcp_f32 v68, v68
    v_rcp_f32 v69, v69
    v_rcp_f32 v70, v70
    v_rcp_f32 v71, v71
    v_pk_mul_f32 v[8:9], v[8:9], v[56:57]
    v_pk_mul_f32 v[10:11], v[10:11], v[58:59]
    v_pk_mul_f32 v[12:13], v[12:13], v[60:61]
    v_pk_mul_f32 v[14:15], v[14:15], v[62:63]
    v_pk_mul_f32 v[16:17], v[16:17], v[64:65]
    v_pk_mul_f32 v[18:19], v[18:19], v[66:67]
    v_pk_mul_f32 v[20:21], v[20:21], v[68:69]
    v_pk_mul_f32 v[22:23], v[22:23], v[70:71]
    v_cvt_pk_bf16_f32 v72, v8, v9
    v_cvt_pk_bf16_f32 v73, v10, v11
    v_cvt_pk_bf16_f32 v74, v12, v13
    v_cvt_pk_bf16_f32 v75, v14, v15
    buffer_store_dwordx4 v[72:75], v1, s[16:19], s54 offen offset:0 sc1
    v_cvt_pk_bf16_f32 v76, v16, v17
    v_cvt_pk_bf16_f32 v77, v18, v19
    v_cvt_pk_bf16_f32 v78, v20, v21
    v_cvt_pk_bf16_f32 v79, v22, v23
    buffer_store_dwordx4 v[76:79], v1, s[16:19], s54 offen offset:1024 sc1
    v_pk_fma_f32 v[24:25], v[210:211], v[144:145], v[24:25] op_sel_hi:[0,1,1] neg_lo:[1,0,0] neg_hi:[1,0,0]
    v_pk_fma_f32 v[26:27], v[210:211], v[146:147], v[26:27] op_sel_hi:[0,1,1] neg_lo:[1,0,0] neg_hi:[1,0,0]
    v_pk_fma_f32 v[28:29], v[210:211], v[148:149], v[28:29] op_sel_hi:[0,1,1] neg_lo:[1,0,0] neg_hi:[1,0,0]
    v_pk_fma_f32 v[30:31], v[210:211], v[150:151], v[30:31] op_sel_hi:[0,1,1] neg_lo:[1,0,0] neg_hi:[1,0,0]
    v_pk_fma_f32 v[32:33], v[210:211], v[152:153], v[32:33] op_sel_hi:[0,1,1] neg_lo:[1,0,0] neg_hi:[1,0,0]
    v_pk_fma_f32 v[34:35], v[210:211], v[154:155], v[34:35] op_sel_hi:[0,1,1] neg_lo:[1,0,0] neg_hi:[1,0,0]
    v_pk_fma_f32 v[36:37], v[210:211], v[156:157], v[36:37] op_sel_hi:[0,1,1] neg_lo:[1,0,0] neg_hi:[1,0,0]
    v_pk_fma_f32 v[38:39], v[210:211], v[158:159], v[38:39] op_sel_hi:[0,1,1] neg_lo:[1,0,0] neg_hi:[1,0,0]
    v_pk_mul_f32 v[24:25], v[24:25], v[210:211] op_sel:[0,1] op_sel_hi:[1,1]
    v_pk_mul_f32 v[26:27], v[26:27], v[210:211] op_sel:[0,1] op_sel_hi:[1,1]
    v_pk_mul_f32 v[28:29], v[28:29], v[210:211] op_sel:[0,1] op_sel_hi:[1,1]
    v_pk_mul_f32 v[30:31], v[30:31], v[210:211] op_sel:[0,1] op_sel_hi:[1,1]
    v_pk_mul_f32 v[32:33], v[32:33], v[210:211] op_sel:[0,1] op_sel_hi:[1,1]
    v_pk_mul_f32 v[34:35], v[34:35], v[210:211] op_sel:[0,1] op_sel_hi:[1,1]
    v_pk_mul_f32 v[36:37], v[36:37], v[210:211] op_sel:[0,1] op_sel_hi:[1,1]
    v_pk_mul_f32 v[38:39], v[38:39], v[210:211] op_sel:[0,1] op_sel_hi:[1,1]
    v_pk_mul_f32 v[56:57], v[24:25], v[24:25]
    v_pk_mul_f32 v[58:59], v[26:27], v[26:27]
    v_pk_mul_f32 v[60:61], v[28:29], v[28:29]
    v_pk_mul_f32 v[62:63], v[30:31], v[30:31]
    v_pk_mul_f32 v[64:65], v[32:33], v[32:33]
    v_pk_mul_f32 v[66:67], v[34:35], v[34:35]
    v_pk_mul_f32 v[68:69], v[36:37], v[36:37]
    v_pk_mul_f32 v[70:71], v[38:39], v[38:39]
    v_pk_fma_f32 v[56:57], v[56:57], s[44:45], v[212:213]
    v_pk_fma_f32 v[58:59], v[58:59], s[44:45], v[212:213]
    v_pk_fma_f32 v[60:61], v[60:61], s[44:45], v[212:213]
    v_pk_fma_f32 v[62:63], v[62:63], s[44:45], v[212:213]
    v_pk_fma_f32 v[64:65], v[64:65], s[44:45], v[212:213]
    v_pk_fma_f32 v[66:67], v[66:67], s[44:45], v[212:213]
    v_pk_fma_f32 v[68:69], v[68:69], s[44:45], v[212:213]
    v_pk_fma_f32 v[70:71], v[70:71], s[44:45], v[212:213]
    v_pk_mul_f32 v[56:57], v[56:57], v[24:25]
    v_pk_mul_f32 v[58:59], v[58:59], v[26:27]
    v_pk_mul_f32 v[60:61], v[60:61], v[28:29]
    v_pk_mul_f32 v[62:63], v[62:63], v[30:31]
    v_pk_mul_f32 v[64:65], v[64:65], v[32:33]
    v_pk_mul_f32 v[66:67], v[66:67], v[34:35]
    v_pk_mul_f32 v[68:69], v[68:69], v[36:37]
    v_pk_mul_f32 v[70:71], v[70:71], v[38:39]
    v_exp_f32 v56, v56
    v_exp_f32 v57, v57
    v_exp_f32 v58, v58
    v_exp_f32 v59, v59
    v_exp_f32 v60, v60
    v_exp_f32 v61, v61
    v_exp_f32 v62, v62
    v_exp_f32 v63, v63
    v_exp_f32 v64, v64
    v_exp_f32 v65, v65
    v_exp_f32 v66, v66
    v_exp_f32 v67, v67
    v_exp_f32 v68, v68
    v_exp_f32 v69, v69
    v_exp_f32 v70, v70
    v_exp_f32 v71, v71
    v_pk_add_f32 v[56:57], v[56:57], 1.0 op_sel_hi:[1,0]
    v_pk_add_f32 v[58:59], v[58:59], 1.0 op_sel_hi:[1,0]
    v_pk_add_f32 v[60:61], v[60:61], 1.0 op_sel_hi:[1,0]
    v_pk_add_f32 v[62:63], v[62:63], 1.0 op_sel_hi:[1,0]
    v_pk_add_f32 v[64:65], v[64:65], 1.0 op_sel_hi:[1,0]
    v_pk_add_f32 v[66:67], v[66:67], 1.0 op_sel_hi:[1,0]
    v_pk_add_f32 v[68:69], v[68:69], 1.0 op_sel_hi:[1,0]
    v_pk_add_f32 v[70:71], v[70:71], 1.0 op_sel_hi:[1,0]
    v_rcp_f32 v56, v56
    v_rcp_f32 v57, v57
    v_rcp_f32 v58, v58
    v_rcp_f32 v59, v59
    v_rcp_f32 v60, v60
    v_rcp_f32 v61, v61
    v_rcp_f32 v62, v62
    v_rcp_f32 v63, v63
    v_rcp_f32 v64, v64
    v_rcp_f32 v65, v65
    v_rcp_f32 v66, v66
    v_rcp_f32 v67, v67
    v_rcp_f32 v68, v68
    v_rcp_f32 v69, v69
    v_rcp_f32 v70, v70
    v_rcp_f32 v71, v71
    v_pk_mul_f32 v[24:25], v[24:25], v[56:57]
    v_pk_mul_f32 v[26:27], v[26:27], v[58:59]
    v_pk_mul_f32 v[28:29], v[28:29], v[60:61]
    v_pk_mul_f32 v[30:31], v[30:31], v[62:63]
    v_pk_mul_f32 v[32:33], v[32:33], v[64:65]
    v_pk_mul_f32 v[34:35], v[34:35], v[66:67]
    v_pk_mul_f32 v[36:37], v[36:37], v[68:69]
    v_pk_mul_f32 v[38:39], v[38:39], v[70:71]
    v_cvt_pk_bf16_f32 v72, v24, v25
    v_cvt_pk_bf16_f32 v73, v26, v27
    v_cvt_pk_bf16_f32 v74, v28, v29
    v_cvt_pk_bf16_f32 v75, v30, v31
    buffer_store_dwordx4 v[72:75], v1, s[16:19], s55 offen offset:0 sc1
    v_cvt_pk_bf16_f32 v76, v32, v33
    v_cvt_pk_bf16_f32 v77, v34, v35
    v_cvt_pk_bf16_f32 v78, v36, v37
    v_cvt_pk_bf16_f32 v79, v38, v39
    buffer_store_dwordx4 v[76:79], v1, s[16:19], s55 offen offset:1024 sc1
    s_add_u32 s35, s33, 4
    s_cmp_ge_u32 s35, s46
    s_cbranch_scc1 B_NOT3_7
    v_pk_fma_f32 v[40:41], v[208:209], v[160:161], v[40:41] op_sel_hi:[0,1,1] neg_lo:[1,0,0] neg_hi:[1,0,0]
    v_pk_fma_f32 v[42:43], v[208:209], v[162:163], v[42:43] op_sel_hi:[0,1,1] neg_lo:[1,0,0] neg_hi:[1,0,0]
    v_pk_fma_f32 v[44:45], v[208:209], v[164:165], v[44:45] op_sel_hi:[0,1,1] neg_lo:[1,0,0] neg_hi:[1,0,0]
    v_pk_fma_f32 v[46:47], v[208:209], v[166:167], v[46:47] op_sel_hi:[0,1,1] neg_lo:[1,0,0] neg_hi:[1,0,0]
    v_pk_fma_f32 v[48:49], v[208:209], v[168:169], v[48:49] op_sel_hi:[0,1,1] neg_lo:[1,0,0] neg_hi:[1,0,0]
    v_pk_fma_f32 v[50:51], v[208:209], v[170:171], v[50:51] op_sel_hi:[0,1,1] neg_lo:[1,0,0] neg_hi:[1,0,0]
    v_pk_fma_f32 v[52:53], v[208:209], v[172:173], v[52:53] op_sel_hi:[0,1,1] neg_lo:[1,0,0] neg_hi:[1,0,0]
    v_pk_fma_f32 v[54:55], v[208:209], v[174:175], v[54:55] op_sel_hi:[0,1,1] neg_lo:[1,0,0] neg_hi:[1,0,0]
    v_pk_mul_f32 v[40:41], v[40:41], v[208:209] op_sel:[0,1] op_sel_hi:[1,1]
    v_pk_mul_f32 v[42:43], v[42:43], v[208:209] op_sel:[0,1] op_sel_hi:[1,1]
    v_pk_mul_f32 v[44:45], v[44:45], v[208:209] op_sel:[0,1] op_sel_hi:[1,1]
    v_pk_mul_f32 v[46:47], v[46:47], v[208:209] op_sel:[0,1] op_sel_hi:[1,1]
    v_pk_mul_f32 v[48:49], v[48:49], v[208:209] op_sel:[0,1] op_sel_hi:[1,1]
    v_pk_mul_f32 v[50:51], v[50:51], v[208:209] op_sel:[0,1] op_sel_hi:[1,1]
    v_pk_mul_f32 v[52:53], v[52:53], v[208:209] op_sel:[0,1] op_sel_hi:[1,1]
    v_pk_mul_f32 v[54:55], v[54:55], v[208:209] op_sel:[0,1] op_sel_hi:[1,1]
    v_pk_mul_f32 v[56:57], v[40:41], v[40:41]
    v_pk_mul_f32 v[58:59], v[42:43], v[42:43]
    v_pk_mul_f32 v[60:61], v[44:45], v[44:45]
    v_pk_mul_f32 v[62:63], v[46:47], v[46:47]
    v_pk_mul_f32 v[64:65], v[48:49], v[48:49]
    v_pk_mul_f32 v[66:67], v[50:51], v[50:51]
    v_pk_mul_f32 v[68:69], v[52:53], v[52:53]
    v_pk_mul_f32 v[70:71], v[54:55], v[54:55]
    v_pk_fma_f32 v[56:57], v[56:57], s[44:45], v[212:213]
    v_pk_fma_f32 v[58:59], v[58:59], s[44:45], v[212:213]
    v_pk_fma_f32 v[60:61], v[60:61], s[44:45], v[212:213]
    v_pk_fma_f32 v[62:63], v[62:63], s[44:45], v[212:213]
    v_pk_fma_f32 v[64:65], v[64:65], s[44:45], v[212:213]
    v_pk_fma_f32 v[66:67], v[66:67], s[44:45], v[212:213]
    v_pk_fma_f32 v[68:69], v[68:69], s[44:45], v[212:213]
    v_pk_fma_f32 v[70:71], v[70:71], s[44:45], v[212:213]
    v_pk_mul_f32 v[56:57], v[56:57], v[40:41]
    v_pk_mul_f32 v[58:59], v[58:59], v[42:43]
    v_pk_mul_f32 v[60:61], v[60:61], v[44:45]
    v_pk_mul_f32 v[62:63], v[62:63], v[46:47]
    v_pk_mul_f32 v[64:65], v[64:65], v[48:49]
    v_pk_mul_f32 v[66:67], v[66:67], v[50:51]
    v_pk_mul_f32 v[68:69], v[68:69], v[52:53]
    v_pk_mul_f32 v[70:71], v[70:71], v[54:55]
    v_exp_f32 v56, v56
    v_exp_f32 v57, v57
    v_exp_f32 v58, v58
    v_exp_f32 v59, v59
    v_exp_f32 v60, v60
    v_exp_f32 v61, v61
    v_exp_f32 v62, v62
    v_exp_f32 v63, v63
    v_exp_f32 v64, v64
    v_exp_f32 v65, v65
    v_exp_f32 v66, v66
    v_exp_f32 v67, v67
    v_exp_f32 v68, v68
    v_exp_f32 v69, v69
    v_exp_f32 v70, v70
    v_exp_f32 v71, v71
    v_pk_add_f32 v[56:57], v[56:57], 1.0 op_sel_hi:[1,0]
    v_pk_add_f32 v[58:59], v[58:59], 1.0 op_sel_hi:[1,0]
    v_pk_add_f32 v[60:61], v[60:61], 1.0 op_sel_hi:[1,0]
    v_pk_add_f32 v[62:63], v[62:63], 1.0 op_sel_hi:[1,0]
    v_pk_add_f32 v[64:65], v[64:65], 1.0 op_sel_hi:[1,0]
    v_pk_add_f32 v[66:67], v[66:67], 1.0 op_sel_hi:[1,0]
    v_pk_add_f32 v[68:69], v[68:69], 1.0 op_sel_hi:[1,0]
    v_pk_add_f32 v[70:71], v[70:71], 1.0 op_sel_hi:[1,0]
    v_rcp_f32 v56, v56
    v_rcp_f32 v57, v57
    v_rcp_f32 v58, v58
    v_rcp_f32 v59, v59
    v_rcp_f32 v60, v60
    v_rcp_f32 v61, v61
    v_rcp_f32 v62, v62
    v_rcp_f32 v63, v63
    v_rcp_f32 v64, v64
    v_rcp_f32 v65, v65
    v_rcp_f32 v66, v66
    v_rcp_f32 v67, v67
    v_rcp_f32 v68, v68
    v_rcp_f32 v69, v69
    v_rcp_f32 v70, v70
    v_rcp_f32 v71, v71
    v_pk_mul_f32 v[40:41], v[40:41], v[56:57]
    v_pk_mul_f32 v[42:43], v[42:43], v[58:59]
    v_pk_mul_f32 v[44:45], v[44:45], v[60:61]
    v_pk_mul_f32 v[46:47], v[46:47], v[62:63]
    v_pk_mul_f32 v[48:49], v[48:49], v[64:65]
    v_pk_mul_f32 v[50:51], v[50:51], v[66:67]
    v_pk_mul_f32 v[52:53], v[52:53], v[68:69]
    v_pk_mul_f32 v[54:55], v[54:55], v[70:71]
    v_cvt_pk_bf16_f32 v72, v40, v41
    v_cvt_pk_bf16_f32 v73, v42, v43
    v_cvt_pk_bf16_f32 v74, v44, v45
    v_cvt_pk_bf16_f32 v75, v46, v47
    buffer_store_dwordx4 v[72:75], v1, s[16:19], s37 offen offset:0 sc1
    v_cvt_pk_bf16_f32 v76, v48, v49
    v_cvt_pk_bf16_f32 v77, v50, v51
    v_cvt_pk_bf16_f32 v78, v52, v53
    v_cvt_pk_bf16_f32 v79, v54, v55
    buffer_store_dwordx4 v[76:79], v1, s[16:19], s37 offen offset:1024 sc1
B_NOT3_7:
    s_waitcnt vmcnt(0)
    s_barrier
    s_cmp_lg_u32 s32, 0
    s_cbranch_scc1 SIG_8
    s_add_u32 s52, s28, 0x1d01000
    s_addc_u32 s53, s29, 0
    s_lshl_b32 vcc_lo, s30, 7
    v_mov_b32 v6, vcc_lo
    v_mov_b32 v7, 1
    s_mov_b64 exec, 1
    global_atomic_add v6, v7, s[52:53] sc1
    s_mov_b64 exec, -1
SIG_8:
    s_mul_i32 s35, s32, 22
    s_cmp_eq_u32 s32, 3
    s_cselect_b32 s35, 65, s35
    s_lshl_b32 s36, s35, 4
    s_lshl_b32 s37, s31, 1
    s_add_u32 s36, s36, s37
    s_add_u32 s36, s36, 1888
    s_lshl_b32 s49, s36, 10
    s_lshl_b32 s36, s30, 1
    s_mul_i32 s36, s36, 86
    s_add_u32 s36, s36, s35
    s_lshl_b32 s54, s36, 10
    s_add_u32 s55, s54, 88064
    s_add_u32 s8, s28, 0xc00000
    s_addc_u32 s9, s29, 0
    s_mov_b32 s10, 0x560000
    s_mov_b32 s11, 0x20000
    s_setprio 0
    buffer_load_dwordx4 v[80:83], v1, s[12:15], s49 offen offset:0
    buffer_load_dwordx4 v[84:87], v1, s[12:15], s49 offen offset:1024
    s_add_u32 s49, s49, 16384
    buffer_load_dwordx4 v[96:99], v1, s[12:15], s49 offen offset:0
    buffer_load_dwordx4 v[100:103], v1, s[12:15], s49 offen offset:1024
    s_add_u32 s49, s49, 16384
    buffer_load_dwordx4 v[112:115], v1, s[12:15], s49 offen offset:0
    buffer_load_dwordx4 v[116:119], v1, s[12:15], s49 offen offset:1024
    s_add_u32 s49, s49, 16384
    buffer_load_dwordx4 v[128:131], v1, s[12:15], s49 offen offset:0
    buffer_load_dwordx4 v[132:135], v1, s[12:15], s49 offen offset:1024
    s_add_u32 s49, s49, 16384
    buffer_load_dwordx4 v[144:147], v1, s[12:15], s49 offen offset:0
    buffer_load_dwordx4 v[148:151], v1, s[12:15], s49 offen offset:1024
    s_add_u32 s49, s49, 16384
    buffer_load_dwordx4 v[160:163], v1, s[12:15], s49 offen offset:0
    buffer_load_dwordx4 v[164:167], v1, s[12:15], s49 offen offset:1024
    s_add_u32 s49, s49, 16384
    s_setprio 2
    s_add_u32 s24, s28, 0x1c00000
    s_addc_u32 s25, s29, 0
    s_mov_b32 s26, 0x2000
    s_mov_b32 s27, 0x20000
    s_lshl_b32 s35, s31, 6
    s_lshl_b32 s36, s32, 3
    s_add_u32 s35, s35, s36
    s_add_u32 s35, s35, 3264
    s_lshl_b32 s37, s35, 10
    s_add_u32 s38, s37, 32768
    v_lshlrev_b32 v238, 2, v237
    buffer_load_dword v238, v238, s[24:27], 0 offen
    s_setprio 0
    buffer_load_dwordx4 v[168:171], v1, s[12:15], s37 offen offset:0
    buffer_load_dwordx4 v[172:175], v1, s[12:15], s38 offen offset:0
    buffer_load_dwordx4 v[176:179], v1, s[12:15], s37 offen offset:1024
    buffer_load_dwordx4 v[180:183], v1, s[12:15], s38 offen offset:1024
    buffer_load_dwordx4 v[184:187], v1, s[12:15], s37 offen offset:2048
    buffer_load_dwordx4 v[188:191], v1, s[12:15], s38 offen offset:2048
    buffer_load_dwordx4 v[192:195], v1, s[12:15], s37 offen offset:3072
    buffer_load_dwordx4 v[196:199], v1, s[12:15], s38 offen offset:3072
    s_add_u32 s37, s37, 4096
    s_add_u32 s38, s38, 4096
    buffer_load_dwordx4 v[200:203], v1, s[12:15], s37 offen offset:0
    buffer_load_dwordx4 v[204:207], v1, s[12:15], s38 offen offset:0
    buffer_load_dwordx4 v[208:211], v1, s[12:15], s37 offen offset:1024
    buffer_load_dwordx4 v[212:215], v1, s[12:15], s38 offen offset:1024
    buffer_load_dwordx4 v[216:219], v1, s[12:15], s37 offen offset:2048
    buffer_load_dwordx4 v[220:223], v1, s[12:15], s38 offen offset:2048
    buffer_load_dwordx4 v[224:227], v1, s[12:15], s37 offen offset:3072
    buffer_load_dwordx4 v[228:231], v1, s[12:15], s38 offen offset:3072
    s_setprio 2
    s_cmp_lg_u32 s32, 0
    s_cbranch_scc1 WT_9_done
    s_add_u32 s52, s28, 0x1d01000
    s_addc_u32 s53, s29, 0
    s_lshl_b32 vcc_lo, s30, 7
    v_mov_b32 v6, vcc_lo
    s_mov_b32 vcc_hi, 0x40000
WT_9:
    global_load_dword v7, v6, s[52:53] sc1
    s_waitcnt vmcnt(0)
    v_readfirstlane_b32 vcc_lo, v7
    s_cmp_ge_u32 vcc_lo, 8
    s_cbranch_scc1 WT_9_done
    s_sub_u32 vcc_hi, vcc_hi, 1
    s_cmp_eq_u32 vcc_hi, 0
    s_cbranch_scc1 WT_9_done
    s_sleep 0
    s_branch WT_9
WT_9_done:
    s_barrier
    s_setprio 0
    buffer_load_dwordx4 v[72:75], v1, s[8:11], s54 offen offset:0 sc1
    buffer_load_dwordx4 v[76:79], v1, s[8:11], s55 offen offset:0 sc1
    buffer_load_dwordx4 v[88:91], v1, s[8:11], s54 offen offset:1024 sc1
    buffer_load_dwordx4 v[92:95], v1, s[8:11], s55 offen offset:1024 sc1
    buffer_load_dwordx4 v[104:107], v1, s[8:11], s54 offen offset:2048 sc1
    buffer_load_dwordx4 v[108:111], v1, s[8:11], s55 offen offset:2048 sc1
    buffer_load_dwordx4 v[120:123], v1, s[8:11], s54 offen offset:3072 sc1
    buffer_load_dwordx4 v[124:127], v1, s[8:11], s55 offen offset:3072 sc1
    s_add_u32 s54, s54, 4096
    s_add_u32 s55, s55, 4096
    buffer_load_dwordx4 v[136:139], v1, s[8:11], s54 offen offset:0 sc1
    buffer_load_dwordx4 v[140:143], v1, s[8:11], s55 offen offset:0 sc1
    buffer_load_dwordx4 v[152:155], v1, s[8:11], s54 offen offset:1024 sc1
    buffer_load_dwordx4 v[156:159], v1, s[8:11], s55 offen offset:1024 sc1
    s_setprio 0
    s_waitcnt vmcnt(10)
    v_mfma_f32_32x32x16_bf16 v[8:23], v[80:83], v[72:75], 0
    v_mfma_f32_32x32x16_bf16 v[24:39], v[84:87], v[72:75], 0
    v_mfma_f32_32x32x16_bf16 v[40:55], v[80:83], v[76:79], 0
    v_mfma_f32_32x32x16_bf16 v[56:71], v[84:87], v[76:79], 0
    buffer_load_dwordx4 v[72:75], v1, s[8:11], s54 offen offset:2048 sc1
    buffer_load_dwordx4 v[76:79], v1, s[8:11], s55 offen offset:2048 sc1
    buffer_load_dwordx4 v[80:83], v1, s[12:15], s49 offen offset:0
    buffer_load_dwordx4 v[84:87], v1, s[12:15], s49 offen offset:1024
    s_add_u32 s49, s49, 16384
    s_waitcnt vmcnt(12)
    v_mfma_f32_32x32x16_bf16 v[8:23], v[96:99], v[88:91], v[8:23]
    v_mfma_f32_32x32x16_bf16 v[24:39], v[100:103], v[88:91], v[24:39]
    v_mfma_f32_32x32x16_bf16 v[40:55], v[96:99], v[92:95], v[40:55]
    v_mfma_f32_32x32x16_bf16 v[56:71], v[100:103], v[92:95], v[56:71]
    buffer_load_dwordx4 v[88:91], v1, s[8:11], s54 offen offset:3072 sc1
    buffer_load_dwordx4 v[92:95], v1, s[8:11], s55 offen offset:3072 sc1
    buffer_load_dwordx4 v[96:99], v1, s[12:15], s49 offen offset:0
    buffer_load_dwordx4 v[100:103], v1, s[12:15], s49 offen offset:1024
    s_add_u32 s49, s49, 16384
    s_waitcnt vmcnt(14)
    v_mfma_f32_32x32x16_bf16 v[8:23], v[112:115], v[104:107], v[8:23]
    v_mfma_f32_32x32x16_bf16 v[24:39], v[116:119], v[104:107], v[24:39]
    v_mfma_f32_32x32x16_bf16 v[40:55], v[112:115], v[108:111], v[40:55]
    v_mfma_f32_32x32x16_bf16 v[56:71], v[116:119], v[108:111], v[56:71]
    s_add_u32 s54, s54, 4096
    s_add_u32 s55, s55, 4096
    buffer_load_dwordx4 v[104:107], v1, s[8:11], s54 offen offset:0 sc1
    buffer_load_dwordx4 v[108:111], v1, s[8:11], s55 offen offset:0 sc1
    buffer_load_dwordx4 v[112:115], v1, s[12:15], s49 offen offset:0
    buffer_load_dwordx4 v[116:119], v1, s[12:15], s49 offen offset:1024
    s_add_u32 s49, s49, 16384
    s_waitcnt vmcnt(16)
    v_mfma_f32_32x32x16_bf16 v[8:23], v[128:131], v[120:123], v[8:23]
    v_mfma_f32_32x32x16_bf16 v[24:39], v[132:135], v[120:123], v[24:39]
    v_mfma_f32_32x32x16_bf16 v[40:55], v[128:131], v[124:127], v[40:55]
    v_mfma_f32_32x32x16_bf16 v[56:71], v[132:135], v[124:127], v[56:71]
    buffer_load_dwordx4 v[120:123], v1, s[8:11], s54 offen offset:1024 sc1
    buffer_load_dwordx4 v[124:127], v1, s[8:11], s55 offen offset:1024 sc1
    buffer_load_dwordx4 v[128:131], v1, s[12:15], s49 offen offset:0
    buffer_load_dwordx4 v[132:135], v1, s[12:15], s49 offen offset:1024
    s_add_u32 s49, s49, 16384
    s_waitcnt vmcnt(18)
    v_mfma_f32_32x32x16_bf16 v[8:23], v[144:147], v[136:139], v[8:23]
    v_mfma_f32_32x32x16_bf16 v[24:39], v[148:151], v[136:139], v[24:39]
    v_mfma_f32_32x32x16_bf16 v[40:55], v[144:147], v[140:143], v[40:55]
    v_mfma_f32_32x32x16_bf16 v[56:71], v[148:151], v[140:143], v[56:71]
    buffer_load_dwordx4 v[136:139], v1, s[8:11], s54 offen offset:2048 sc1
    buffer_load_dwordx4 v[140:143], v1, s[8:11], s55 offen offset:2048 sc1
    buffer_load_dwordx4 v[144:147], v1, s[12:15], s49 offen offset:0
    buffer_load_dwordx4 v[148:151], v1, s[12:15], s49 offen offset:1024
    s_add_u32 s49, s49, 16384
    s_waitcnt vmcnt(20)
    v_mfma_f32_32x32x16_bf16 v[8:23], v[160:163], v[152:155], v[8:23]
    v_mfma_f32_32x32x16_bf16 v[24:39], v[164:167], v[152:155], v[24:39]
    v_mfma_f32_32x32x16_bf16 v[40:55], v[160:163], v[156:159], v[40:55]
    v_mfma_f32_32x32x16_bf16 v[56:71], v[164:167], v[156:159], v[56:71]
    buffer_load_dwordx4 v[152:155], v1, s[8:11], s54 offen offset:3072 sc1
    buffer_load_dwordx4 v[156:159], v1, s[8:11], s55 offen offset:3072 sc1
    buffer_load_dwordx4 v[160:163], v1, s[12:15], s49 offen offset:0
    buffer_load_dwordx4 v[164:167], v1, s[12:15], s49 offen offset:1024
    s_add_u32 s49, s49, 16384
    s_waitcnt vmcnt(20)
    v_mfma_f32_32x32x16_bf16 v[8:23], v[80:83], v[72:75], v[8:23]
    v_mfma_f32_32x32x16_bf16 v[24:39], v[84:87], v[72:75], v[24:39]
    v_mfma_f32_32x32x16_bf16 v[40:55], v[80:83], v[76:79], v[40:55]
    v_mfma_f32_32x32x16_bf16 v[56:71], v[84:87], v[76:79], v[56:71]
    s_add_u32 s54, s54, 4096
    s_add_u32 s55, s55, 4096
    buffer_load_dwordx4 v[72:75], v1, s[8:11], s54 offen offset:0 sc1
    buffer_load_dwordx4 v[76:79], v1, s[8:11], s55 offen offset:0 sc1
    buffer_load_dwordx4 v[80:83], v1, s[12:15], s49 offen offset:0
    buffer_load_dwordx4 v[84:87], v1, s[12:15], s49 offen offset:1024
    s_add_u32 s49, s49, 16384
    s_waitcnt vmcnt(20)
    v_mfma_f32_32x32x16_bf16 v[8:23], v[96:99], v[88:91], v[8:23]
    v_mfma_f32_32x32x16_bf16 v[24:39], v[100:103], v[88:91], v[24:39]
    v_mfma_f32_32x32x16_bf16 v[40:55], v[96:99], v[92:95], v[40:55]
    v_mfma_f32_32x32x16_bf16 v[56:71], v[100:103], v[92:95], v[56:71]
    buffer_load_dwordx4 v[88:91], v1, s[8:11], s54 offen offset:1024 sc1
    buffer_load_dwordx4 v[92:95], v1, s[8:11], s55 offen offset:1024 sc1
    buffer_load_dwordx4 v[96:99], v1, s[12:15], s49 offen offset:0
    buffer_load_dwordx4 v[100:103], v1, s[12:15], s49 offen offset:1024
    s_add_u32 s49, s49, 16384
    s_waitcnt vmcnt(20)
    v_mfma_f32_32x32x16_bf16 v[8:23], v[112:115], v[104:107], v[8:23]
    v_mfma_f32_32x32x16_bf16 v[24:39], v[116:119], v[104:107], v[24:39]
    v_mfma_f32_32x32x16_bf16 v[40:55], v[112:115], v[108:111], v[40:55]
    v_mfma_f32_32x32x16_bf16 v[56:71], v[116:119], v[108:111], v[56:71]
    buffer_load_dwordx4 v[104:107], v1, s[8:11], s54 offen offset:2048 sc1
    buffer_load_dwordx4 v[108:111], v1, s[8:11], s55 offen offset:2048 sc1
    buffer_load_dwordx4 v[112:115], v1, s[12:15], s49 offen offset:0
    buffer_load_dwordx4 v[116:119], v1, s[12:15], s49 offen offset:1024
    s_add_u32 s49, s49, 16384
    s_waitcnt vmcnt(20)
    v_mfma_f32_32x32x16_bf16 v[8:23], v[128:131], v[120:123], v[8:23]
    v_mfma_f32_32x32x16_bf16 v[24:39], v[132:135], v[120:123], v[24:39]
    v_mfma_f32_32x32x16_bf16 v[40:55], v[128:131], v[124:127], v[40:55]
    v_mfma_f32_32x32x16_bf16 v[56:71], v[132:135], v[124:127], v[56:71]
    buffer_load_dwordx4 v[120:123], v1, s[8:11], s54 offen offset:3072 sc1
    buffer_load_dwordx4 v[124:127], v1, s[8:11], s55 offen offset:3072 sc1
    buffer_load_dwordx4 v[128:131], v1, s[12:15], s49 offen offset:0
    buffer_load_dwordx4 v[132:135], v1, s[12:15], s49 offen offset:1024
    s_add_u32 s49, s49, 16384
    s_waitcnt vmcnt(20)
    v_mfma_f32_32x32x16_bf16 v[8:23], v[144:147], v[136:139], v[8:23]
    v_mfma_f32_32x32x16_bf16 v[24:39], v[148:151], v[136:139], v[24:39]
    v_mfma_f32_32x32x16_bf16 v[40:55], v[144:147], v[140:143], v[40:55]
    v_mfma_f32_32x32x16_bf16 v[56:71], v[148:151], v[140:143], v[56:71]
    s_add_u32 s54, s54, 4096
    s_add_u32 s55, s55, 4096
    buffer_load_dwordx4 v[136:139], v1, s[8:11], s54 offen offset:0 sc1
    buffer_load_dwordx4 v[140:143], v1, s[8:11], s55 offen offset:0 sc1
    buffer_load_dwordx4 v[144:147], v1, s[12:15], s49 offen offset:0
    buffer_load_dwordx4 v[148:151], v1, s[12:15], s49 offen offset:1024
    s_add_u32 s49, s49, 16384
    s_waitcnt vmcnt(20)
    v_mfma_f32_32x32x16_bf16 v[8:23], v[160:163], v[152:155], v[8:23]
    v_mfma_f32_32x32x16_bf16 v[24:39], v[164:167], v[152:155], v[24:39]
    v_mfma_f32_32x32x16_bf16 v[40:55], v[160:163], v[156:159], v[40:55]
    v_mfma_f32_32x32x16_bf16 v[56:71], v[164:167], v[156:159], v[56:71]
    buffer_load_dwordx4 v[152:155], v1, s[8:11], s54 offen offset:1024 sc1
    buffer_load_dwordx4 v[156:159], v1, s[8:11], s55 offen offset:1024 sc1
    buffer_load_dwordx4 v[160:163], v1, s[12:15], s49 offen offset:0
    buffer_load_dwordx4 v[164:167], v1, s[12:15], s49 offen offset:1024
    s_add_u32 s49, s49, 16384
    s_waitcnt vmcnt(20)
    v_mfma_f32_32x32x16_bf16 v[8:23], v[80:83], v[72:75], v[8:23]
    v_mfma_f32_32x32x16_bf16 v[24:39], v[84:87], v[72:75], v[24:39]
    v_mfma_f32_32x32x16_bf16 v[40:55], v[80:83], v[76:79], v[40:55]
    v_mfma_f32_32x32x16_bf16 v[56:71], v[84:87], v[76:79], v[56:71]
    buffer_load_dwordx4 v[72:75], v1, s[8:11], s54 offen offset:2048 sc1
    buffer_load_dwordx4 v[76:79], v1, s[8:11], s55 offen offset:2048 sc1
    buffer_load_dwordx4 v[80:83], v1, s[12:15], s49 offen offset:0
    buffer_load_dwordx4 v[84:87], v1, s[12:15], s49 offen offset:1024
    s_add_u32 s49, s49, 16384
    s_waitcnt vmcnt(20)
    v_mfma_f32_32x32x16_bf16 v[8:23], v[96:99], v[88:91], v[8:23]
    v_mfma_f32_32x32x16_bf16 v[24:39], v[100:103], v[88:91], v[24:39]
    v_mfma_f32_32x32x16_bf16 v[40:55], v[96:99], v[92:95], v[40:55]
    v_mfma_f32_32x32x16_bf16 v[56:71], v[100:103], v[92:95], v[56:71]
    buffer_load_dwordx4 v[88:91], v1, s[8:11], s54 offen offset:3072 sc1
    buffer_load_dwordx4 v[92:95], v1, s[8:11], s55 offen offset:3072 sc1
    buffer_load_dwordx4 v[96:99], v1, s[12:15], s49 offen offset:0
    buffer_load_dwordx4 v[100:103], v1, s[12:15], s49 offen offset:1024
    s_add_u32 s49, s49, 16384
    s_waitcnt vmcnt(20)
    v_mfma_f32_32x32x16_bf16 v[8:23], v[112:115], v[104:107], v[8:23]
    v_mfma_f32_32x32x16_bf16 v[24:39], v[116:119], v[104:107], v[24:39]
    v_mfma_f32_32x32x16_bf16 v[40:55], v[112:115], v[108:111], v[40:55]
    v_mfma_f32_32x32x16_bf16 v[56:71], v[116:119], v[108:111], v[56:71]
    s_add_u32 s54, s54, 4096
    s_add_u32 s55, s55, 4096
    buffer_load_dwordx4 v[104:107], v1, s[8:11], s54 offen offset:0 sc1
    buffer_load_dwordx4 v[108:111], v1, s[8:11], s55 offen offset:0 sc1
    buffer_load_dwordx4 v[112:115], v1, s[12:15], s49 offen offset:0
    buffer_load_dwordx4 v[116:119], v1, s[12:15], s49 offen offset:1024
    s_add_u32 s49, s49, 16384
    s_waitcnt vmcnt(20)
    v_mfma_f32_32x32x16_bf16 v[8:23], v[128:131], v[120:123], v[8:23]
    v_mfma_f32_32x32x16_bf16 v[24:39], v[132:135], v[120:123], v[24:39]
    v_mfma_f32_32x32x16_bf16 v[40:55], v[128:131], v[124:127], v[40:55]
    v_mfma_f32_32x32x16_bf16 v[56:71], v[132:135], v[124:127], v[56:71]
    buffer_load_dwordx4 v[120:123], v1, s[8:11], s54 offen offset:1024 sc1
    buffer_load_dwordx4 v[124:127], v1, s[8:11], s55 offen offset:1024 sc1
    buffer_load_dwordx4 v[128:131], v1, s[12:15], s49 offen offset:0
    buffer_load_dwordx4 v[132:135], v1, s[12:15], s49 offen offset:1024
    s_add_u32 s49, s49, 16384
    s_waitcnt vmcnt(20)
    v_mfma_f32_32x32x16_bf16 v[8:23], v[144:147], v[136:139], v[8:23]
    v_mfma_f32_32x32x16_bf16 v[24:39], v[148:151], v[136:139], v[24:39]
    v_mfma_f32_32x32x16_bf16 v[40:55], v[144:147], v[140:143], v[40:55]
    v_mfma_f32_32x32x16_bf16 v[56:71], v[148:151], v[140:143], v[56:71]
    s_waitcnt vmcnt(16)
    v_mfma_f32_32x32x16_bf16 v[8:23], v[160:163], v[152:155], v[8:23]
    v_mfma_f32_32x32x16_bf16 v[24:39], v[164:167], v[152:155], v[24:39]
    v_mfma_f32_32x32x16_bf16 v[40:55], v[160:163], v[156:159], v[40:55]
    v_mfma_f32_32x32x16_bf16 v[56:71], v[164:167], v[156:159], v[56:71]
    s_waitcnt vmcnt(12)
    v_mfma_f32_32x32x16_bf16 v[8:23], v[80:83], v[72:75], v[8:23]
    v_mfma_f32_32x32x16_bf16 v[24:39], v[84:87], v[72:75], v[24:39]
    v_mfma_f32_32x32x16_bf16 v[40:55], v[80:83], v[76:79], v[40:55]
    v_mfma_f32_32x32x16_bf16 v[56:71], v[84:87], v[76:79], v[56:71]
    s_waitcnt vmcnt(8)
    v_mfma_f32_32x32x16_bf16 v[8:23], v[96:99], v[88:91], v[8:23]
    v_mfma_f32_32x32x16_bf16 v[24:39], v[100:103], v[88:91], v[24:39]
    v_mfma_f32_32x32x16_bf16 v[40:55], v[96:99], v[92:95], v[40:55]
    v_mfma_f32_32x32x16_bf16 v[56:71], v[100:103], v[92:95], v[56:71]
    s_waitcnt vmcnt(4)
    v_mfma_f32_32x32x16_bf16 v[8:23], v[112:115], v[104:107], v[8:23]
    v_mfma_f32_32x32x16_bf16 v[24:39], v[116:119], v[104:107], v[24:39]
    v_mfma_f32_32x32x16_bf16 v[40:55], v[112:115], v[108:111], v[40:55]
    v_mfma_f32_32x32x16_bf16 v[56:71], v[116:119], v[108:111], v[56:71]
    s_cmp_ge_u32 s32, 2
    s_cbranch_scc1 B_W4D_10
    s_waitcnt vmcnt(0)
    v_mfma_f32_32x32x16_bf16 v[8:23], v[128:131], v[120:123], v[8:23]
    v_mfma_f32_32x32x16_bf16 v[24:39], v[132:135], v[120:123], v[24:39]
    v_mfma_f32_32x32x16_bf16 v[40:55], v[128:131], v[124:127], v[40:55]
    v_mfma_f32_32x32x16_bf16 v[56:71], v[132:135], v[124:127], v[56:71]
B_W4D_10:
    s_setprio 2
    s_waitcnt vmcnt(0)
    s_lshl_b32 s35, s32, 12
    v_add_u32 v236, s35, v1
    s_nop 7
    ds_write_b128 v236, v[8:11] offset:0
    ds_write_b128 v236, v[12:15] offset:1024
    ds_write_b128 v236, v[16:19] offset:2048
    ds_write_b128 v236, v[20:23] offset:3072
    ds_write_b128 v236, v[24:27] offset:16384
    ds_write_b128 v236, v[28:31] offset:17408
    ds_write_b128 v236, v[32:35] offset:18432
    ds_write_b128 v236, v[36:39] offset:19456
    ds_write_b128 v236, v[40:43] offset:32768
    ds_write_b128 v236, v[44:47] offset:33792
    ds_write_b128 v236, v[48:51] offset:34816
    ds_write_b128 v236, v[52:55] offset:35840
    ds_write_b128 v236, v[56:59] offset:49152
    ds_write_b128 v236, v[60:63] offset:50176
    ds_write_b128 v236, v[64:67] offset:51200
    ds_write_b128 v236, v[68:71] offset:52224
    s_lshl_b32 s35, s32, 14
    v_add_u32 v236, s35, v1
    s_waitcnt lgkmcnt(0)
    s_barrier
    ds_read_b128 v[8:11], v236 offset:0
    ds_read_b128 v[12:15], v236 offset:1024
    ds_read_b128 v[16:19], v236 offset:2048
    ds_read_b128 v[20:23], v236 offset:3072
    ds_read_b128 v[24:27], v236 offset:4096
    ds_read_b128 v[28:31], v236 offset:5120
    ds_read_b128 v[32:35], v236 offset:6144
    ds_read_b128 v[36:39], v236 offset:7168
    ds_read_b128 v[40:43], v236 offset:8192
    ds_read_b128 v[44:47], v236 offset:9216
    ds_read_b128 v[48:51], v236 offset:10240
    ds_read_b128 v[52:55], v236 offset:11264
    ds_read_b128 v[56:59], v236 offset:12288
    ds_read_b128 v[60:63], v236 offset:13312
    ds_read_b128 v[64:67], v236 offset:14336
    ds_read_b128 v[68:71], v236 offset:15360
    s_waitcnt lgkmcnt(12)
    v_pk_add_f32 v[240:241], v[240:241], v[8:9]
    v_pk_add_f32 v[242:243], v[242:243], v[10:11]
    v_pk_add_f32 v[244:245], v[244:245], v[12:13]
    v_pk_add_f32 v[246:247], v[246:247], v[14:15]
    v_pk_add_f32 v[248:249], v[248:249], v[16:17]
    v_pk_add_f32 v[250:251], v[250:251], v[18:19]
    v_pk_add_f32 v[252:253], v[252:253], v[20:21]
    v_pk_add_f32 v[254:255], v[254:255], v[22:23]
    s_waitcnt lgkmcnt(8)
    v_pk_add_f32 v[240:241], v[240:241], v[24:25]
    v_pk_add_f32 v[242:243], v[242:243], v[26:27]
    v_pk_add_f32 v[244:245], v[244:245], v[28:29]
    v_pk_add_f32 v[246:247], v[246:247], v[30:31]
    v_pk_add_f32 v[248:249], v[248:249], v[32:33]
    v_pk_add_f32 v[250:251], v[250:251], v[34:35]
    v_pk_add_f32 v[252:253], v[252:253], v[36:37]
    v_pk_add_f32 v[254:255], v[254:255], v[38:39]
    s_waitcnt lgkmcnt(4)
    v_pk_add_f32 v[240:241], v[240:241], v[40:41]
    v_pk_add_f32 v[242:243], v[242:243], v[42:43]
    v_pk_add_f32 v[244:245], v[244:245], v[44:45]
    v_pk_add_f32 v[246:247], v[246:247], v[46:47]
    v_pk_add_f32 v[248:249], v[248:249], v[48:49]
    v_pk_add_f32 v[250:251], v[250:251], v[50:51]
    v_pk_add_f32 v[252:253], v[252:253], v[52:53]
    v_pk_add_f32 v[254:255], v[254:255], v[54:55]
    s_waitcnt lgkmcnt(0)
    v_pk_add_f32 v[240:241], v[240:241], v[56:57]
    v_pk_add_f32 v[242:243], v[242:243], v[58:59]
    v_pk_add_f32 v[244:245], v[244:245], v[60:61]
    v_pk_add_f32 v[246:247], v[246:247], v[62:63]
    v_pk_add_f32 v[248:249], v[248:249], v[64:65]
    v_pk_add_f32 v[250:251], v[250:251], v[66:67]
    v_pk_add_f32 v[252:253], v[252:253], v[68:69]
    v_pk_add_f32 v[254:255], v[254:255], v[70:71]
    s_add_u32 s8, s28, 0xa00000
    s_addc_u32 s9, s29, 0
    s_mov_b32 s10, 0x200000
    s_mov_b32 s11, 0x20000
    s_lshl_b32 s35, s30, 6
    s_lshl_b32 s36, s32, 3
    s_add_u32 s35, s35, s36
    s_lshl_b32 s54, s35, 10
    s_add_u32 s55, s54, 32768
    s_lshr_b32 s46, s30, 2
    s_cmp_lg_u32 s32, 0
    s_cbranch_scc1 WT_11_done
    s_add_u32 s52, s28, 0x1d02800
    s_addc_u32 s53, s29, 0
    s_lshl_b32 vcc_lo, s30, 7
    v_mov_b32 v6, vcc_lo
    s_mov_b32 vcc_hi, 0x40000
WT_11:
    global_load_dword v7, v6, s[52:53] sc1
    s_waitcnt vmcnt(0)
    v_readfirstlane_b32 vcc_lo, v7
    s_cmp_ge_u32 vcc_lo, 32
    s_cbranch_scc1 WT_11_done
    s_sub_u32 vcc_hi, vcc_hi, 1
    s_cmp_eq_u32 vcc_hi, 0
    s_cbranch_scc1 WT_11_done
    s_sleep 0
    s_branch WT_11
WT_11_done:
    s_barrier
    s_setprio 0
    buffer_load_dwordx4 v[72:75], v1, s[8:11], s54 offen offset:0 sc1
    buffer_load_dwordx4 v[76:79], v1, s[8:11], s55 offen offset:0 sc1
    buffer_load_dwordx4 v[80:83], v1, s[8:11], s54 offen offset:1024 sc1
    buffer_load_dwordx4 v[84:87], v1, s[8:11], s55 offen offset:1024 sc1
    buffer_load_dwordx4 v[88:91], v1, s[8:11], s54 offen offset:2048 sc1
    buffer_load_dwordx4 v[92:95], v1, s[8:11], s55 offen offset:2048 sc1
    buffer_load_dwordx4 v[96:99], v1, s[8:11], s54 offen offset:3072 sc1
    buffer_load_dwordx4 v[100:103], v1, s[8:11], s55 offen offset:3072 sc1
    s_add_u32 s54, s54, 4096
    s_add_u32 s55, s55, 4096
    buffer_load_dwordx4 v[104:107], v1, s[8:11], s54 offen offset:0 sc1
    buffer_load_dwordx4 v[108:111], v1, s[8:11], s55 offen offset:0 sc1
    buffer_load_dwordx4 v[112:115], v1, s[8:11], s54 offen offset:1024 sc1
    buffer_load_dwordx4 v[116:119], v1, s[8:11], s55 offen offset:1024 sc1
    buffer_load_dwordx4 v[120:123], v1, s[8:11], s54 offen offset:2048 sc1
    buffer_load_dwordx4 v[124:127], v1, s[8:11], s55 offen offset:2048 sc1
    buffer_load_dwordx4 v[128:131], v1, s[8:11], s54 offen offset:3072 sc1
    buffer_load_dwordx4 v[132:135], v1, s[8:11], s55 offen offset:3072 sc1
    s_setprio 2
    s_waitcnt vmcnt(14)
    v_mfma_f32_32x32x16_bf16 v[8:23], v[168:171], v[72:75], 0
    v_mfma_f32_32x32x16_bf16 v[24:39], v[172:175], v[72:75], 0
    v_mfma_f32_32x32x16_bf16 v[40:55], v[168:171], v[76:79], 0
    v_mfma_f32_32x32x16_bf16 v[56:71], v[172:175], v[76:79], 0
    s_waitcnt vmcnt(12)
    v_mfma_f32_32x32x16_bf16 v[8:23], v[176:179], v[80:83], v[8:23]
    v_mfma_f32_32x32x16_bf16 v[24:39], v[180:183], v[80:83], v[24:39]
    v_mfma_f32_32x32x16_bf16 v[40:55], v[176:179], v[84:87], v[40:55]
    v_mfma_f32_32x32x16_bf16 v[56:71], v[180:183], v[84:87], v[56:71]
    s_waitcnt vmcnt(10)
    v_mfma_f32_32x32x16_bf16 v[8:23], v[184:187], v[88:91], v[8:23]
    v_mfma_f32_32x32x16_bf16 v[24:39], v[188:191], v[88:91], v[24:39]
    v_mfma_f32_32x32x16_bf16 v[40:55], v[184:187], v[92:95], v[40:55]
    v_mfma_f32_32x32x16_bf16 v[56:71], v[188:191], v[92:95], v[56:71]
    s_waitcnt vmcnt(8)
    v_mfma_f32_32x32x16_bf16 v[8:23], v[192:195], v[96:99], v[8:23]
    v_mfma_f32_32x32x16_bf16 v[24:39], v[196:199], v[96:99], v[24:39]
    v_mfma_f32_32x32x16_bf16 v[40:55], v[192:195], v[100:103], v[40:55]
    v_mfma_f32_32x32x16_bf16 v[56:71], v[196:199], v[100:103], v[56:71]
    s_waitcnt vmcnt(6)
    v_mfma_f32_32x32x16_bf16 v[8:23], v[200:203], v[104:107], v[8:23]
    v_mfma_f32_32x32x16_bf16 v[24:39], v[204:207], v[104:107], v[24:39]
    v_mfma_f32_32x32x16_bf16 v[40:55], v[200:203], v[108:111], v[40:55]
    v_mfma_f32_32x32x16_bf16 v[56:71], v[204:207], v[108:111], v[56:71]
    s_waitcnt vmcnt(4)
    v_mfma_f32_32x32x16_bf16 v[8:23], v[208:211], v[112:115], v[8:23]
    v_mfma_f32_32x32x16_bf16 v[24:39], v[212:215], v[112:115], v[24:39]
    v_mfma_f32_32x32x16_bf16 v[40:55], v[208:211], v[116:119], v[40:55]
    v_mfma_f32_32x32x16_bf16 v[56:71], v[212:215], v[116:119], v[56:71]
    s_waitcnt vmcnt(2)
    v_mfma_f32_32x32x16_bf16 v[8:23], v[216:219], v[120:123], v[8:23]
    v_mfma_f32_32x32x16_bf16 v[24:39], v[220:223], v[120:123], v[24:39]
    v_mfma_f32_32x32x16_bf16 v[40:55], v[216:219], v[124:127], v[40:55]
    v_mfma_f32_32x32x16_bf16 v[56:71], v[220:223], v[124:127], v[56:71]
    s_waitcnt vmcnt(0)
    v_mfma_f32_32x32x16_bf16 v[8:23], v[224:227], v[128:131], v[8:23]
    v_mfma_f32_32x32x16_bf16 v[24:39], v[228:231], v[128:131], v[24:39]
    v_mfma_f32_32x32x16_bf16 v[40:55], v[224:227], v[132:135], v[40:55]
    v_mfma_f32_32x32x16_bf16 v[56:71], v[228:231], v[132:135], v[56:71]
    s_nop 7
    s_lshl_b32 s35, s32, 12
    v_add_u32 v236, s35, v1
    ds_write_b128 v236, v[8:11] offset:0
    ds_write_b128 v236, v[12:15] offset:1024
    ds_write_b128 v236, v[16:19] offset:2048
    ds_write_b128 v236, v[20:23] offset:3072
    ds_write_b128 v236, v[24:27] offset:16384
    ds_write_b128 v236, v[28:31] offset:17408
    ds_write_b128 v236, v[32:35] offset:18432
    ds_write_b128 v236, v[36:39] offset:19456
    ds_write_b128 v236, v[40:43] offset:32768
    ds_write_b128 v236, v[44:47] offset:33792
    ds_write_b128 v236, v[48:51] offset:34816
    ds_write_b128 v236, v[52:55] offset:35840
    ds_write_b128 v236, v[56:59] offset:49152
    ds_write_b128 v236, v[60:63] offset:50176
    ds_write_b128 v236, v[64:67] offset:51200
    ds_write_b128 v236, v[68:71] offset:52224
    s_lshl_b32 s35, s32, 14
    v_add_u32 v236, s35, v1
    s_waitcnt lgkmcnt(0)
    s_barrier
    ds_read_b128 v[8:11], v236 offset:0
    ds_read_b128 v[12:15], v236 offset:1024
    ds_read_b128 v[16:19], v236 offset:2048
    ds_read_b128 v[20:23], v236 offset:3072
    ds_read_b128 v[24:27], v236 offset:4096
    ds_read_b128 v[28:31], v236 offset:5120
    ds_read_b128 v[32:35], v236 offset:6144
    ds_read_b128 v[36:39], v236 offset:7168
    ds_read_b128 v[40:43], v236 offset:8192
    ds_read_b128 v[44:47], v236 offset:9216
    ds_read_b128 v[48:51], v236 offset:10240
    ds_read_b128 v[52:55], v236 offset:11264
    ds_read_b128 v[56:59], v236 offset:12288
    ds_read_b128 v[60:63], v236 offset:13312
    ds_read_b128 v[64:67], v236 offset:14336
    ds_read_b128 v[68:71], v236 offset:15360
    s_waitcnt lgkmcnt(8)
    v_pk_add_f32 v[8:9], v[8:9], v[24:25]
    v_pk_add_f32 v[10:11], v[10:11], v[26:27]
    v_pk_add_f32 v[12:13], v[12:13], v[28:29]
    v_pk_add_f32 v[14:15], v[14:15], v[30:31]
    v_pk_add_f32 v[16:17], v[16:17], v[32:33]
    v_pk_add_f32 v[18:19], v[18:19], v[34:35]
    v_pk_add_f32 v[20:21], v[20:21], v[36:37]
    v_pk_add_f32 v[22:23], v[22:23], v[38:39]
    s_waitcnt lgkmcnt(0)
    v_pk_add_f32 v[40:41], v[40:41], v[56:57]
    v_pk_add_f32 v[42:43], v[42:43], v[58:59]
    v_pk_add_f32 v[44:45], v[44:45], v[60:61]
    v_pk_add_f32 v[46:47], v[46:47], v[62:63]
    v_pk_add_f32 v[48:49], v[48:49], v[64:65]
    v_pk_add_f32 v[50:51], v[50:51], v[66:67]
    v_pk_add_f32 v[52:53], v[52:53], v[68:69]
    v_pk_add_f32 v[54:55], v[54:55], v[70:71]
    v_pk_add_f32 v[8:9], v[8:9], v[40:41]
    v_pk_add_f32 v[10:11], v[10:11], v[42:43]
    v_pk_add_f32 v[12:13], v[12:13], v[44:45]
    v_pk_add_f32 v[14:15], v[14:15], v[46:47]
    v_pk_add_f32 v[16:17], v[16:17], v[48:49]
    v_pk_add_f32 v[18:19], v[18:19], v[50:51]
    v_pk_add_f32 v[20:21], v[20:21], v[52:53]
    v_pk_add_f32 v[22:23], v[22:23], v[54:55]
    v_pk_add_f32 v[8:9], v[8:9], v[240:241] neg_lo:[0,1] neg_hi:[0,1]
    v_pk_add_f32 v[10:11], v[10:11], v[242:243] neg_lo:[0,1] neg_hi:[0,1]
    v_pk_add_f32 v[12:13], v[12:13], v[244:245] neg_lo:[0,1] neg_hi:[0,1]
    v_pk_add_f32 v[14:15], v[14:15], v[246:247] neg_lo:[0,1] neg_hi:[0,1]
    v_pk_add_f32 v[16:17], v[16:17], v[248:249] neg_lo:[0,1] neg_hi:[0,1]
    v_pk_add_f32 v[18:19], v[18:19], v[250:251] neg_lo:[0,1] neg_hi:[0,1]
    v_pk_add_f32 v[20:21], v[20:21], v[252:253] neg_lo:[0,1] neg_hi:[0,1]
    v_pk_add_f32 v[22:23], v[22:23], v[254:255] neg_lo:[0,1] neg_hi:[0,1]
    v_pk_fma_f32 v[8:9], v[8:9], v[238:239], v[240:241] op_sel_hi:[1,0,1]
    v_pk_fma_f32 v[10:11], v[10:11], v[238:239], v[242:243] op_sel_hi:[1,0,1]
    v_pk_fma_f32 v[12:13], v[12:13], v[238:239], v[244:245] op_sel_hi:[1,0,1]
    v_pk_fma_f32 v[14:15], v[14:15], v[238:239], v[246:247] op_sel_hi:[1,0,1]
    v_pk_fma_f32 v[16:17], v[16:17], v[238:239], v[248:249] op_sel_hi:[1,0,1]
    v_pk_fma_f32 v[18:19], v[18:19], v[238:239], v[250:251] op_sel_hi:[1,0,1]
    v_pk_fma_f32 v[20:21], v[20:21], v[238:239], v[252:253] op_sel_hi:[1,0,1]
    v_pk_fma_f32 v[22:23], v[22:23], v[238:239], v[254:255] op_sel_hi:[1,0,1]
    s_mov_b32 s16, s42
    s_mov_b32 s17, s43
    s_mov_b32 s18, 0x200000
    s_mov_b32 s19, 0x20000
    v_lshlrev_b32 v236, 10, v237
    v_lshl_add_u32 v236, v3, 4, v236
    s_lshl_b32 s35, s31, 7
    s_lshl_b32 s36, s34, 6
    s_add_u32 s35, s35, s36
    v_cvt_pk_bf16_f32 v72, v8, v9
    v_cvt_pk_bf16_f32 v73, v10, v11
    v_cvt_pk_bf16_f32 v74, v12, v13
    v_cvt_pk_bf16_f32 v75, v14, v15
    v_cvt_pk_bf16_f32 v76, v16, v17
    v_cvt_pk_bf16_f32 v77, v18, v19
    v_cvt_pk_bf16_f32 v78, v20, v21
    v_cvt_pk_bf16_f32 v79, v22, v23
    s_nop 1
    v_permlane32_swap_b32 v72, v74
    v_permlane32_swap_b32 v73, v75
    v_permlane32_swap_b32 v76, v78
    v_permlane32_swap_b32 v77, v79
    buffer_store_dwordx4 v[72:75], v236, s[16:19], s35 offen offset:0 nt
    buffer_store_dwordx4 v[76:79], v236, s[16:19], s35 offen offset:32 nt
K2_END:
    s_endpgm
K2_CODE_END:
    s_endpgm
.section .rodata,"a"
.p2align 6
.amdhsa_kernel k1_kernel
  .amdhsa_next_free_vgpr 168
  .amdhsa_next_free_sgpr 96
  .amdhsa_accum_offset 168
  .amdhsa_group_segment_fixed_size 0
  .amdhsa_kernarg_size 96
  .amdhsa_user_sgpr_count 2
  .amdhsa_user_sgpr_kernarg_segment_ptr 1
  .amdhsa_system_sgpr_workgroup_id_x 1
  .amdhsa_float_denorm_mode_32 3
.end_amdhsa_kernel
.p2align 6
.amdhsa_kernel k2_kernel
  .amdhsa_next_free_vgpr 256
  .amdhsa_next_free_sgpr 96
  .amdhsa_accum_offset 256
  .amdhsa_group_segment_fixed_size 0
  .amdhsa_kernarg_size 96
  .amdhsa_user_sgpr_count 2
  .amdhsa_user_sgpr_kernarg_segment_ptr 1
  .amdhsa_system_sgpr_workgroup_id_x 1
  .amdhsa_float_denorm_mode_32 3
.end_amdhsa_kernel
```
